```python
import torch

def _softmax(x, axis=-1):
    return torch.softmax(x, dim=axis)
def _gelu(x):
    return torch.nn.functional.gelu(x, approximate="tanh")
def _silu(x):
    return torch.nn.functional.silu(x)
def _sigmoid(x):
    return torch.sigmoid(x)
def _layernorm(x, axis=-1, eps=1e-5):
    m = x.mean(dim=axis, keepdim=True)
    v = x.var(dim=axis, keepdim=True, unbiased=False)
    return (x - m) / torch.sqrt(v + eps)
def _scatter_add(tgt, idx, src, axis=0):
    return tgt.clone().index_add_(axis, idx, src)
def _segment_sum(src, seg, n):
    out = torch.zeros((n,) + src.shape[1:], dtype=src.dtype)
    return out.index_add_(0, seg, src)
def _pad(x, pw):
    flat = tuple(v for pair in reversed(pw) for v in pair)
    return torch.nn.functional.pad(x, flat)

kernel_name = 'parallel_sum__sliding_local_dilated__dense_activation_relu__prompt'

def setup_inputs():

    _w = (lambda a: (lambda t: t.to(torch.bfloat16) if t.is_floating_point() else t)(torch.as_tensor(a)))
    def _A_setup():
        B, S, D = 1, 2048, 1024
        return {
            "x": _w((lambda *s: torch.randn(*s, dtype=torch.bfloat16) * 0.05)(B, S, D)),
            "wqkv": _w((lambda *s: torch.randn(*s, dtype=torch.bfloat16) * 0.05)(D, 3 * D)),
            "wo": _w((lambda *s: torch.randn(*s, dtype=torch.bfloat16) * 0.05)(D, D)),
        }
    _A_in = _A_setup()

    def _B_setup():
        B, S, D, Dff = 1, 2048, 1024, 3584
        return {
            "x": _w((lambda *s: torch.randn(*s, dtype=torch.bfloat16) * 0.05)(B, S, D)),
            "w1": _w((lambda *s: torch.randn(*s, dtype=torch.bfloat16) * 0.05)(D, Dff)),
            "w2": _w((lambda *s: torch.randn(*s, dtype=torch.bfloat16) * 0.05)(Dff, D)),
        }
    _B_in = _B_setup()

    return {
        "A_x": _A_in["x"],
        "A_wqkv": _A_in["wqkv"],
        "A_wo": _A_in["wo"],
        "B_x": _B_in["x"],
        "B_w1": _B_in["w1"],
        "B_w2": _B_in["w2"],
    }

def reference(A_x, A_wqkv, A_wo, B_x, B_w1, B_w2):
    def _A_ref(x, wqkv, wo):
        B, S, D = x.shape
        H = 32; Dh = D // H
        W, dil = 8, 2
        qkv = (lambda x, *d: x.permute(*d))((x @ wqkv).reshape(B, S, 3, H, Dh), 2, 0, 3, 1, 4)
        q, k, v = qkv[0], qkv[1], qkv[2]
        scale = Dh ** -0.5
        pos = torch.arange(S)
        off = torch.arange(W) * dil
        idx = pos[:, None] - off[None, :]
        mask = idx >= 0
        idx_c = torch.where(mask, idx, 0).reshape(-1)
        kg = k[:, :, idx_c, :].reshape(B, H, S, W, Dh)
        vg = v[:, :, idx_c, :].reshape(B, H, S, W, Dh)
        logits = torch.einsum("bhsd,bhswd->bhsw", q, kg) * scale
        logits = torch.where(mask[None, None, :, :], logits, -1e9)
        attn = _softmax(logits, axis=-1)
        o = torch.einsum("bhsw,bhswd->bhsd", attn, vg)
        return (lambda x, *d: x.permute(*d))(o, 0, 2, 1, 3).reshape(B, S, D) @ wo

    def _B_ref(x, w1, w2):
        h = torch.einsum("bsd,df->bsf", x, w1)
        zero = torch.zeros_like(h)
        h = torch.maximum(h, zero)
        return torch.einsum("bsf,fd->bsd", h, w2)

    x = A_x
    xn = _layernorm(x, axis=-1)
    return x + _A_ref(xn, A_wqkv, A_wo) + _B_ref(xn, B_w1, B_w2)
```

```asm
; @launch grid=(256,1,1) block=(512,1,1) lds=163840
.amdgcn_target "amdgcn-amd-amdhsa--gfx950"
.text
.globl parallel_sum__sliding_local_dilated__dense_activation_relu__prompt_kernel
.p2align 8
.type parallel_sum__sliding_local_dilated__dense_activation_relu__prompt_kernel,@function
parallel_sum__sliding_local_dilated__dense_activation_relu__prompt_kernel:
    s_cmp_ge_u32 s2, 256
    s_cbranch_scc1 L_end
    s_load_dwordx4 s[4:7], s[0:1], 0
    s_load_dwordx2 s[8:9], s[0:1], 16
    s_load_dwordx4 s[12:15], s[0:1], 40
    s_load_dwordx2 s[10:11], s[0:1], 32
    s_load_dwordx4 s[16:19], s[0:1], 56
    v_lshrrev_b32 v1, 6, v0
    v_and_b32 v2, 63, v0
    v_readfirstlane_b32 s20, v1
    v_and_b32 v3, 15, v0
    v_lshrrev_b32 v4, 4, v2
    s_and_b32 s21, s20, 3
    s_lshr_b32 s25, s20, 2
    s_lshr_b32 s85, s20, 1
    s_and_b32 s86, s20, 1
    s_and_b32 s60, s2, 7
    s_lshr_b32 s61, s2, 3
    s_and_b32 s23, s60, 1
    s_lshl_b32 s23, s23, 2
    s_and_b32 s62, s61, 3
    s_add_u32 s23, s23, s62
    s_lshr_b32 s74, s61, 2
    s_lshr_b32 s72, s60, 1
    s_lshl_b32 s24, s72, 3
    s_add_u32 s24, s24, s74
    s_lshl_b32 s75, s23, 3
    s_add_u32 s75, s75, s74
    s_lshl_b32 s75, s75, 2
    s_add_u32 s75, s75, s72
    s_mov_b32 s71, 0x3f803f80
    s_mov_b32 s84, 0xffff0000
    s_cmp_eq_u32 s25, 0
    s_cbranch_scc1 L_q_start
L_h_start:
    v_lshrrev_b32 v31, 3, v2
    v_and_b32 v32, 7, v2
    v_xor_b32 v33, v32, v31
    v_lshlrev_b32 v33, 4, v33
    s_lshl_b32 s60, s20, 5
    v_add_u32 v34, s60, v31
    v_lshl_add_u32 v24, v34, 11, v33
    v_add_u32 v25, 0x4000, v24
    v_add_u32 v26, 0x8000, v24
    v_add_u32 v27, 0xc000, v24
    s_lshl_b32 s50, s23, 19
    s_lshl_b32 s52, s20, 12
    v_lshrrev_b32 v33, 2, v31
    v_and_b32 v34, 3, v31
    v_lshl_add_u32 v33, v33, 3, v34
    v_and_b32 v34, 6, v31
    v_xor_b32 v34, v34, v32
    v_lshlrev_b32 v34, 4, v34
    s_mov_b32 s62, 7168
    s_and_b32 s60, s21, 1
    s_lshl_b32 s61, s60, 2
    v_add_u32 v33, s61, v33
    v_mul_lo_u32 v33, v33, s62
    v_add_u32 v33, v33, v34
    s_lshr_b32 s61, s21, 1
    s_lshl_b32 s63, s61, 7
    v_add_u32 v28, s63, v33
    v_add_u32 v29, 0x1c000, v28
    s_mul_i32 s51, s24, 224
    s_mul_i32 s53, s60, 7168
    s_lshl_b32 s61, s61, 11
    s_add_u32 s53, s53, s61
    s_add_u32 s53, s53, 0x1a400
    s_add_u32 s56, s53, 1024
    v_and_b32 v35, 1, v31
    s_lshl_b32 s60, s20, 1
    v_add_u32 v33, s60, v35
    v_and_b32 v34, 7, v33
    v_xor_b32 v34, v34, v32
    v_lshlrev_b32 v34, 4, v34
    v_lshl_add_u32 v30, v33, 11, v34
    s_lshl_b32 s55, s23, 8
    s_sub_i32 s55, s55, 16
    s_max_i32 s55, s55, 0
    s_mov_b32 s77, s55
    s_lshl_b32 s55, s55, 11
    s_lshl_b32 s57, s20, 8
    s_add_u32 s57, s57, 0x8000
    s_lshl_b32 s60, s2, 2
    s_add_u32 s60, s60, s21
    s_lshl_b32 s91, s60, 13
    s_mul_i32 s89, s60, 2341
    s_lshr_b32 s89, s89, 16
    s_sub_i32 s89, s89, 8
    s_max_i32 s89, s89, 0
    s_and_b32 s90, s60, 15
    s_min_u32 s90, s90, 15
    s_add_u32 s90, s90, 8
    v_lshlrev_b32 v253, 7, v2
    s_waitcnt lgkmcnt(0)
    s_mov_b32 s32, s4
    s_mov_b32 s33, s5
    s_mov_b32 s34, 0x400000
    s_mov_b32 s35, 0x20000
    s_mov_b32 s36, s10
    s_mov_b32 s37, s11
    s_mov_b32 s38, 0x700000
    s_mov_b32 s39, 0x20000
    s_add_u32 m0, s52, 0x0
    s_nop 0
    buffer_load_dwordx4 v24, s[32:35], s50 offen lds
    s_add_u32 m0, s52, 0x400
    s_nop 0
    buffer_load_dwordx4 v25, s[32:35], s50 offen lds
    s_add_u32 m0, s57, 0x0
    s_mov_b64 exec, 0xffff
    buffer_load_dwordx4 v30, s[32:35], s55 offen lds
    s_mov_b64 exec, -1
    s_add_u32 m0, s53, 0x0
    s_nop 0
    buffer_load_dwordx4 v28, s[36:39], s51 offen lds
    s_add_u32 m0, s56, 0x0
    s_nop 0
    buffer_load_dwordx4 v29, s[36:39], s51 offen lds
    s_add_u32 s51, s51, 0x38000
    s_add_u32 m0, s52, 0x800
    s_nop 0
    buffer_load_dwordx4 v26, s[32:35], s50 offen lds
    s_add_u32 m0, s52, 0xc00
    s_nop 0
    buffer_load_dwordx4 v27, s[32:35], s50 offen lds
    s_add_u32 s50, s50, 128
    s_add_u32 s55, s55, 128
    s_add_u32 m0, s53, 0x3800
    s_nop 0
    buffer_load_dwordx4 v28, s[36:39], s51 offen lds
    s_add_u32 m0, s56, 0x3800
    s_nop 0
    buffer_load_dwordx4 v29, s[36:39], s51 offen lds
    s_add_u32 s51, s51, 0x38000
    s_mov_b32 s28, s18
    s_mov_b32 s29, s19
    s_mov_b32 s30, 0x4000000
    s_mov_b32 s31, 0x20000
    s_mov_b32 s40, s16
    s_mov_b32 s41, s17
    s_mov_b32 s42, 0x100
    s_mov_b32 s43, 0x20000
    s_mov_b32 s44, s14
    s_mov_b32 s45, s15
    s_mov_b32 s46, 0x400000
    s_mov_b32 s47, 0x20000
    v_and_b32 v31, 7, v3
    v_xor_b32 v31, v31, v4
    v_lshlrev_b32 v31, 4, v31
    v_lshl_add_u32 v31, v3, 7, v31
    s_lshl_b32 s60, s21, 13
    v_add_u32 v16, s60, v31
    v_xor_b32 v17, 64, v16
    v_lshrrev_b32 v31, 2, v3
    v_lshl_add_u32 v31, v4, 2, v31
    v_and_b32 v32, 6, v31
    v_and_b32 v33, 3, v3
    v_lshlrev_b32 v33, 3, v33
    v_lshl_add_u32 v33, v31, 7, v33
    v_add_u32 v33, 0x1a400, v33
    s_lshl_b32 s63, s21, 1
    s_add_u32 s60, s63, 0
    s_sub_u32 s61, s60, 7
    s_cmp_ge_u32 s60, 7
    s_cselect_b32 s64, s61, s60
    s_and_b32 s60, s64, 3
    s_lshl_b32 s60, s60, 1
    v_xor_b32 v34, s60, v32
    v_lshl_add_u32 v34, v34, 4, v33
    s_lshr_b32 s61, s64, 2
    s_lshl_b32 s61, s61, 11
    v_add_u32 v8, s61, v34
    s_add_u32 s60, s63, 1
    s_sub_u32 s61, s60, 7
    s_cmp_ge_u32 s60, 7
    s_cselect_b32 s65, s61, s60
    s_and_b32 s60, s65, 3
    s_lshl_b32 s60, s60, 1
    v_xor_b32 v34, s60, v32
    v_lshl_add_u32 v34, v34, 4, v33
    s_lshr_b32 s61, s65, 2
    s_lshl_b32 s61, s61, 11
    v_add_u32 v9, s61, v34
    s_add_u32 s60, s63, 2
    s_sub_u32 s61, s60, 7
    s_cmp_ge_u32 s60, 7
    s_cselect_b32 s66, s61, s60
    s_and_b32 s60, s66, 3
    s_lshl_b32 s60, s60, 1
    v_xor_b32 v34, s60, v32
    v_lshl_add_u32 v34, v34, 4, v33
    s_lshr_b32 s61, s66, 2
    s_lshl_b32 s61, s61, 11
    v_add_u32 v10, s61, v34
    s_add_u32 s60, s63, 3
    s_sub_u32 s61, s60, 7
    s_cmp_ge_u32 s60, 7
    s_cselect_b32 s67, s61, s60
    s_and_b32 s60, s67, 3
    s_lshl_b32 s60, s60, 1
    v_xor_b32 v34, s60, v32
    v_lshl_add_u32 v34, v34, 4, v33
    s_lshr_b32 s61, s67, 2
    s_lshl_b32 s61, s61, 11
    v_add_u32 v11, s61, v34
    s_add_u32 s60, s63, 4
    s_sub_u32 s61, s60, 7
    s_cmp_ge_u32 s60, 7
    s_cselect_b32 s68, s61, s60
    s_and_b32 s60, s68, 3
    s_lshl_b32 s60, s60, 1
    v_xor_b32 v34, s60, v32
    v_lshl_add_u32 v34, v34, 4, v33
    s_lshr_b32 s61, s68, 2
    s_lshl_b32 s61, s61, 11
    v_add_u32 v12, s61, v34
    s_add_u32 s60, s63, 5
    s_sub_u32 s61, s60, 7
    s_cmp_ge_u32 s60, 7
    s_cselect_b32 s69, s61, s60
    s_and_b32 s60, s69, 3
    s_lshl_b32 s60, s60, 1
    v_xor_b32 v34, s60, v32
    v_lshl_add_u32 v34, v34, 4, v33
    s_lshr_b32 s61, s69, 2
    s_lshl_b32 s61, s61, 11
    v_add_u32 v13, s61, v34
    s_add_u32 s60, s63, 6
    s_sub_u32 s61, s60, 7
    s_cmp_ge_u32 s60, 7
    s_cselect_b32 s70, s61, s60
    s_and_b32 s60, s70, 3
    s_lshl_b32 s60, s60, 1
    v_xor_b32 v34, s60, v32
    v_lshl_add_u32 v34, v34, 4, v33
    s_lshr_b32 s61, s70, 2
    s_lshl_b32 s61, s61, 11
    v_add_u32 v14, s61, v34
    v_mov_b32 v128, 0
    v_mov_b32 v129, 0
    v_mov_b32 v130, 0
    v_mov_b32 v131, 0
    v_mov_b32 v132, 0
    v_mov_b32 v133, 0
    v_mov_b32 v134, 0
    v_mov_b32 v135, 0
    v_mov_b32 v136, 0
    v_mov_b32 v137, 0
    v_mov_b32 v138, 0
    v_mov_b32 v139, 0
    v_mov_b32 v140, 0
    v_mov_b32 v141, 0
    v_mov_b32 v142, 0
    v_mov_b32 v143, 0
    v_mov_b32 v144, 0
    v_mov_b32 v145, 0
    v_mov_b32 v146, 0
    v_mov_b32 v147, 0
    v_mov_b32 v148, 0
    v_mov_b32 v149, 0
    v_mov_b32 v150, 0
    v_mov_b32 v151, 0
    v_mov_b32 v152, 0
    v_mov_b32 v153, 0
    v_mov_b32 v154, 0
    v_mov_b32 v155, 0
    v_mov_b32 v156, 0
    v_mov_b32 v157, 0
    v_mov_b32 v158, 0
    v_mov_b32 v159, 0
    v_mov_b32 v160, 0
    v_mov_b32 v161, 0
    v_mov_b32 v162, 0
    v_mov_b32 v163, 0
    v_mov_b32 v164, 0
    v_mov_b32 v165, 0
    v_mov_b32 v166, 0
    v_mov_b32 v167, 0
    v_mov_b32 v168, 0
    v_mov_b32 v169, 0
    v_mov_b32 v170, 0
    v_mov_b32 v171, 0
    v_mov_b32 v172, 0
    v_mov_b32 v173, 0
    v_mov_b32 v174, 0
    v_mov_b32 v175, 0
    v_mov_b32 v176, 0
    v_mov_b32 v177, 0
    v_mov_b32 v178, 0
    v_mov_b32 v179, 0
    v_mov_b32 v180, 0
    v_mov_b32 v181, 0
    v_mov_b32 v182, 0
    v_mov_b32 v183, 0
    v_mov_b32 v184, 0
    v_mov_b32 v185, 0
    v_mov_b32 v186, 0
    v_mov_b32 v187, 0
    v_mov_b32 v188, 0
    v_mov_b32 v189, 0
    v_mov_b32 v190, 0
    v_mov_b32 v191, 0
    v_mov_b32 v192, 0
    v_mov_b32 v193, 0
    v_mov_b32 v194, 0
    v_mov_b32 v195, 0
    v_mov_b32 v196, 0
    v_mov_b32 v197, 0
    v_mov_b32 v198, 0
    v_mov_b32 v199, 0
    v_mov_b32 v200, 0
    v_mov_b32 v201, 0
    v_mov_b32 v202, 0
    v_mov_b32 v203, 0
    v_mov_b32 v204, 0
    v_mov_b32 v205, 0
    v_mov_b32 v206, 0
    v_mov_b32 v207, 0
    v_mov_b32 v208, 0
    v_mov_b32 v209, 0
    v_mov_b32 v210, 0
    v_mov_b32 v211, 0
    v_mov_b32 v212, 0
    v_mov_b32 v213, 0
    v_mov_b32 v214, 0
    v_mov_b32 v215, 0
    v_mov_b32 v216, 0
    v_mov_b32 v217, 0
    v_mov_b32 v218, 0
    v_mov_b32 v219, 0
    v_mov_b32 v220, 0
    v_mov_b32 v221, 0
    v_mov_b32 v222, 0
    v_mov_b32 v223, 0
    v_mov_b32 v224, 0
    v_mov_b32 v225, 0
    v_mov_b32 v226, 0
    v_mov_b32 v227, 0
    v_mov_b32 v228, 0
    v_mov_b32 v229, 0
    v_mov_b32 v230, 0
    v_mov_b32 v231, 0
    v_mov_b32 v232, 0
    v_mov_b32 v233, 0
    v_mov_b32 v234, 0
    v_mov_b32 v235, 0
    v_mov_b32 v236, 0
    v_mov_b32 v237, 0
    v_mov_b32 v238, 0
    v_mov_b32 v239, 0
    v_mov_b32 v244, 0
    v_mov_b32 v245, 0
    v_mov_b32 v246, 0
    v_mov_b32 v247, 0
    v_mov_b32 v248, 0
    v_mov_b32 v249, 0
    v_mov_b32 v250, 0
    v_mov_b32 v251, 0
    v_mov_b32 v240, s71
    v_mov_b32 v241, s71
    v_mov_b32 v242, s71
    v_mov_b32 v243, s71
    s_waitcnt vmcnt(2)
    s_barrier
    ds_read_b128 v[40:43], v16 offset:0
    ds_read_b128 v[44:47], v16 offset:2048
    ds_read_b128 v[48:51], v16 offset:4096
    ds_read_b128 v[52:55], v16 offset:6144
    ds_read_b64_tr_b16 v[56:57], v8 offset:0
    ds_read_b64_tr_b16 v[58:59], v8 offset:7168
    ds_read_b64_tr_b16 v[60:61], v9 offset:0
    ds_read_b64_tr_b16 v[62:63], v9 offset:7168
    ds_read_b64_tr_b16 v[64:65], v10 offset:0
    ds_read_b64_tr_b16 v[66:67], v10 offset:7168
    ds_read_b64_tr_b16 v[68:69], v11 offset:0
    ds_read_b64_tr_b16 v[70:71], v11 offset:7168
    ds_read_b64_tr_b16 v[72:73], v12 offset:0
    ds_read_b64_tr_b16 v[74:75], v12 offset:7168
    ds_read_b64_tr_b16 v[76:77], v13 offset:0
    ds_read_b64_tr_b16 v[78:79], v13 offset:7168
    ds_read_b64_tr_b16 v[80:81], v14 offset:0
    ds_read_b64_tr_b16 v[82:83], v14 offset:7168
    s_add_u32 m0, s52, 0x8800
    s_nop 0
    buffer_load_dwordx4 v24, s[32:35], s50 offen lds
    s_add_u32 m0, s52, 0x8c00
    s_nop 0
    buffer_load_dwordx4 v25, s[32:35], s50 offen lds
    s_add_u32 m0, s57, 0x8800
    s_mov_b64 exec, 0xffff
    buffer_load_dwordx4 v30, s[32:35], s55 offen lds
    s_mov_b64 exec, -1
    s_add_u32 m0, s53, 0x7000
    s_nop 0
    buffer_load_dwordx4 v28, s[36:39], s51 offen lds
    s_add_u32 m0, s56, 0x7000
    s_nop 0
    buffer_load_dwordx4 v29, s[36:39], s51 offen lds
    s_add_u32 s51, s51, 0x38000
    s_add_u32 m0, s52, 0x9000
    s_nop 0
    buffer_load_dwordx4 v26, s[32:35], s50 offen lds
    s_add_u32 m0, s52, 0x9400
    s_nop 0
    buffer_load_dwordx4 v27, s[32:35], s50 offen lds
    s_add_u32 s50, s50, 128
    s_add_u32 s55, s55, 128
    v_mov_b32 v19, v17
    s_mov_b32 s48, 0
    s_add_u32 s49, s52, 0x11000
    s_mov_b32 s58, 0x11000
    s_waitcnt vmcnt(7) lgkmcnt(0)
    s_mov_b32 s54, 0
    s_mov_b32 s88, 0
    s_barrier
    v_mfma_f32_16x16x32_bf16 v[128:131], v[56:59], v[40:43], v[128:131]
    s_cmp_lg_u32 s88, s89
    s_cbranch_scc1 L_h_0pfa
    buffer_load_dword v252, v253, s[36:39], s91 offen

L_h_0pfa:
    s_add_u32 s88, s88, 1
    v_mfma_f32_16x16x32_bf16 v[132:135], v[56:59], v[44:47], v[132:135]
    s_add_u32 m0, s53, 0xa800
    ds_read_b128 v[84:87], v19 offset:0
    v_mfma_f32_16x16x32_bf16 v[136:139], v[56:59], v[48:51], v[136:139]
    buffer_load_dwordx4 v28, s[36:39], s51 offen lds
    v_mfma_f32_16x16x32_bf16 v[140:143], v[56:59], v[52:55], v[140:143]
    ds_read_b128 v[88:91], v19 offset:2048
    s_add_u32 m0, s56, 0xa800
    v_mfma_f32_16x16x32_bf16 v[144:147], v[60:63], v[40:43], v[144:147]
    ds_read_b128 v[92:95], v19 offset:4096
    v_mfma_f32_16x16x32_bf16 v[148:151], v[60:63], v[44:47], v[148:151]
    buffer_load_dwordx4 v29, s[36:39], s51 offen lds
    s_add_u32 s51, s51, 0x38000
    v_mfma_f32_16x16x32_bf16 v[152:155], v[60:63], v[48:51], v[152:155]
    ds_read_b128 v[96:99], v19 offset:6144
    v_mfma_f32_16x16x32_bf16 v[156:159], v[60:63], v[52:55], v[156:159]
    s_add_u32 m0, s52, 0x11000
    ds_read_b64_tr_b16 v[100:101], v8 offset:14336
    v_mfma_f32_16x16x32_bf16 v[244:247], v[56:59], v[240:243], v[244:247]
    buffer_load_dwordx4 v24, s[32:35], s50 offen lds
    v_mfma_f32_16x16x32_bf16 v[160:163], v[64:67], v[40:43], v[160:163]
    ds_read_b64_tr_b16 v[102:103], v8 offset:21504
    s_add_u32 m0, s52, 0x11400
    v_mfma_f32_16x16x32_bf16 v[164:167], v[64:67], v[44:47], v[164:167]
    ds_read_b64_tr_b16 v[104:105], v9 offset:14336
    buffer_load_dwordx4 v25, s[32:35], s50 offen lds
    v_mfma_f32_16x16x32_bf16 v[168:171], v[64:67], v[48:51], v[168:171]
    ds_read_b64_tr_b16 v[106:107], v9 offset:21504
    v_mfma_f32_16x16x32_bf16 v[172:175], v[64:67], v[52:55], v[172:175]
    s_add_u32 m0, s57, 0x11000
    ds_read_b64_tr_b16 v[108:109], v10 offset:14336
    v_mfma_f32_16x16x32_bf16 v[176:179], v[68:71], v[40:43], v[176:179]
    s_mov_b64 exec, 0xffff
    buffer_load_dwordx4 v30, s[32:35], s55 offen lds
    s_mov_b64 exec, -1
    v_mfma_f32_16x16x32_bf16 v[180:183], v[68:71], v[44:47], v[180:183]
    ds_read_b64_tr_b16 v[110:111], v10 offset:21504
    s_add_u32 m0, s53, 0x0
    v_mfma_f32_16x16x32_bf16 v[184:187], v[68:71], v[48:51], v[184:187]
    ds_read_b64_tr_b16 v[112:113], v11 offset:14336
    v_mfma_f32_16x16x32_bf16 v[188:191], v[68:71], v[52:55], v[188:191]
    buffer_load_dwordx4 v28, s[36:39], s51 offen lds
    ds_read_b64_tr_b16 v[114:115], v11 offset:21504
    v_mfma_f32_16x16x32_bf16 v[248:251], v[60:63], v[240:243], v[248:251]
    s_add_u32 m0, s56, 0x0
    v_mfma_f32_16x16x32_bf16 v[192:195], v[72:75], v[40:43], v[192:195]
    ds_read_b64_tr_b16 v[116:117], v12 offset:14336
    buffer_load_dwordx4 v29, s[36:39], s51 offen lds
    v_mfma_f32_16x16x32_bf16 v[196:199], v[72:75], v[44:47], v[196:199]
    s_add_u32 s51, s51, 0x38000
    ds_read_b64_tr_b16 v[118:119], v12 offset:21504
    v_mfma_f32_16x16x32_bf16 v[200:203], v[72:75], v[48:51], v[200:203]
    s_add_u32 m0, s49, 0x800
    v_mfma_f32_16x16x32_bf16 v[204:207], v[72:75], v[52:55], v[204:207]
    ds_read_b64_tr_b16 v[120:121], v13 offset:14336
    buffer_load_dwordx4 v26, s[32:35], s50 offen lds
    v_mfma_f32_16x16x32_bf16 v[208:211], v[76:79], v[40:43], v[208:211]
    ds_read_b64_tr_b16 v[122:123], v13 offset:21504
    v_mfma_f32_16x16x32_bf16 v[212:215], v[76:79], v[44:47], v[212:215]
    s_add_u32 m0, s49, 0xc00
    ds_read_b64_tr_b16 v[124:125], v14 offset:14336
    v_mfma_f32_16x16x32_bf16 v[216:219], v[76:79], v[48:51], v[216:219]
    buffer_load_dwordx4 v27, s[32:35], s50 offen lds
    v_mfma_f32_16x16x32_bf16 v[220:223], v[76:79], v[52:55], v[220:223]
    s_add_u32 s50, s50, 128
    s_add_u32 s55, s55, 128
    v_mfma_f32_16x16x32_bf16 v[224:227], v[80:83], v[40:43], v[224:227]
    ds_read_b64_tr_b16 v[126:127], v14 offset:21504
    v_mfma_f32_16x16x32_bf16 v[228:231], v[80:83], v[44:47], v[228:231]
    v_mfma_f32_16x16x32_bf16 v[232:235], v[80:83], v[48:51], v[232:235]
    v_mfma_f32_16x16x32_bf16 v[236:239], v[80:83], v[52:55], v[236:239]
    s_waitcnt vmcnt(9) lgkmcnt(0)
    s_barrier
    v_mfma_f32_16x16x32_bf16 v[128:131], v[100:103], v[84:87], v[128:131]
    s_cmp_lg_u32 s88, s89
    s_cbranch_scc1 L_h_1pfa
    buffer_load_dword v252, v253, s[36:39], s91 offen

L_h_1pfa:
    s_add_u32 s88, s88, 1
    v_mfma_f32_16x16x32_bf16 v[132:135], v[100:103], v[88:91], v[132:135]
    s_mov_b32 s58, s48
    v_mfma_f32_16x16x32_bf16 v[136:139], v[100:103], v[92:95], v[136:139]
    s_add_u32 s49, s48, s52
    s_add_u32 s48, s48, 0x8800
    v_mfma_f32_16x16x32_bf16 v[140:143], v[100:103], v[96:99], v[140:143]
    s_cmp_eq_u32 s48, 0x19800
    v_mfma_f32_16x16x32_bf16 v[144:147], v[104:107], v[84:87], v[144:147]
    s_cselect_b32 s48, 0, s48
    v_add_u32 v18, s48, v16
    v_mfma_f32_16x16x32_bf16 v[148:151], v[104:107], v[88:91], v[148:151]
    v_add_u32 v19, s48, v17
    v_mfma_f32_16x16x32_bf16 v[152:155], v[104:107], v[92:95], v[152:155]
    s_add_u32 m0, s53, 0x3800
    v_mfma_f32_16x16x32_bf16 v[156:159], v[104:107], v[96:99], v[156:159]
    ds_read_b128 v[40:43], v18 offset:0
    buffer_load_dwordx4 v28, s[36:39], s51 offen lds
    v_mfma_f32_16x16x32_bf16 v[244:247], v[100:103], v[240:243], v[244:247]
    ds_read_b128 v[44:47], v18 offset:2048
    v_mfma_f32_16x16x32_bf16 v[160:163], v[108:111], v[84:87], v[160:163]
    ds_read_b128 v[48:51], v18 offset:4096
    s_add_u32 m0, s56, 0x3800
    v_mfma_f32_16x16x32_bf16 v[164:167], v[108:111], v[88:91], v[164:167]
    ds_read_b128 v[52:55], v18 offset:6144
    v_mfma_f32_16x16x32_bf16 v[168:171], v[108:111], v[92:95], v[168:171]
    buffer_load_dwordx4 v29, s[36:39], s51 offen lds
    v_mfma_f32_16x16x32_bf16 v[172:175], v[108:111], v[96:99], v[172:175]
    s_add_u32 s51, s51, 0x38000
    ds_read_b64_tr_b16 v[56:57], v8 offset:28672
    v_mfma_f32_16x16x32_bf16 v[176:179], v[112:115], v[84:87], v[176:179]
    ds_read_b64_tr_b16 v[58:59], v8 offset:35840
    v_mfma_f32_16x16x32_bf16 v[180:183], v[112:115], v[88:91], v[180:183]
    s_add_u32 m0, s49, 0x0
    ds_read_b64_tr_b16 v[60:61], v9 offset:28672
    v_mfma_f32_16x16x32_bf16 v[184:187], v[112:115], v[92:95], v[184:187]
    buffer_load_dwordx4 v24, s[32:35], s50 offen lds
    v_mfma_f32_16x16x32_bf16 v[188:191], v[112:115], v[96:99], v[188:191]
    ds_read_b64_tr_b16 v[62:63], v9 offset:35840
    v_mfma_f32_16x16x32_bf16 v[248:251], v[104:107], v[240:243], v[248:251]
    ds_read_b64_tr_b16 v[64:65], v10 offset:28672
    s_add_u32 m0, s49, 0x400
    v_mfma_f32_16x16x32_bf16 v[192:195], v[116:119], v[84:87], v[192:195]
    ds_read_b64_tr_b16 v[66:67], v10 offset:35840
    v_mfma_f32_16x16x32_bf16 v[196:199], v[116:119], v[88:91], v[196:199]
    buffer_load_dwordx4 v25, s[32:35], s50 offen lds
    ds_read_b64_tr_b16 v[68:69], v11 offset:28672
    v_mfma_f32_16x16x32_bf16 v[200:203], v[116:119], v[92:95], v[200:203]
    ds_read_b64_tr_b16 v[70:71], v11 offset:35840
    v_mfma_f32_16x16x32_bf16 v[204:207], v[116:119], v[96:99], v[204:207]
    s_add_u32 m0, s57, s58
    v_mfma_f32_16x16x32_bf16 v[208:211], v[120:123], v[84:87], v[208:211]
    ds_read_b64_tr_b16 v[72:73], v12 offset:28672
    s_mov_b64 exec, 0xffff
    buffer_load_dwordx4 v30, s[32:35], s55 offen lds
    s_mov_b64 exec, -1
    v_mfma_f32_16x16x32_bf16 v[212:215], v[120:123], v[88:91], v[212:215]
    ds_read_b64_tr_b16 v[74:75], v12 offset:35840
    v_mfma_f32_16x16x32_bf16 v[216:219], v[120:123], v[92:95], v[216:219]
    ds_read_b64_tr_b16 v[76:77], v13 offset:28672
    ds_read_b64_tr_b16 v[78:79], v13 offset:35840
    v_mfma_f32_16x16x32_bf16 v[220:223], v[120:123], v[96:99], v[220:223]
    ds_read_b64_tr_b16 v[80:81], v14 offset:28672
    v_mfma_f32_16x16x32_bf16 v[224:227], v[124:127], v[84:87], v[224:227]
    ds_read_b64_tr_b16 v[82:83], v14 offset:35840
    v_mfma_f32_16x16x32_bf16 v[228:231], v[124:127], v[88:91], v[228:231]
    v_mfma_f32_16x16x32_bf16 v[232:235], v[124:127], v[92:95], v[232:235]
    v_mfma_f32_16x16x32_bf16 v[236:239], v[124:127], v[96:99], v[236:239]
    s_waitcnt vmcnt(12) lgkmcnt(0)
    s_barrier
    v_mfma_f32_16x16x32_bf16 v[128:131], v[56:59], v[40:43], v[128:131]
    s_cmp_lg_u32 s88, s89
    s_cbranch_scc1 L_h_2pfa
    buffer_load_dword v252, v253, s[36:39], s91 offen

L_h_2pfa:
    s_add_u32 s88, s88, 1
    v_mfma_f32_16x16x32_bf16 v[132:135], v[56:59], v[44:47], v[132:135]
    s_add_u32 m0, s53, 0x7000
    v_mfma_f32_16x16x32_bf16 v[136:139], v[56:59], v[48:51], v[136:139]
    ds_read_b128 v[84:87], v19 offset:0
    v_mfma_f32_16x16x32_bf16 v[140:143], v[56:59], v[52:55], v[140:143]
    buffer_load_dwordx4 v28, s[36:39], s51 offen lds
    v_mfma_f32_16x16x32_bf16 v[144:147], v[60:63], v[40:43], v[144:147]
    ds_read_b128 v[88:91], v19 offset:2048
    v_mfma_f32_16x16x32_bf16 v[148:151], v[60:63], v[44:47], v[148:151]
    ds_read_b128 v[92:95], v19 offset:4096
    v_mfma_f32_16x16x32_bf16 v[152:155], v[60:63], v[48:51], v[152:155]
    ds_read_b128 v[96:99], v19 offset:6144
    s_add_u32 m0, s56, 0x7000
    v_mfma_f32_16x16x32_bf16 v[156:159], v[60:63], v[52:55], v[156:159]
    ds_read_b64_tr_b16 v[100:101], v8 offset:43008
    v_mfma_f32_16x16x32_bf16 v[244:247], v[56:59], v[240:243], v[244:247]
    buffer_load_dwordx4 v29, s[36:39], s51 offen lds
    v_mfma_f32_16x16x32_bf16 v[160:163], v[64:67], v[40:43], v[160:163]
    s_add_u32 s51, s51, 0x38000
    v_mfma_f32_16x16x32_bf16 v[164:167], v[64:67], v[44:47], v[164:167]
    ds_read_b64_tr_b16 v[102:103], v8 offset:50176
    v_mfma_f32_16x16x32_bf16 v[168:171], v[64:67], v[48:51], v[168:171]
    ds_read_b64_tr_b16 v[104:105], v9 offset:43008
    v_mfma_f32_16x16x32_bf16 v[172:175], v[64:67], v[52:55], v[172:175]
    ds_read_b64_tr_b16 v[106:107], v9 offset:50176
    v_mfma_f32_16x16x32_bf16 v[176:179], v[68:71], v[40:43], v[176:179]
    s_add_u32 m0, s49, 0x800
    ds_read_b64_tr_b16 v[108:109], v10 offset:43008
    v_mfma_f32_16x16x32_bf16 v[180:183], v[68:71], v[44:47], v[180:183]
    buffer_load_dwordx4 v26, s[32:35], s50 offen lds
    v_mfma_f32_16x16x32_bf16 v[184:187], v[68:71], v[48:51], v[184:187]
    ds_read_b64_tr_b16 v[110:111], v10 offset:50176
    v_mfma_f32_16x16x32_bf16 v[188:191], v[68:71], v[52:55], v[188:191]
    ds_read_b64_tr_b16 v[112:113], v11 offset:43008
    v_mfma_f32_16x16x32_bf16 v[248:251], v[60:63], v[240:243], v[248:251]
    ds_read_b64_tr_b16 v[114:115], v11 offset:50176
    v_mfma_f32_16x16x32_bf16 v[192:195], v[72:75], v[40:43], v[192:195]
    s_add_u32 m0, s49, 0xc00
    v_mfma_f32_16x16x32_bf16 v[196:199], v[72:75], v[44:47], v[196:199]
    ds_read_b64_tr_b16 v[116:117], v12 offset:43008
    v_mfma_f32_16x16x32_bf16 v[200:203], v[72:75], v[48:51], v[200:203]
    buffer_load_dwordx4 v27, s[32:35], s50 offen lds
    s_add_u32 s50, s50, 128
    v_mfma_f32_16x16x32_bf16 v[204:207], v[72:75], v[52:55], v[204:207]
    s_add_u32 s55, s55, 128
    v_mfma_f32_16x16x32_bf16 v[208:211], v[76:79], v[40:43], v[208:211]
    ds_read_b64_tr_b16 v[118:119], v12 offset:50176
    v_mfma_f32_16x16x32_bf16 v[212:215], v[76:79], v[44:47], v[212:215]
    ds_read_b64_tr_b16 v[120:121], v13 offset:43008
    v_mfma_f32_16x16x32_bf16 v[216:219], v[76:79], v[48:51], v[216:219]
    ds_read_b64_tr_b16 v[122:123], v13 offset:50176
    v_mfma_f32_16x16x32_bf16 v[220:223], v[76:79], v[52:55], v[220:223]
    ds_read_b64_tr_b16 v[124:125], v14 offset:43008
    v_mfma_f32_16x16x32_bf16 v[224:227], v[80:83], v[40:43], v[224:227]
    ds_read_b64_tr_b16 v[126:127], v14 offset:50176
    v_mfma_f32_16x16x32_bf16 v[228:231], v[80:83], v[44:47], v[228:231]
    v_mfma_f32_16x16x32_bf16 v[232:235], v[80:83], v[48:51], v[232:235]
    v_mfma_f32_16x16x32_bf16 v[236:239], v[80:83], v[52:55], v[236:239]
    s_waitcnt vmcnt(9) lgkmcnt(0)
    s_barrier
    v_mfma_f32_16x16x32_bf16 v[128:131], v[100:103], v[84:87], v[128:131]
    s_cmp_lg_u32 s88, s89
    s_cbranch_scc1 L_h_3pfa
    buffer_load_dword v252, v253, s[36:39], s91 offen

L_h_3pfa:
    s_add_u32 s88, s88, 1
    v_mfma_f32_16x16x32_bf16 v[132:135], v[100:103], v[88:91], v[132:135]
    s_mov_b32 s58, s48
    v_mfma_f32_16x16x32_bf16 v[136:139], v[100:103], v[92:95], v[136:139]
    s_add_u32 s49, s48, s52
    s_add_u32 s48, s48, 0x8800
    v_mfma_f32_16x16x32_bf16 v[140:143], v[100:103], v[96:99], v[140:143]
    s_cmp_eq_u32 s48, 0x19800
    v_mfma_f32_16x16x32_bf16 v[144:147], v[104:107], v[84:87], v[144:147]
    s_cselect_b32 s48, 0, s48
    v_add_u32 v18, s48, v16
    v_mfma_f32_16x16x32_bf16 v[148:151], v[104:107], v[88:91], v[148:151]
    v_add_u32 v19, s48, v17
    v_mfma_f32_16x16x32_bf16 v[152:155], v[104:107], v[92:95], v[152:155]
    s_add_u32 m0, s53, 0xa800
    v_mfma_f32_16x16x32_bf16 v[156:159], v[104:107], v[96:99], v[156:159]
    ds_read_b128 v[40:43], v18 offset:0
    buffer_load_dwordx4 v28, s[36:39], s51 offen lds
    v_mfma_f32_16x16x32_bf16 v[244:247], v[100:103], v[240:243], v[244:247]
    ds_read_b128 v[44:47], v18 offset:2048
    v_mfma_f32_16x16x32_bf16 v[160:163], v[108:111], v[84:87], v[160:163]
    ds_read_b128 v[48:51], v18 offset:4096
    s_add_u32 m0, s56, 0xa800
    v_mfma_f32_16x16x32_bf16 v[164:167], v[108:111], v[88:91], v[164:167]
    ds_read_b128 v[52:55], v18 offset:6144
    v_mfma_f32_16x16x32_bf16 v[168:171], v[108:111], v[92:95], v[168:171]
    buffer_load_dwordx4 v29, s[36:39], s51 offen lds
    v_mfma_f32_16x16x32_bf16 v[172:175], v[108:111], v[96:99], v[172:175]
    s_add_u32 s51, s51, 0x38000
    ds_read_b64_tr_b16 v[56:57], v8 offset:0
    v_mfma_f32_16x16x32_bf16 v[176:179], v[112:115], v[84:87], v[176:179]
    ds_read_b64_tr_b16 v[58:59], v8 offset:7168
    v_mfma_f32_16x16x32_bf16 v[180:183], v[112:115], v[88:91], v[180:183]
    s_add_u32 m0, s49, 0x0
    ds_read_b64_tr_b16 v[60:61], v9 offset:0
    v_mfma_f32_16x16x32_bf16 v[184:187], v[112:115], v[92:95], v[184:187]
    buffer_load_dwordx4 v24, s[32:35], s50 offen lds
    v_mfma_f32_16x16x32_bf16 v[188:191], v[112:115], v[96:99], v[188:191]
    ds_read_b64_tr_b16 v[62:63], v9 offset:7168
    v_mfma_f32_16x16x32_bf16 v[248:251], v[104:107], v[240:243], v[248:251]
    ds_read_b64_tr_b16 v[64:65], v10 offset:0
    s_add_u32 m0, s49, 0x400
    v_mfma_f32_16x16x32_bf16 v[192:195], v[116:119], v[84:87], v[192:195]
    ds_read_b64_tr_b16 v[66:67], v10 offset:7168
    v_mfma_f32_16x16x32_bf16 v[196:199], v[116:119], v[88:91], v[196:199]
    buffer_load_dwordx4 v25, s[32:35], s50 offen lds
    ds_read_b64_tr_b16 v[68:69], v11 offset:0
    v_mfma_f32_16x16x32_bf16 v[200:203], v[116:119], v[92:95], v[200:203]
    ds_read_b64_tr_b16 v[70:71], v11 offset:7168
    v_mfma_f32_16x16x32_bf16 v[204:207], v[116:119], v[96:99], v[204:207]
    s_add_u32 m0, s57, s58
    v_mfma_f32_16x16x32_bf16 v[208:211], v[120:123], v[84:87], v[208:211]
    ds_read_b64_tr_b16 v[72:73], v12 offset:0
    s_mov_b64 exec, 0xffff
    buffer_load_dwordx4 v30, s[32:35], s55 offen lds
    s_mov_b64 exec, -1
    v_mfma_f32_16x16x32_bf16 v[212:215], v[120:123], v[88:91], v[212:215]
    ds_read_b64_tr_b16 v[74:75], v12 offset:7168
    v_mfma_f32_16x16x32_bf16 v[216:219], v[120:123], v[92:95], v[216:219]
    ds_read_b64_tr_b16 v[76:77], v13 offset:0
    ds_read_b64_tr_b16 v[78:79], v13 offset:7168
    v_mfma_f32_16x16x32_bf16 v[220:223], v[120:123], v[96:99], v[220:223]
    ds_read_b64_tr_b16 v[80:81], v14 offset:0
    v_mfma_f32_16x16x32_bf16 v[224:227], v[124:127], v[84:87], v[224:227]
    ds_read_b64_tr_b16 v[82:83], v14 offset:7168
    v_mfma_f32_16x16x32_bf16 v[228:231], v[124:127], v[88:91], v[228:231]
    v_mfma_f32_16x16x32_bf16 v[232:235], v[124:127], v[92:95], v[232:235]
    v_mfma_f32_16x16x32_bf16 v[236:239], v[124:127], v[96:99], v[236:239]
    s_waitcnt vmcnt(12) lgkmcnt(0)
.p2align 6
L_h_loop:
    s_barrier
    v_mfma_f32_16x16x32_bf16 v[128:131], v[56:59], v[40:43], v[128:131]
    s_cmp_lg_u32 s88, s89
    s_cbranch_scc1 L_h_4pfa
    buffer_load_dword v252, v253, s[36:39], s91 offen

L_h_4pfa:
    s_cmp_lg_u32 s88, s90
    s_cbranch_scc1 L_h_4pfb
    s_lshl_b32 s60, s2, 3
    s_add_u32 s60, s60, s20
    s_lshl_b32 s60, s60, 13
    s_mov_b32 s80, s12
    s_mov_b32 s81, s13
    s_mov_b32 s82, 0x700000
    s_mov_b32 s83, 0x20000
    buffer_load_dword v252, v253, s[80:83], s60 offen
    s_sub_u32 s60, s60, 0x800000
    s_mov_b32 s80, s8
    s_mov_b32 s81, s9
    s_mov_b32 s82, 0x200000
    buffer_load_dword v252, v253, s[80:83], s60 offen
L_h_4pfb:
    v_mfma_f32_16x16x32_bf16 v[132:135], v[56:59], v[44:47], v[132:135]
    s_add_u32 s88, s88, 1
    v_mfma_f32_16x16x32_bf16 v[136:139], v[56:59], v[48:51], v[136:139]
    s_add_u32 m0, s53, 0x0
    v_mfma_f32_16x16x32_bf16 v[140:143], v[56:59], v[52:55], v[140:143]
    ds_read_b128 v[84:87], v19 offset:0
    v_mfma_f32_16x16x32_bf16 v[144:147], v[60:63], v[40:43], v[144:147]
    buffer_load_dwordx4 v28, s[36:39], s51 offen lds
    v_mfma_f32_16x16x32_bf16 v[148:151], v[60:63], v[44:47], v[148:151]
    ds_read_b128 v[88:91], v19 offset:2048
    ds_read_b128 v[92:95], v19 offset:4096
    v_mfma_f32_16x16x32_bf16 v[152:155], v[60:63], v[48:51], v[152:155]
    ds_read_b128 v[96:99], v19 offset:6144
    v_mfma_f32_16x16x32_bf16 v[156:159], v[60:63], v[52:55], v[156:159]
    s_add_u32 m0, s56, 0x0
    v_mfma_f32_16x16x32_bf16 v[244:247], v[56:59], v[240:243], v[244:247]
    ds_read_b64_tr_b16 v[100:101], v8 offset:14336
    v_mfma_f32_16x16x32_bf16 v[160:163], v[64:67], v[40:43], v[160:163]
    buffer_load_dwordx4 v29, s[36:39], s51 offen lds
    v_mfma_f32_16x16x32_bf16 v[164:167], v[64:67], v[44:47], v[164:167]
    s_add_u32 s51, s51, 0x38000
    ds_read_b64_tr_b16 v[102:103], v8 offset:21504
    v_mfma_f32_16x16x32_bf16 v[168:171], v[64:67], v[48:51], v[168:171]
    ds_read_b64_tr_b16 v[104:105], v9 offset:14336
    v_mfma_f32_16x16x32_bf16 v[172:175], v[64:67], v[52:55], v[172:175]
    ds_read_b64_tr_b16 v[106:107], v9 offset:21504
    v_mfma_f32_16x16x32_bf16 v[176:179], v[68:71], v[40:43], v[176:179]
    s_add_u32 m0, s49, 0x800
    v_mfma_f32_16x16x32_bf16 v[180:183], v[68:71], v[44:47], v[180:183]
    ds_read_b64_tr_b16 v[108:109], v10 offset:14336
    v_mfma_f32_16x16x32_bf16 v[184:187], v[68:71], v[48:51], v[184:187]
    buffer_load_dwordx4 v26, s[32:35], s50 offen lds
    v_mfma_f32_16x16x32_bf16 v[188:191], v[68:71], v[52:55], v[188:191]
    ds_read_b64_tr_b16 v[110:111], v10 offset:21504
    ds_read_b64_tr_b16 v[112:113], v11 offset:14336
    v_mfma_f32_16x16x32_bf16 v[248:251], v[60:63], v[240:243], v[248:251]
    ds_read_b64_tr_b16 v[114:115], v11 offset:21504
    v_mfma_f32_16x16x32_bf16 v[192:195], v[72:75], v[40:43], v[192:195]
    s_add_u32 m0, s49, 0xc00
    v_mfma_f32_16x16x32_bf16 v[196:199], v[72:75], v[44:47], v[196:199]
    ds_read_b64_tr_b16 v[116:117], v12 offset:14336
    v_mfma_f32_16x16x32_bf16 v[200:203], v[72:75], v[48:51], v[200:203]
    buffer_load_dwordx4 v27, s[32:35], s50 offen lds
    v_mfma_f32_16x16x32_bf16 v[204:207], v[72:75], v[52:55], v[204:207]
    s_add_u32 s50, s50, 128
    s_add_u32 s55, s55, 128
    v_mfma_f32_16x16x32_bf16 v[208:211], v[76:79], v[40:43], v[208:211]
    ds_read_b64_tr_b16 v[118:119], v12 offset:21504
    v_mfma_f32_16x16x32_bf16 v[212:215], v[76:79], v[44:47], v[212:215]
    ds_read_b64_tr_b16 v[120:121], v13 offset:14336
    v_mfma_f32_16x16x32_bf16 v[216:219], v[76:79], v[48:51], v[216:219]
    ds_read_b64_tr_b16 v[122:123], v13 offset:21504
    v_mfma_f32_16x16x32_bf16 v[220:223], v[76:79], v[52:55], v[220:223]
    ds_read_b64_tr_b16 v[124:125], v14 offset:14336
    v_mfma_f32_16x16x32_bf16 v[224:227], v[80:83], v[40:43], v[224:227]
    ds_read_b64_tr_b16 v[126:127], v14 offset:21504
    v_mfma_f32_16x16x32_bf16 v[228:231], v[80:83], v[44:47], v[228:231]
    v_mfma_f32_16x16x32_bf16 v[232:235], v[80:83], v[48:51], v[232:235]
    v_mfma_f32_16x16x32_bf16 v[236:239], v[80:83], v[52:55], v[236:239]
    s_waitcnt vmcnt(9) lgkmcnt(0)
    s_barrier
    v_mfma_f32_16x16x32_bf16 v[128:131], v[100:103], v[84:87], v[128:131]
    s_cmp_lg_u32 s88, s89
    s_cbranch_scc1 L_h_5pfa
    buffer_load_dword v252, v253, s[36:39], s91 offen

L_h_5pfa:
    s_cmp_lg_u32 s88, s90
    s_cbranch_scc1 L_h_5pfb
    s_lshl_b32 s60, s2, 3
    s_add_u32 s60, s60, s20
    s_lshl_b32 s60, s60, 13
    s_mov_b32 s80, s12
    s_mov_b32 s81, s13
    s_mov_b32 s82, 0x700000
    s_mov_b32 s83, 0x20000
    buffer_load_dword v252, v253, s[80:83], s60 offen
    s_sub_u32 s60, s60, 0x800000
    s_mov_b32 s80, s8
    s_mov_b32 s81, s9
    s_mov_b32 s82, 0x200000
    buffer_load_dword v252, v253, s[80:83], s60 offen
L_h_5pfb:
    v_mfma_f32_16x16x32_bf16 v[132:135], v[100:103], v[88:91], v[132:135]
    s_add_u32 s88, s88, 1
    v_mfma_f32_16x16x32_bf16 v[136:139], v[100:103], v[92:95], v[136:139]
    s_mov_b32 s58, s48
    s_add_u32 s49, s48, s52
    v_mfma_f32_16x16x32_bf16 v[140:143], v[100:103], v[96:99], v[140:143]
    s_add_u32 s48, s48, 0x8800
    v_mfma_f32_16x16x32_bf16 v[144:147], v[104:107], v[84:87], v[144:147]
    s_cmp_eq_u32 s48, 0x19800
    s_cselect_b32 s48, 0, s48
    v_mfma_f32_16x16x32_bf16 v[148:151], v[104:107], v[88:91], v[148:151]
    v_add_u32 v18, s48, v16
    v_mfma_f32_16x16x32_bf16 v[152:155], v[104:107], v[92:95], v[152:155]
    v_add_u32 v19, s48, v17
    s_add_u32 m0, s53, 0x3800
    v_mfma_f32_16x16x32_bf16 v[156:159], v[104:107], v[96:99], v[156:159]
    ds_read_b128 v[40:43], v18 offset:0
    v_mfma_f32_16x16x32_bf16 v[244:247], v[100:103], v[240:243], v[244:247]
    buffer_load_dwordx4 v28, s[36:39], s51 offen lds
    v_mfma_f32_16x16x32_bf16 v[160:163], v[108:111], v[84:87], v[160:163]
    ds_read_b128 v[44:47], v18 offset:2048
    ds_read_b128 v[48:51], v18 offset:4096
    v_mfma_f32_16x16x32_bf16 v[164:167], v[108:111], v[88:91], v[164:167]
    s_add_u32 m0, s56, 0x3800
    v_mfma_f32_16x16x32_bf16 v[168:171], v[108:111], v[92:95], v[168:171]
    ds_read_b128 v[52:55], v18 offset:6144
    buffer_load_dwordx4 v29, s[36:39], s51 offen lds
    v_mfma_f32_16x16x32_bf16 v[172:175], v[108:111], v[96:99], v[172:175]
    s_add_u32 s51, s51, 0x38000
    v_mfma_f32_16x16x32_bf16 v[176:179], v[112:115], v[84:87], v[176:179]
    ds_read_b64_tr_b16 v[56:57], v8 offset:28672
    ds_read_b64_tr_b16 v[58:59], v8 offset:35840
    v_mfma_f32_16x16x32_bf16 v[180:183], v[112:115], v[88:91], v[180:183]
    s_add_u32 m0, s49, 0x0
    v_mfma_f32_16x16x32_bf16 v[184:187], v[112:115], v[92:95], v[184:187]
    ds_read_b64_tr_b16 v[60:61], v9 offset:28672
    buffer_load_dwordx4 v24, s[32:35], s50 offen lds
    v_mfma_f32_16x16x32_bf16 v[188:191], v[112:115], v[96:99], v[188:191]
    ds_read_b64_tr_b16 v[62:63], v9 offset:35840
    v_mfma_f32_16x16x32_bf16 v[248:251], v[104:107], v[240:243], v[248:251]
    ds_read_b64_tr_b16 v[64:65], v10 offset:28672
    v_mfma_f32_16x16x32_bf16 v[192:195], v[116:119], v[84:87], v[192:195]
    s_add_u32 m0, s49, 0x400
    ds_read_b64_tr_b16 v[66:67], v10 offset:35840
    v_mfma_f32_16x16x32_bf16 v[196:199], v[116:119], v[88:91], v[196:199]
    buffer_load_dwordx4 v25, s[32:35], s50 offen lds
    v_mfma_f32_16x16x32_bf16 v[200:203], v[116:119], v[92:95], v[200:203]
    ds_read_b64_tr_b16 v[68:69], v11 offset:28672
    ds_read_b64_tr_b16 v[70:71], v11 offset:35840
    v_mfma_f32_16x16x32_bf16 v[204:207], v[116:119], v[96:99], v[204:207]
    s_add_u32 m0, s57, s58
    v_mfma_f32_16x16x32_bf16 v[208:211], v[120:123], v[84:87], v[208:211]
    ds_read_b64_tr_b16 v[72:73], v12 offset:28672
    s_mov_b64 exec, 0xffff
    buffer_load_dwordx4 v30, s[32:35], s55 offen lds
    s_mov_b64 exec, -1
    v_mfma_f32_16x16x32_bf16 v[212:215], v[120:123], v[88:91], v[212:215]
    ds_read_b64_tr_b16 v[74:75], v12 offset:35840
    v_mfma_f32_16x16x32_bf16 v[216:219], v[120:123], v[92:95], v[216:219]
    ds_read_b64_tr_b16 v[76:77], v13 offset:28672
    ds_read_b64_tr_b16 v[78:79], v13 offset:35840
    v_mfma_f32_16x16x32_bf16 v[220:223], v[120:123], v[96:99], v[220:223]
    ds_read_b64_tr_b16 v[80:81], v14 offset:28672
    v_mfma_f32_16x16x32_bf16 v[224:227], v[124:127], v[84:87], v[224:227]
    ds_read_b64_tr_b16 v[82:83], v14 offset:35840
    v_mfma_f32_16x16x32_bf16 v[228:231], v[124:127], v[88:91], v[228:231]
    v_mfma_f32_16x16x32_bf16 v[232:235], v[124:127], v[92:95], v[232:235]
    v_mfma_f32_16x16x32_bf16 v[236:239], v[124:127], v[96:99], v[236:239]
    s_waitcnt vmcnt(12) lgkmcnt(0)
    s_barrier
    v_mfma_f32_16x16x32_bf16 v[128:131], v[56:59], v[40:43], v[128:131]
    s_cmp_lg_u32 s88, s89
    s_cbranch_scc1 L_h_6pfa
    buffer_load_dword v252, v253, s[36:39], s91 offen

L_h_6pfa:
    s_cmp_lg_u32 s88, s90
    s_cbranch_scc1 L_h_6pfb
    s_lshl_b32 s60, s2, 3
    s_add_u32 s60, s60, s20
    s_lshl_b32 s60, s60, 13
    s_mov_b32 s80, s12
    s_mov_b32 s81, s13
    s_mov_b32 s82, 0x700000
    s_mov_b32 s83, 0x20000
    buffer_load_dword v252, v253, s[80:83], s60 offen
    s_sub_u32 s60, s60, 0x800000
    s_mov_b32 s80, s8
    s_mov_b32 s81, s9
    s_mov_b32 s82, 0x200000
    buffer_load_dword v252, v253, s[80:83], s60 offen
L_h_6pfb:
    v_mfma_f32_16x16x32_bf16 v[132:135], v[56:59], v[44:47], v[132:135]
    s_add_u32 s88, s88, 1
    v_mfma_f32_16x16x32_bf16 v[136:139], v[56:59], v[48:51], v[136:139]
    s_add_u32 m0, s53, 0x7000
    v_mfma_f32_16x16x32_bf16 v[140:143], v[56:59], v[52:55], v[140:143]
    ds_read_b128 v[84:87], v19 offset:0
    v_mfma_f32_16x16x32_bf16 v[144:147], v[60:63], v[40:43], v[144:147]
    buffer_load_dwordx4 v28, s[36:39], s51 offen lds
    v_mfma_f32_16x16x32_bf16 v[148:151], v[60:63], v[44:47], v[148:151]
    ds_read_b128 v[88:91], v19 offset:2048
    ds_read_b128 v[92:95], v19 offset:4096
    v_mfma_f32_16x16x32_bf16 v[152:155], v[60:63], v[48:51], v[152:155]
    ds_read_b128 v[96:99], v19 offset:6144
    v_mfma_f32_16x16x32_bf16 v[156:159], v[60:63], v[52:55], v[156:159]
    s_add_u32 m0, s56, 0x7000
    v_mfma_f32_16x16x32_bf16 v[244:247], v[56:59], v[240:243], v[244:247]
    ds_read_b64_tr_b16 v[100:101], v8 offset:43008
    v_mfma_f32_16x16x32_bf16 v[160:163], v[64:67], v[40:43], v[160:163]
    buffer_load_dwordx4 v29, s[36:39], s51 offen lds
    v_mfma_f32_16x16x32_bf16 v[164:167], v[64:67], v[44:47], v[164:167]
    s_add_u32 s51, s51, 0x38000
    ds_read_b64_tr_b16 v[102:103], v8 offset:50176
    v_mfma_f32_16x16x32_bf16 v[168:171], v[64:67], v[48:51], v[168:171]
    ds_read_b64_tr_b16 v[104:105], v9 offset:43008
    v_mfma_f32_16x16x32_bf16 v[172:175], v[64:67], v[52:55], v[172:175]
    ds_read_b64_tr_b16 v[106:107], v9 offset:50176
    v_mfma_f32_16x16x32_bf16 v[176:179], v[68:71], v[40:43], v[176:179]
    s_add_u32 m0, s49, 0x800
    v_mfma_f32_16x16x32_bf16 v[180:183], v[68:71], v[44:47], v[180:183]
    ds_read_b64_tr_b16 v[108:109], v10 offset:43008
    v_mfma_f32_16x16x32_bf16 v[184:187], v[68:71], v[48:51], v[184:187]
    buffer_load_dwordx4 v26, s[32:35], s50 offen lds
    v_mfma_f32_16x16x32_bf16 v[188:191], v[68:71], v[52:55], v[188:191]
    ds_read_b64_tr_b16 v[110:111], v10 offset:50176
    ds_read_b64_tr_b16 v[112:113], v11 offset:43008
    v_mfma_f32_16x16x32_bf16 v[248:251], v[60:63], v[240:243], v[248:251]
    ds_read_b64_tr_b16 v[114:115], v11 offset:50176
    v_mfma_f32_16x16x32_bf16 v[192:195], v[72:75], v[40:43], v[192:195]
    s_add_u32 m0, s49, 0xc00
    v_mfma_f32_16x16x32_bf16 v[196:199], v[72:75], v[44:47], v[196:199]
    ds_read_b64_tr_b16 v[116:117], v12 offset:43008
    v_mfma_f32_16x16x32_bf16 v[200:203], v[72:75], v[48:51], v[200:203]
    buffer_load_dwordx4 v27, s[32:35], s50 offen lds
    v_mfma_f32_16x16x32_bf16 v[204:207], v[72:75], v[52:55], v[204:207]
    s_add_u32 s50, s50, 128
    s_add_u32 s55, s55, 128
    v_mfma_f32_16x16x32_bf16 v[208:211], v[76:79], v[40:43], v[208:211]
    ds_read_b64_tr_b16 v[118:119], v12 offset:50176
    v_mfma_f32_16x16x32_bf16 v[212:215], v[76:79], v[44:47], v[212:215]
    ds_read_b64_tr_b16 v[120:121], v13 offset:43008
    v_mfma_f32_16x16x32_bf16 v[216:219], v[76:79], v[48:51], v[216:219]
    ds_read_b64_tr_b16 v[122:123], v13 offset:50176
    v_mfma_f32_16x16x32_bf16 v[220:223], v[76:79], v[52:55], v[220:223]
    ds_read_b64_tr_b16 v[124:125], v14 offset:43008
    v_mfma_f32_16x16x32_bf16 v[224:227], v[80:83], v[40:43], v[224:227]
    ds_read_b64_tr_b16 v[126:127], v14 offset:50176
    v_mfma_f32_16x16x32_bf16 v[228:231], v[80:83], v[44:47], v[228:231]
    v_mfma_f32_16x16x32_bf16 v[232:235], v[80:83], v[48:51], v[232:235]
    v_mfma_f32_16x16x32_bf16 v[236:239], v[80:83], v[52:55], v[236:239]
    s_waitcnt vmcnt(9) lgkmcnt(0)
    s_barrier
    v_mfma_f32_16x16x32_bf16 v[128:131], v[100:103], v[84:87], v[128:131]
    s_cmp_lg_u32 s88, s89
    s_cbranch_scc1 L_h_7pfa
    buffer_load_dword v252, v253, s[36:39], s91 offen

L_h_7pfa:
    s_cmp_lg_u32 s88, s90
    s_cbranch_scc1 L_h_7pfb
    s_lshl_b32 s60, s2, 3
    s_add_u32 s60, s60, s20
    s_lshl_b32 s60, s60, 13
    s_mov_b32 s80, s12
    s_mov_b32 s81, s13
    s_mov_b32 s82, 0x700000
    s_mov_b32 s83, 0x20000
    buffer_load_dword v252, v253, s[80:83], s60 offen
    s_sub_u32 s60, s60, 0x800000
    s_mov_b32 s80, s8
    s_mov_b32 s81, s9
    s_mov_b32 s82, 0x200000
    buffer_load_dword v252, v253, s[80:83], s60 offen
L_h_7pfb:
    v_mfma_f32_16x16x32_bf16 v[132:135], v[100:103], v[88:91], v[132:135]
    s_add_u32 s88, s88, 1
    v_mfma_f32_16x16x32_bf16 v[136:139], v[100:103], v[92:95], v[136:139]
    s_mov_b32 s58, s48
    s_add_u32 s49, s48, s52
    v_mfma_f32_16x16x32_bf16 v[140:143], v[100:103], v[96:99], v[140:143]
    s_add_u32 s48, s48, 0x8800
    v_mfma_f32_16x16x32_bf16 v[144:147], v[104:107], v[84:87], v[144:147]
    s_cmp_eq_u32 s48, 0x19800
    s_cselect_b32 s48, 0, s48
    v_mfma_f32_16x16x32_bf16 v[148:151], v[104:107], v[88:91], v[148:151]
    v_add_u32 v18, s48, v16
    v_mfma_f32_16x16x32_bf16 v[152:155], v[104:107], v[92:95], v[152:155]
    v_add_u32 v19, s48, v17
    s_add_u32 m0, s53, 0xa800
    v_mfma_f32_16x16x32_bf16 v[156:159], v[104:107], v[96:99], v[156:159]
    ds_read_b128 v[40:43], v18 offset:0
    v_mfma_f32_16x16x32_bf16 v[244:247], v[100:103], v[240:243], v[244:247]
    buffer_load_dwordx4 v28, s[36:39], s51 offen lds
    v_mfma_f32_16x16x32_bf16 v[160:163], v[108:111], v[84:87], v[160:163]
    ds_read_b128 v[44:47], v18 offset:2048
    ds_read_b128 v[48:51], v18 offset:4096
    v_mfma_f32_16x16x32_bf16 v[164:167], v[108:111], v[88:91], v[164:167]
    s_add_u32 m0, s56, 0xa800
    v_mfma_f32_16x16x32_bf16 v[168:171], v[108:111], v[92:95], v[168:171]
    ds_read_b128 v[52:55], v18 offset:6144
    buffer_load_dwordx4 v29, s[36:39], s51 offen lds
    v_mfma_f32_16x16x32_bf16 v[172:175], v[108:111], v[96:99], v[172:175]
    s_add_u32 s51, s51, 0x38000
    v_mfma_f32_16x16x32_bf16 v[176:179], v[112:115], v[84:87], v[176:179]
    ds_read_b64_tr_b16 v[56:57], v8 offset:0
    ds_read_b64_tr_b16 v[58:59], v8 offset:7168
    v_mfma_f32_16x16x32_bf16 v[180:183], v[112:115], v[88:91], v[180:183]
    s_add_u32 m0, s49, 0x0
    v_mfma_f32_16x16x32_bf16 v[184:187], v[112:115], v[92:95], v[184:187]
    ds_read_b64_tr_b16 v[60:61], v9 offset:0
    buffer_load_dwordx4 v24, s[32:35], s50 offen lds
    v_mfma_f32_16x16x32_bf16 v[188:191], v[112:115], v[96:99], v[188:191]
    ds_read_b64_tr_b16 v[62:63], v9 offset:7168
    v_mfma_f32_16x16x32_bf16 v[248:251], v[104:107], v[240:243], v[248:251]
    ds_read_b64_tr_b16 v[64:65], v10 offset:0
    v_mfma_f32_16x16x32_bf16 v[192:195], v[116:119], v[84:87], v[192:195]
    s_add_u32 m0, s49, 0x400
    ds_read_b64_tr_b16 v[66:67], v10 offset:7168
    v_mfma_f32_16x16x32_bf16 v[196:199], v[116:119], v[88:91], v[196:199]
    buffer_load_dwordx4 v25, s[32:35], s50 offen lds
    v_mfma_f32_16x16x32_bf16 v[200:203], v[116:119], v[92:95], v[200:203]
    ds_read_b64_tr_b16 v[68:69], v11 offset:0
    ds_read_b64_tr_b16 v[70:71], v11 offset:7168
    v_mfma_f32_16x16x32_bf16 v[204:207], v[116:119], v[96:99], v[204:207]
    s_add_u32 m0, s57, s58
    v_mfma_f32_16x16x32_bf16 v[208:211], v[120:123], v[84:87], v[208:211]
    ds_read_b64_tr_b16 v[72:73], v12 offset:0
    s_mov_b64 exec, 0xffff
    buffer_load_dwordx4 v30, s[32:35], s55 offen lds
    s_mov_b64 exec, -1
    v_mfma_f32_16x16x32_bf16 v[212:215], v[120:123], v[88:91], v[212:215]
    ds_read_b64_tr_b16 v[74:75], v12 offset:7168
    v_mfma_f32_16x16x32_bf16 v[216:219], v[120:123], v[92:95], v[216:219]
    ds_read_b64_tr_b16 v[76:77], v13 offset:0
    ds_read_b64_tr_b16 v[78:79], v13 offset:7168
    v_mfma_f32_16x16x32_bf16 v[220:223], v[120:123], v[96:99], v[220:223]
    ds_read_b64_tr_b16 v[80:81], v14 offset:0
    v_mfma_f32_16x16x32_bf16 v[224:227], v[124:127], v[84:87], v[224:227]
    ds_read_b64_tr_b16 v[82:83], v14 offset:7168
    v_mfma_f32_16x16x32_bf16 v[228:231], v[124:127], v[88:91], v[228:231]
    v_mfma_f32_16x16x32_bf16 v[232:235], v[124:127], v[92:95], v[232:235]
    v_mfma_f32_16x16x32_bf16 v[236:239], v[124:127], v[96:99], v[236:239]
    s_waitcnt vmcnt(12) lgkmcnt(0)
    s_add_u32 s54, s54, 1
    s_cmp_lt_u32 s54, 5
    s_cbranch_scc1 L_h_loop
    s_barrier
    v_mfma_f32_16x16x32_bf16 v[128:131], v[56:59], v[40:43], v[128:131]
    s_lshl_b32 s79, s23, 2
    buffer_load_dwordx2 v[252:253], off, s[40:43], s79 sc1
    s_add_u32 m0, s53, 0x0
    v_mfma_f32_16x16x32_bf16 v[132:135], v[56:59], v[44:47], v[132:135]
    ds_read_b128 v[84:87], v19 offset:0
    v_mfma_f32_16x16x32_bf16 v[136:139], v[56:59], v[48:51], v[136:139]
    buffer_load_dwordx4 v28, s[36:39], s51 offen lds
    v_mfma_f32_16x16x32_bf16 v[140:143], v[56:59], v[52:55], v[140:143]
    ds_read_b128 v[88:91], v19 offset:2048
    v_mfma_f32_16x16x32_bf16 v[144:147], v[60:63], v[40:43], v[144:147]
    ds_read_b128 v[92:95], v19 offset:4096
    v_mfma_f32_16x16x32_bf16 v[148:151], v[60:63], v[44:47], v[148:151]
    ds_read_b128 v[96:99], v19 offset:6144
    v_mfma_f32_16x16x32_bf16 v[152:155], v[60:63], v[48:51], v[152:155]
    s_add_u32 m0, s56, 0x0
    v_mfma_f32_16x16x32_bf16 v[156:159], v[60:63], v[52:55], v[156:159]
    ds_read_b64_tr_b16 v[100:101], v8 offset:14336
    v_mfma_f32_16x16x32_bf16 v[244:247], v[56:59], v[240:243], v[244:247]
    buffer_load_dwordx4 v29, s[36:39], s51 offen lds
    v_mfma_f32_16x16x32_bf16 v[160:163], v[64:67], v[40:43], v[160:163]
    s_add_u32 s51, s51, 0x38000
    ds_read_b64_tr_b16 v[102:103], v8 offset:21504
    v_mfma_f32_16x16x32_bf16 v[164:167], v[64:67], v[44:47], v[164:167]
    ds_read_b64_tr_b16 v[104:105], v9 offset:14336
    v_mfma_f32_16x16x32_bf16 v[168:171], v[64:67], v[48:51], v[168:171]
    ds_read_b64_tr_b16 v[106:107], v9 offset:21504
    v_mfma_f32_16x16x32_bf16 v[172:175], v[64:67], v[52:55], v[172:175]
    s_add_u32 m0, s49, 0x800
    v_mfma_f32_16x16x32_bf16 v[176:179], v[68:71], v[40:43], v[176:179]
    ds_read_b64_tr_b16 v[108:109], v10 offset:14336
    v_mfma_f32_16x16x32_bf16 v[180:183], v[68:71], v[44:47], v[180:183]
    buffer_load_dwordx4 v26, s[32:35], s50 offen lds
    v_mfma_f32_16x16x32_bf16 v[184:187], v[68:71], v[48:51], v[184:187]
    ds_read_b64_tr_b16 v[110:111], v10 offset:21504
    v_mfma_f32_16x16x32_bf16 v[188:191], v[68:71], v[52:55], v[188:191]
    ds_read_b64_tr_b16 v[112:113], v11 offset:14336
    v_mfma_f32_16x16x32_bf16 v[248:251], v[60:63], v[240:243], v[248:251]
    ds_read_b64_tr_b16 v[114:115], v11 offset:21504
    v_mfma_f32_16x16x32_bf16 v[192:195], v[72:75], v[40:43], v[192:195]
    s_add_u32 m0, s49, 0xc00
    ds_read_b64_tr_b16 v[116:117], v12 offset:14336
    v_mfma_f32_16x16x32_bf16 v[196:199], v[72:75], v[44:47], v[196:199]
    buffer_load_dwordx4 v27, s[32:35], s50 offen lds
    v_mfma_f32_16x16x32_bf16 v[200:203], v[72:75], v[48:51], v[200:203]
    s_add_u32 s50, s50, 128
    v_mfma_f32_16x16x32_bf16 v[204:207], v[72:75], v[52:55], v[204:207]
    s_add_u32 s55, s55, 128
    v_mfma_f32_16x16x32_bf16 v[208:211], v[76:79], v[40:43], v[208:211]
    ds_read_b64_tr_b16 v[118:119], v12 offset:21504
    v_mfma_f32_16x16x32_bf16 v[212:215], v[76:79], v[44:47], v[212:215]
    ds_read_b64_tr_b16 v[120:121], v13 offset:14336
    v_mfma_f32_16x16x32_bf16 v[216:219], v[76:79], v[48:51], v[216:219]
    ds_read_b64_tr_b16 v[122:123], v13 offset:21504
    v_mfma_f32_16x16x32_bf16 v[220:223], v[76:79], v[52:55], v[220:223]
    ds_read_b64_tr_b16 v[124:125], v14 offset:14336
    v_mfma_f32_16x16x32_bf16 v[224:227], v[80:83], v[40:43], v[224:227]
    ds_read_b64_tr_b16 v[126:127], v14 offset:21504
    v_mfma_f32_16x16x32_bf16 v[228:231], v[80:83], v[44:47], v[228:231]
    v_mfma_f32_16x16x32_bf16 v[232:235], v[80:83], v[48:51], v[232:235]
    v_mfma_f32_16x16x32_bf16 v[236:239], v[80:83], v[52:55], v[236:239]
    s_waitcnt vmcnt(9) lgkmcnt(0)
    s_barrier
    v_mfma_f32_16x16x32_bf16 v[128:131], v[100:103], v[84:87], v[128:131]
    s_mov_b32 s58, s48
    s_add_u32 s49, s48, s52
    v_mfma_f32_16x16x32_bf16 v[132:135], v[100:103], v[88:91], v[132:135]
    s_add_u32 s48, s48, 0x8800
    v_mfma_f32_16x16x32_bf16 v[136:139], v[100:103], v[92:95], v[136:139]
    s_cmp_eq_u32 s48, 0x19800
    v_mfma_f32_16x16x32_bf16 v[140:143], v[100:103], v[96:99], v[140:143]
    s_cselect_b32 s48, 0, s48
    v_add_u32 v18, s48, v16
    v_mfma_f32_16x16x32_bf16 v[144:147], v[104:107], v[84:87], v[144:147]
    v_add_u32 v19, s48, v17
    v_mfma_f32_16x16x32_bf16 v[148:151], v[104:107], v[88:91], v[148:151]
    s_add_u32 m0, s53, 0x3800
    v_mfma_f32_16x16x32_bf16 v[152:155], v[104:107], v[92:95], v[152:155]
    ds_read_b128 v[40:43], v18 offset:0
    buffer_load_dwordx4 v28, s[36:39], s51 offen lds
    v_mfma_f32_16x16x32_bf16 v[156:159], v[104:107], v[96:99], v[156:159]
    ds_read_b128 v[44:47], v18 offset:2048
    v_mfma_f32_16x16x32_bf16 v[244:247], v[100:103], v[240:243], v[244:247]
    ds_read_b128 v[48:51], v18 offset:4096
    v_mfma_f32_16x16x32_bf16 v[160:163], v[108:111], v[84:87], v[160:163]
    s_add_u32 m0, s56, 0x3800
    ds_read_b128 v[52:55], v18 offset:6144
    v_mfma_f32_16x16x32_bf16 v[164:167], v[108:111], v[88:91], v[164:167]
    buffer_load_dwordx4 v29, s[36:39], s51 offen lds
    v_mfma_f32_16x16x32_bf16 v[168:171], v[108:111], v[92:95], v[168:171]
    s_add_u32 s51, s51, 0x38000
    v_mfma_f32_16x16x32_bf16 v[172:175], v[108:111], v[96:99], v[172:175]
    ds_read_b64_tr_b16 v[56:57], v8 offset:28672
    ds_read_b64_tr_b16 v[58:59], v8 offset:35840
    v_mfma_f32_16x16x32_bf16 v[176:179], v[112:115], v[84:87], v[176:179]
    s_add_u32 m0, s49, 0x0
    v_mfma_f32_16x16x32_bf16 v[180:183], v[112:115], v[88:91], v[180:183]
    ds_read_b64_tr_b16 v[60:61], v9 offset:28672
    v_mfma_f32_16x16x32_bf16 v[184:187], v[112:115], v[92:95], v[184:187]
    buffer_load_dwordx4 v24, s[32:35], s50 offen lds
    ds_read_b64_tr_b16 v[62:63], v9 offset:35840
    v_mfma_f32_16x16x32_bf16 v[188:191], v[112:115], v[96:99], v[188:191]
    ds_read_b64_tr_b16 v[64:65], v10 offset:28672
    v_mfma_f32_16x16x32_bf16 v[248:251], v[104:107], v[240:243], v[248:251]
    s_add_u32 m0, s49, 0x400
    v_mfma_f32_16x16x32_bf16 v[192:195], v[116:119], v[84:87], v[192:195]
    ds_read_b64_tr_b16 v[66:67], v10 offset:35840
    buffer_load_dwordx4 v25, s[32:35], s50 offen lds
    v_mfma_f32_16x16x32_bf16 v[196:199], v[116:119], v[88:91], v[196:199]
    ds_read_b64_tr_b16 v[68:69], v11 offset:28672
    v_mfma_f32_16x16x32_bf16 v[200:203], v[116:119], v[92:95], v[200:203]
    ds_read_b64_tr_b16 v[70:71], v11 offset:35840
    v_mfma_f32_16x16x32_bf16 v[204:207], v[116:119], v[96:99], v[204:207]
    s_add_u32 m0, s57, s58
    ds_read_b64_tr_b16 v[72:73], v12 offset:28672
    v_mfma_f32_16x16x32_bf16 v[208:211], v[120:123], v[84:87], v[208:211]
    s_mov_b64 exec, 0xffff
    buffer_load_dwordx4 v30, s[32:35], s55 offen lds
    s_mov_b64 exec, -1
    v_mfma_f32_16x16x32_bf16 v[212:215], v[120:123], v[88:91], v[212:215]
    ds_read_b64_tr_b16 v[74:75], v12 offset:35840
    v_mfma_f32_16x16x32_bf16 v[216:219], v[120:123], v[92:95], v[216:219]
    ds_read_b64_tr_b16 v[76:77], v13 offset:28672
    ds_read_b64_tr_b16 v[78:79], v13 offset:35840
    v_mfma_f32_16x16x32_bf16 v[220:223], v[120:123], v[96:99], v[220:223]
    ds_read_b64_tr_b16 v[80:81], v14 offset:28672
    v_mfma_f32_16x16x32_bf16 v[224:227], v[124:127], v[84:87], v[224:227]
    ds_read_b64_tr_b16 v[82:83], v14 offset:35840
    v_mfma_f32_16x16x32_bf16 v[228:231], v[124:127], v[88:91], v[228:231]
    v_mfma_f32_16x16x32_bf16 v[232:235], v[124:127], v[92:95], v[232:235]
    v_mfma_f32_16x16x32_bf16 v[236:239], v[124:127], v[96:99], v[236:239]
    s_waitcnt vmcnt(12) lgkmcnt(0)
    s_barrier
    v_mfma_f32_16x16x32_bf16 v[128:131], v[56:59], v[40:43], v[128:131]
    s_add_u32 m0, s53, 0x7000
    ds_read_b128 v[84:87], v19 offset:0
    v_mfma_f32_16x16x32_bf16 v[132:135], v[56:59], v[44:47], v[132:135]
    buffer_load_dwordx4 v28, s[36:39], s51 offen lds
    v_mfma_f32_16x16x32_bf16 v[136:139], v[56:59], v[48:51], v[136:139]
    ds_read_b128 v[88:91], v19 offset:2048
    v_mfma_f32_16x16x32_bf16 v[140:143], v[56:59], v[52:55], v[140:143]
    ds_read_b128 v[92:95], v19 offset:4096
    v_mfma_f32_16x16x32_bf16 v[144:147], v[60:63], v[40:43], v[144:147]
    ds_read_b128 v[96:99], v19 offset:6144
    v_mfma_f32_16x16x32_bf16 v[148:151], v[60:63], v[44:47], v[148:151]
    s_add_u32 m0, s56, 0x7000
    v_mfma_f32_16x16x32_bf16 v[152:155], v[60:63], v[48:51], v[152:155]
    ds_read_b64_tr_b16 v[100:101], v8 offset:43008
    v_mfma_f32_16x16x32_bf16 v[156:159], v[60:63], v[52:55], v[156:159]
    buffer_load_dwordx4 v29, s[36:39], s51 offen lds
    v_mfma_f32_16x16x32_bf16 v[244:247], v[56:59], v[240:243], v[244:247]
    s_add_u32 s51, s51, 0x38000
    v_mfma_f32_16x16x32_bf16 v[160:163], v[64:67], v[40:43], v[160:163]
    ds_read_b64_tr_b16 v[102:103], v8 offset:50176
    v_mfma_f32_16x16x32_bf16 v[164:167], v[64:67], v[44:47], v[164:167]
    ds_read_b64_tr_b16 v[104:105], v9 offset:43008
    v_mfma_f32_16x16x32_bf16 v[168:171], v[64:67], v[48:51], v[168:171]
    ds_read_b64_tr_b16 v[106:107], v9 offset:50176
    v_mfma_f32_16x16x32_bf16 v[172:175], v[64:67], v[52:55], v[172:175]
    s_add_u32 m0, s49, 0x800
    v_mfma_f32_16x16x32_bf16 v[176:179], v[68:71], v[40:43], v[176:179]
    ds_read_b64_tr_b16 v[108:109], v10 offset:43008
    buffer_load_dwordx4 v26, s[32:35], s50 offen lds
    v_mfma_f32_16x16x32_bf16 v[180:183], v[68:71], v[44:47], v[180:183]
    ds_read_b64_tr_b16 v[110:111], v10 offset:50176
    v_mfma_f32_16x16x32_bf16 v[184:187], v[68:71], v[48:51], v[184:187]
    ds_read_b64_tr_b16 v[112:113], v11 offset:43008
    v_mfma_f32_16x16x32_bf16 v[188:191], v[68:71], v[52:55], v[188:191]
    ds_read_b64_tr_b16 v[114:115], v11 offset:50176
    v_mfma_f32_16x16x32_bf16 v[248:251], v[60:63], v[240:243], v[248:251]
    s_add_u32 m0, s49, 0xc00
    v_mfma_f32_16x16x32_bf16 v[192:195], v[72:75], v[40:43], v[192:195]
    ds_read_b64_tr_b16 v[116:117], v12 offset:43008
    v_mfma_f32_16x16x32_bf16 v[196:199], v[72:75], v[44:47], v[196:199]
    buffer_load_dwordx4 v27, s[32:35], s50 offen lds
    v_mfma_f32_16x16x32_bf16 v[200:203], v[72:75], v[48:51], v[200:203]
    s_add_u32 s50, s50, 128
    v_mfma_f32_16x16x32_bf16 v[204:207], v[72:75], v[52:55], v[204:207]
    s_add_u32 s55, s55, 128
    v_mfma_f32_16x16x32_bf16 v[208:211], v[76:79], v[40:43], v[208:211]
    ds_read_b64_tr_b16 v[118:119], v12 offset:50176
    v_mfma_f32_16x16x32_bf16 v[212:215], v[76:79], v[44:47], v[212:215]
    ds_read_b64_tr_b16 v[120:121], v13 offset:43008
    v_mfma_f32_16x16x32_bf16 v[216:219], v[76:79], v[48:51], v[216:219]
    ds_read_b64_tr_b16 v[122:123], v13 offset:50176
    v_mfma_f32_16x16x32_bf16 v[220:223], v[76:79], v[52:55], v[220:223]
    ds_read_b64_tr_b16 v[124:125], v14 offset:43008
    v_mfma_f32_16x16x32_bf16 v[224:227], v[80:83], v[40:43], v[224:227]
    ds_read_b64_tr_b16 v[126:127], v14 offset:50176
    v_mfma_f32_16x16x32_bf16 v[228:231], v[80:83], v[44:47], v[228:231]
    v_mfma_f32_16x16x32_bf16 v[232:235], v[80:83], v[48:51], v[232:235]
    v_mfma_f32_16x16x32_bf16 v[236:239], v[80:83], v[52:55], v[236:239]
    s_waitcnt vmcnt(9) lgkmcnt(0)
    s_barrier
    v_mfma_f32_16x16x32_bf16 v[128:131], v[100:103], v[84:87], v[128:131]
    s_mov_b32 s58, s48
    s_add_u32 s49, s48, s52
    v_mfma_f32_16x16x32_bf16 v[132:135], v[100:103], v[88:91], v[132:135]
    s_add_u32 s48, s48, 0x8800
    v_mfma_f32_16x16x32_bf16 v[136:139], v[100:103], v[92:95], v[136:139]
    s_cmp_eq_u32 s48, 0x19800
    v_mfma_f32_16x16x32_bf16 v[140:143], v[100:103], v[96:99], v[140:143]
    s_cselect_b32 s48, 0, s48
    v_mfma_f32_16x16x32_bf16 v[144:147], v[104:107], v[84:87], v[144:147]
    v_add_u32 v18, s48, v16
    v_mfma_f32_16x16x32_bf16 v[148:151], v[104:107], v[88:91], v[148:151]
    v_add_u32 v19, s48, v17
    v_mfma_f32_16x16x32_bf16 v[152:155], v[104:107], v[92:95], v[152:155]
    s_mov_b32 s61, 0
L_h_chk:
    v_readfirstlane_b32 s60, v253
    s_cmp_ge_u32 s60, 32
    s_cbranch_scc1 L_h_chkok
    s_sleep 2
    buffer_load_dwordx2 v[252:253], off, s[40:43], s79 sc1
    s_waitcnt vmcnt(0)
    s_add_u32 s61, s61, 1
    s_cmp_lt_u32 s61, 0x20000
    s_cbranch_scc1 L_h_chk
L_h_chkok:
    s_add_u32 m0, s53, 0xa800
    v_mfma_f32_16x16x32_bf16 v[156:159], v[104:107], v[96:99], v[156:159]
    ds_read_b128 v[40:43], v18 offset:0
    v_mfma_f32_16x16x32_bf16 v[244:247], v[100:103], v[240:243], v[244:247]
    buffer_load_dwordx4 v28, s[36:39], s51 offen lds
    v_mfma_f32_16x16x32_bf16 v[160:163], v[108:111], v[84:87], v[160:163]
    ds_read_b128 v[44:47], v18 offset:2048
    v_mfma_f32_16x16x32_bf16 v[164:167], v[108:111], v[88:91], v[164:167]
    ds_read_b128 v[48:51], v18 offset:4096
    v_mfma_f32_16x16x32_bf16 v[168:171], v[108:111], v[92:95], v[168:171]
    ds_read_b128 v[52:55], v18 offset:6144
    v_mfma_f32_16x16x32_bf16 v[172:175], v[108:111], v[96:99], v[172:175]
    ds_read_b64_tr_b16 v[56:57], v8 offset:0
    v_mfma_f32_16x16x32_bf16 v[176:179], v[112:115], v[84:87], v[176:179]
    ds_read_b64_tr_b16 v[58:59], v8 offset:7168
    s_add_u32 m0, s56, 0xa800
    v_mfma_f32_16x16x32_bf16 v[180:183], v[112:115], v[88:91], v[180:183]
    ds_read_b64_tr_b16 v[60:61], v9 offset:0
    v_mfma_f32_16x16x32_bf16 v[184:187], v[112:115], v[92:95], v[184:187]
    buffer_load_dwordx4 v29, s[36:39], s51 offen lds
    v_mfma_f32_16x16x32_bf16 v[188:191], v[112:115], v[96:99], v[188:191]
    s_add_u32 s51, s51, 0x38000
    v_mfma_f32_16x16x32_bf16 v[248:251], v[104:107], v[240:243], v[248:251]
    ds_read_b64_tr_b16 v[62:63], v9 offset:7168
    v_mfma_f32_16x16x32_bf16 v[192:195], v[116:119], v[84:87], v[192:195]
    ds_read_b64_tr_b16 v[64:65], v10 offset:0
    v_mfma_f32_16x16x32_bf16 v[196:199], v[116:119], v[88:91], v[196:199]
    ds_read_b64_tr_b16 v[66:67], v10 offset:7168
    v_mfma_f32_16x16x32_bf16 v[200:203], v[116:119], v[92:95], v[200:203]
    ds_read_b64_tr_b16 v[68:69], v11 offset:0
    ds_read_b64_tr_b16 v[70:71], v11 offset:7168
    v_mfma_f32_16x16x32_bf16 v[204:207], v[116:119], v[96:99], v[204:207]
    ds_read_b64_tr_b16 v[72:73], v12 offset:0
    v_mfma_f32_16x16x32_bf16 v[208:211], v[120:123], v[84:87], v[208:211]
    ds_read_b64_tr_b16 v[74:75], v12 offset:7168
    v_mfma_f32_16x16x32_bf16 v[212:215], v[120:123], v[88:91], v[212:215]
    ds_read_b64_tr_b16 v[76:77], v13 offset:0
    v_mfma_f32_16x16x32_bf16 v[216:219], v[120:123], v[92:95], v[216:219]
    ds_read_b64_tr_b16 v[78:79], v13 offset:7168
    v_mfma_f32_16x16x32_bf16 v[220:223], v[120:123], v[96:99], v[220:223]
    ds_read_b64_tr_b16 v[80:81], v14 offset:0
    v_mfma_f32_16x16x32_bf16 v[224:227], v[124:127], v[84:87], v[224:227]
    ds_read_b64_tr_b16 v[82:83], v14 offset:7168
    v_mfma_f32_16x16x32_bf16 v[228:231], v[124:127], v[88:91], v[228:231]
    v_mfma_f32_16x16x32_bf16 v[232:235], v[124:127], v[92:95], v[232:235]
    v_mfma_f32_16x16x32_bf16 v[236:239], v[124:127], v[96:99], v[236:239]
    s_waitcnt vmcnt(9) lgkmcnt(0)
    s_barrier
    v_mfma_f32_16x16x32_bf16 v[128:131], v[56:59], v[40:43], v[128:131]
    ds_read_b128 v[84:87], v19 offset:0
    v_mfma_f32_16x16x32_bf16 v[132:135], v[56:59], v[44:47], v[132:135]
    ds_read_b128 v[88:91], v19 offset:2048
    v_mfma_f32_16x16x32_bf16 v[136:139], v[56:59], v[48:51], v[136:139]
    v_mfma_f32_16x16x32_bf16 v[140:143], v[56:59], v[52:55], v[140:143]
    ds_read_b128 v[92:95], v19 offset:4096
    v_mfma_f32_16x16x32_bf16 v[144:147], v[60:63], v[40:43], v[144:147]
    ds_read_b128 v[96:99], v19 offset:6144
    v_mfma_f32_16x16x32_bf16 v[148:151], v[60:63], v[44:47], v[148:151]
    v_mfma_f32_16x16x32_bf16 v[152:155], v[60:63], v[48:51], v[152:155]
    ds_read_b64_tr_b16 v[100:101], v8 offset:14336
    v_mfma_f32_16x16x32_bf16 v[156:159], v[60:63], v[52:55], v[156:159]
    ds_read_b64_tr_b16 v[102:103], v8 offset:21504
    v_mfma_f32_16x16x32_bf16 v[244:247], v[56:59], v[240:243], v[244:247]
    v_mfma_f32_16x16x32_bf16 v[160:163], v[64:67], v[40:43], v[160:163]
    ds_read_b64_tr_b16 v[104:105], v9 offset:14336
    v_mfma_f32_16x16x32_bf16 v[164:167], v[64:67], v[44:47], v[164:167]
    ds_read_b64_tr_b16 v[106:107], v9 offset:21504
    v_mfma_f32_16x16x32_bf16 v[168:171], v[64:67], v[48:51], v[168:171]
    v_mfma_f32_16x16x32_bf16 v[172:175], v[64:67], v[52:55], v[172:175]
    ds_read_b64_tr_b16 v[108:109], v10 offset:14336
    v_mfma_f32_16x16x32_bf16 v[176:179], v[68:71], v[40:43], v[176:179]
    ds_read_b64_tr_b16 v[110:111], v10 offset:21504
    v_mfma_f32_16x16x32_bf16 v[180:183], v[68:71], v[44:47], v[180:183]
    v_mfma_f32_16x16x32_bf16 v[184:187], v[68:71], v[48:51], v[184:187]
    ds_read_b64_tr_b16 v[112:113], v11 offset:14336
    v_mfma_f32_16x16x32_bf16 v[188:191], v[68:71], v[52:55], v[188:191]
    ds_read_b64_tr_b16 v[114:115], v11 offset:21504
    v_mfma_f32_16x16x32_bf16 v[248:251], v[60:63], v[240:243], v[248:251]
    v_mfma_f32_16x16x32_bf16 v[192:195], v[72:75], v[40:43], v[192:195]
    ds_read_b64_tr_b16 v[116:117], v12 offset:14336
    v_mfma_f32_16x16x32_bf16 v[196:199], v[72:75], v[44:47], v[196:199]
    ds_read_b64_tr_b16 v[118:119], v12 offset:21504
    v_mfma_f32_16x16x32_bf16 v[200:203], v[72:75], v[48:51], v[200:203]
    v_mfma_f32_16x16x32_bf16 v[204:207], v[72:75], v[52:55], v[204:207]
    ds_read_b64_tr_b16 v[120:121], v13 offset:14336
    v_mfma_f32_16x16x32_bf16 v[208:211], v[76:79], v[40:43], v[208:211]
    ds_read_b64_tr_b16 v[122:123], v13 offset:21504
    v_mfma_f32_16x16x32_bf16 v[212:215], v[76:79], v[44:47], v[212:215]
    v_mfma_f32_16x16x32_bf16 v[216:219], v[76:79], v[48:51], v[216:219]
    ds_read_b64_tr_b16 v[124:125], v14 offset:14336
    v_mfma_f32_16x16x32_bf16 v[220:223], v[76:79], v[52:55], v[220:223]
    ds_read_b64_tr_b16 v[126:127], v14 offset:21504
    v_mfma_f32_16x16x32_bf16 v[224:227], v[80:83], v[40:43], v[224:227]
    v_mfma_f32_16x16x32_bf16 v[228:231], v[80:83], v[44:47], v[228:231]
    v_mfma_f32_16x16x32_bf16 v[232:235], v[80:83], v[48:51], v[232:235]
    v_mfma_f32_16x16x32_bf16 v[236:239], v[80:83], v[52:55], v[236:239]
    s_waitcnt vmcnt(2) lgkmcnt(0)
    s_barrier
    v_mfma_f32_16x16x32_bf16 v[128:131], v[100:103], v[84:87], v[128:131]
    s_mov_b32 s58, s48
    v_mfma_f32_16x16x32_bf16 v[132:135], v[100:103], v[88:91], v[132:135]
    s_add_u32 s49, s48, s52
    v_mfma_f32_16x16x32_bf16 v[136:139], v[100:103], v[92:95], v[136:139]
    s_add_u32 s48, s48, 0x8800
    v_mfma_f32_16x16x32_bf16 v[140:143], v[100:103], v[96:99], v[140:143]
    s_cmp_eq_u32 s48, 0x19800
    v_mfma_f32_16x16x32_bf16 v[144:147], v[104:107], v[84:87], v[144:147]
    s_cselect_b32 s48, 0, s48
    v_mfma_f32_16x16x32_bf16 v[148:151], v[104:107], v[88:91], v[148:151]
    v_add_u32 v18, s48, v16
    v_mfma_f32_16x16x32_bf16 v[152:155], v[104:107], v[92:95], v[152:155]
    v_add_u32 v19, s48, v17
    v_mfma_f32_16x16x32_bf16 v[156:159], v[104:107], v[96:99], v[156:159]
    ds_read_b128 v[40:43], v18 offset:0
    v_mfma_f32_16x16x32_bf16 v[244:247], v[100:103], v[240:243], v[244:247]
    ds_read_b128 v[44:47], v18 offset:2048
    v_mfma_f32_16x16x32_bf16 v[160:163], v[108:111], v[84:87], v[160:163]
    ds_read_b128 v[48:51], v18 offset:4096
    v_mfma_f32_16x16x32_bf16 v[164:167], v[108:111], v[88:91], v[164:167]
    ds_read_b128 v[52:55], v18 offset:6144
    v_mfma_f32_16x16x32_bf16 v[168:171], v[108:111], v[92:95], v[168:171]
    ds_read_b64_tr_b16 v[56:57], v8 offset:28672
    v_mfma_f32_16x16x32_bf16 v[172:175], v[108:111], v[96:99], v[172:175]
    ds_read_b64_tr_b16 v[58:59], v8 offset:35840
    v_mfma_f32_16x16x32_bf16 v[176:179], v[112:115], v[84:87], v[176:179]
    v_mfma_f32_16x16x32_bf16 v[180:183], v[112:115], v[88:91], v[180:183]
    ds_read_b64_tr_b16 v[60:61], v9 offset:28672
    v_mfma_f32_16x16x32_bf16 v[184:187], v[112:115], v[92:95], v[184:187]
    ds_read_b64_tr_b16 v[62:63], v9 offset:35840
    v_mfma_f32_16x16x32_bf16 v[188:191], v[112:115], v[96:99], v[188:191]
    ds_read_b64_tr_b16 v[64:65], v10 offset:28672
    v_mfma_f32_16x16x32_bf16 v[248:251], v[104:107], v[240:243], v[248:251]
    ds_read_b64_tr_b16 v[66:67], v10 offset:35840
    v_mfma_f32_16x16x32_bf16 v[192:195], v[116:119], v[84:87], v[192:195]
    ds_read_b64_tr_b16 v[68:69], v11 offset:28672
    v_mfma_f32_16x16x32_bf16 v[196:199], v[116:119], v[88:91], v[196:199]
    ds_read_b64_tr_b16 v[70:71], v11 offset:35840
    v_mfma_f32_16x16x32_bf16 v[200:203], v[116:119], v[92:95], v[200:203]
    ds_read_b64_tr_b16 v[72:73], v12 offset:28672
    v_mfma_f32_16x16x32_bf16 v[204:207], v[116:119], v[96:99], v[204:207]
    ds_read_b64_tr_b16 v[74:75], v12 offset:35840
    v_mfma_f32_16x16x32_bf16 v[208:211], v[120:123], v[84:87], v[208:211]
    ds_read_b64_tr_b16 v[76:77], v13 offset:28672
    v_mfma_f32_16x16x32_bf16 v[212:215], v[120:123], v[88:91], v[212:215]
    ds_read_b64_tr_b16 v[78:79], v13 offset:35840
    v_mfma_f32_16x16x32_bf16 v[216:219], v[120:123], v[92:95], v[216:219]
    ds_read_b64_tr_b16 v[80:81], v14 offset:28672
    v_mfma_f32_16x16x32_bf16 v[220:223], v[120:123], v[96:99], v[220:223]
    ds_read_b64_tr_b16 v[82:83], v14 offset:35840
    v_mfma_f32_16x16x32_bf16 v[224:227], v[124:127], v[84:87], v[224:227]
    v_mfma_f32_16x16x32_bf16 v[228:231], v[124:127], v[88:91], v[228:231]
    v_mfma_f32_16x16x32_bf16 v[232:235], v[124:127], v[92:95], v[232:235]
    v_mfma_f32_16x16x32_bf16 v[236:239], v[124:127], v[96:99], v[236:239]
    s_waitcnt vmcnt(0) lgkmcnt(0)
    s_barrier
    v_mfma_f32_16x16x32_bf16 v[128:131], v[56:59], v[40:43], v[128:131]
    ds_read_b128 v[84:87], v19 offset:0
    v_mfma_f32_16x16x32_bf16 v[132:135], v[56:59], v[44:47], v[132:135]
    ds_read_b128 v[88:91], v19 offset:2048
    v_mfma_f32_16x16x32_bf16 v[136:139], v[56:59], v[48:51], v[136:139]
    v_mfma_f32_16x16x32_bf16 v[140:143], v[56:59], v[52:55], v[140:143]
    ds_read_b128 v[92:95], v19 offset:4096
    v_mfma_f32_16x16x32_bf16 v[144:147], v[60:63], v[40:43], v[144:147]
    ds_read_b128 v[96:99], v19 offset:6144
    v_mfma_f32_16x16x32_bf16 v[148:151], v[60:63], v[44:47], v[148:151]
    v_mfma_f32_16x16x32_bf16 v[152:155], v[60:63], v[48:51], v[152:155]
    ds_read_b64_tr_b16 v[100:101], v8 offset:43008
    v_mfma_f32_16x16x32_bf16 v[156:159], v[60:63], v[52:55], v[156:159]
    ds_read_b64_tr_b16 v[102:103], v8 offset:50176
    v_mfma_f32_16x16x32_bf16 v[244:247], v[56:59], v[240:243], v[244:247]
    v_mfma_f32_16x16x32_bf16 v[160:163], v[64:67], v[40:43], v[160:163]
    ds_read_b64_tr_b16 v[104:105], v9 offset:43008
    v_mfma_f32_16x16x32_bf16 v[164:167], v[64:67], v[44:47], v[164:167]
    ds_read_b64_tr_b16 v[106:107], v9 offset:50176
    v_mfma_f32_16x16x32_bf16 v[168:171], v[64:67], v[48:51], v[168:171]
    v_mfma_f32_16x16x32_bf16 v[172:175], v[64:67], v[52:55], v[172:175]
    ds_read_b64_tr_b16 v[108:109], v10 offset:43008
    v_mfma_f32_16x16x32_bf16 v[176:179], v[68:71], v[40:43], v[176:179]
    ds_read_b64_tr_b16 v[110:111], v10 offset:50176
    v_mfma_f32_16x16x32_bf16 v[180:183], v[68:71], v[44:47], v[180:183]
    v_mfma_f32_16x16x32_bf16 v[184:187], v[68:71], v[48:51], v[184:187]
    ds_read_b64_tr_b16 v[112:113], v11 offset:43008
    v_mfma_f32_16x16x32_bf16 v[188:191], v[68:71], v[52:55], v[188:191]
    ds_read_b64_tr_b16 v[114:115], v11 offset:50176
    v_mfma_f32_16x16x32_bf16 v[248:251], v[60:63], v[240:243], v[248:251]
    v_mfma_f32_16x16x32_bf16 v[192:195], v[72:75], v[40:43], v[192:195]
    ds_read_b64_tr_b16 v[116:117], v12 offset:43008
    v_mfma_f32_16x16x32_bf16 v[196:199], v[72:75], v[44:47], v[196:199]
    ds_read_b64_tr_b16 v[118:119], v12 offset:50176
    v_mfma_f32_16x16x32_bf16 v[200:203], v[72:75], v[48:51], v[200:203]
    v_mfma_f32_16x16x32_bf16 v[204:207], v[72:75], v[52:55], v[204:207]
    ds_read_b64_tr_b16 v[120:121], v13 offset:43008
    v_mfma_f32_16x16x32_bf16 v[208:211], v[76:79], v[40:43], v[208:211]
    ds_read_b64_tr_b16 v[122:123], v13 offset:50176
    v_mfma_f32_16x16x32_bf16 v[212:215], v[76:79], v[44:47], v[212:215]
    v_mfma_f32_16x16x32_bf16 v[216:219], v[76:79], v[48:51], v[216:219]
    ds_read_b64_tr_b16 v[124:125], v14 offset:43008
    v_mfma_f32_16x16x32_bf16 v[220:223], v[76:79], v[52:55], v[220:223]
    ds_read_b64_tr_b16 v[126:127], v14 offset:50176
    v_mfma_f32_16x16x32_bf16 v[224:227], v[80:83], v[40:43], v[224:227]
    v_mfma_f32_16x16x32_bf16 v[228:231], v[80:83], v[44:47], v[228:231]
    v_mfma_f32_16x16x32_bf16 v[232:235], v[80:83], v[48:51], v[232:235]
    v_mfma_f32_16x16x32_bf16 v[236:239], v[80:83], v[52:55], v[236:239]
    s_waitcnt lgkmcnt(0)
    s_barrier
    v_mfma_f32_16x16x32_bf16 v[128:131], v[100:103], v[84:87], v[128:131]
    s_lshl_b32 s60, s23, 2
    s_add_u32 s60, s60, s21
    s_lshl_b32 s60, s60, 9
    s_add_u32 s60, s60, 0x3800000
    v_lshlrev_b32 v253, 3, v3
    v_mfma_f32_16x16x32_bf16 v[132:135], v[100:103], v[88:91], v[132:135]
    v_mfma_f32_16x16x32_bf16 v[136:139], v[100:103], v[92:95], v[136:139]
    v_mfma_f32_16x16x32_bf16 v[140:143], v[100:103], v[96:99], v[140:143]
    v_mfma_f32_16x16x32_bf16 v[144:147], v[104:107], v[84:87], v[144:147]
    v_mfma_f32_16x16x32_bf16 v[148:151], v[104:107], v[88:91], v[148:151]
    buffer_load_dwordx2 v[40:41], v253, s[28:31], s60 offen offset:0 sc1
    v_mfma_f32_16x16x32_bf16 v[152:155], v[104:107], v[92:95], v[152:155]
    v_mfma_f32_16x16x32_bf16 v[156:159], v[104:107], v[96:99], v[156:159]
    v_mfma_f32_16x16x32_bf16 v[244:247], v[100:103], v[240:243], v[244:247]
    v_mfma_f32_16x16x32_bf16 v[160:163], v[108:111], v[84:87], v[160:163]
    v_mfma_f32_16x16x32_bf16 v[164:167], v[108:111], v[88:91], v[164:167]
    buffer_load_dwordx2 v[42:43], v253, s[28:31], s60 offen offset:128 sc1
    v_mfma_f32_16x16x32_bf16 v[168:171], v[108:111], v[92:95], v[168:171]
    v_mfma_f32_16x16x32_bf16 v[172:175], v[108:111], v[96:99], v[172:175]
    v_mfma_f32_16x16x32_bf16 v[176:179], v[112:115], v[84:87], v[176:179]
    v_mfma_f32_16x16x32_bf16 v[180:183], v[112:115], v[88:91], v[180:183]
    v_mfma_f32_16x16x32_bf16 v[184:187], v[112:115], v[92:95], v[184:187]
    v_mfma_f32_16x16x32_bf16 v[188:191], v[112:115], v[96:99], v[188:191]
    buffer_load_dwordx2 v[44:45], v253, s[28:31], s60 offen offset:256 sc1
    v_mfma_f32_16x16x32_bf16 v[248:251], v[104:107], v[240:243], v[248:251]
    v_mfma_f32_16x16x32_bf16 v[192:195], v[116:119], v[84:87], v[192:195]
    v_mfma_f32_16x16x32_bf16 v[196:199], v[116:119], v[88:91], v[196:199]
    v_mfma_f32_16x16x32_bf16 v[200:203], v[116:119], v[92:95], v[200:203]
    v_mfma_f32_16x16x32_bf16 v[204:207], v[116:119], v[96:99], v[204:207]
    buffer_load_dwordx2 v[46:47], v253, s[28:31], s60 offen offset:384 sc1
    v_mfma_f32_16x16x32_bf16 v[208:211], v[120:123], v[84:87], v[208:211]
    v_mfma_f32_16x16x32_bf16 v[212:215], v[120:123], v[88:91], v[212:215]
    v_mfma_f32_16x16x32_bf16 v[216:219], v[120:123], v[92:95], v[216:219]
    v_mfma_f32_16x16x32_bf16 v[220:223], v[120:123], v[96:99], v[220:223]
    v_mfma_f32_16x16x32_bf16 v[224:227], v[124:127], v[84:87], v[224:227]
    v_mfma_f32_16x16x32_bf16 v[228:231], v[124:127], v[88:91], v[228:231]
    v_mfma_f32_16x16x32_bf16 v[232:235], v[124:127], v[92:95], v[232:235]
    v_mfma_f32_16x16x32_bf16 v[236:239], v[124:127], v[96:99], v[236:239]
    s_setprio 3
    s_mov_b32 s62, 0x27a00
    v_lshl_add_u32 v34, v4, 4, s62
    s_mov_b32 exec_lo, 0x10001
    s_mov_b32 exec_hi, 0x10001
    s_lshl_b32 s60, s64, 6
    v_add_u32 v35, s60, v34
    ds_write_b128 v35, v[244:247]
    s_lshl_b32 s60, s65, 6
    v_add_u32 v36, s60, v34
    ds_write_b128 v36, v[248:251]
    s_mov_b64 exec, -1
    s_waitcnt lgkmcnt(0)
    s_barrier
    s_lshl_b32 s60, s64, 6
    v_add_u32 v35, s60, v34
    ds_read_b128 v[84:87], v35
    s_lshl_b32 s60, s65, 6
    v_add_u32 v35, s60, v34
    ds_read_b128 v[88:91], v35
    s_lshl_b32 s60, s66, 6
    v_add_u32 v35, s60, v34
    ds_read_b128 v[92:95], v35
    s_lshl_b32 s60, s67, 6
    v_add_u32 v35, s60, v34
    ds_read_b128 v[96:99], v35
    s_lshl_b32 s60, s68, 6
    v_add_u32 v35, s60, v34
    ds_read_b128 v[100:103], v35
    s_lshl_b32 s60, s69, 6
    v_add_u32 v35, s60, v34
    ds_read_b128 v[104:107], v35
    s_lshl_b32 s60, s70, 6
    v_add_u32 v35, s60, v34
    ds_read_b128 v[108:111], v35
    s_mov_b32 s36, s12
    s_mov_b32 s37, s13
    s_mov_b32 s38, 0x700000
    s_mov_b32 s39, 0x20000
    s_lshl_b32 s60, s74, 8
    s_mul_i32 s49, s72, 0x1c0000
    s_add_u32 s49, s49, s60
    s_lshl_b32 s55, s72, 19
    s_add_u32 s55, s55, s60
    v_lshrrev_b32 v24, 3, v2
    v_and_b32 v25, 7, v2
    v_lshrrev_b32 v26, 2, v24
    v_and_b32 v27, 3, v24
    v_lshl_add_u32 v26, v26, 3, v27
    s_and_b32 s60, s20, 1
    s_lshl_b32 s60, s60, 4
    s_and_b32 s61, s20, 2
    s_lshl_b32 s61, s61, 1
    s_add_u32 s60, s60, s61
    v_add_u32 v26, s60, v26
    v_and_b32 v27, 6, v24
    v_xor_b32 v27, v27, v25
    v_lshlrev_b32 v27, 4, v27
    v_lshl_add_u32 v26, v26, 11, v27
    s_lshr_b32 s60, s20, 2
    s_lshl_b32 s60, s60, 7
    v_add_u32 v22, s60, v26
    s_lshl_b32 s50, s20, 10
    s_add_u32 s51, s50, 0x4000
    s_mov_b32 s52, 0
    s_waitcnt vmcnt(0) lgkmcnt(0)
    v_and_b32 v32, 1, v4
    v_lshrrev_b32 v37, 1, v4
    v_lshlrev_b32 v31, 5, v3
    v_lshl_add_u32 v31, v37, 4, v31
    s_lshl_b32 s60, s64, 9
    s_sub_i32 s61, s65, s64
    s_lshl_b32 s61, s61, 9
    v_add_u32 v34, s60, v31
    v_mad_i32_i24 v34, v32, s61, v34
    s_lshl_b32 s60, s66, 9
    s_sub_i32 s61, s67, s66
    s_lshl_b32 s61, s61, 9
    v_add_u32 v35, s60, v31
    v_mad_i32_i24 v35, v32, s61, v35
    s_lshl_b32 s60, s68, 9
    s_sub_i32 s61, s69, s68
    s_lshl_b32 s61, s61, 9
    v_add_u32 v36, s60, v31
    v_mad_i32_i24 v36, v32, s61, v36
    v_mul_u32_u24 v33, 0x24000, v32
    v_add_u32 v33, v33, v31
    s_lshl_b32 s60, s70, 9
    v_add_u32 v33, s60, v33
    s_lshl_b32 s60, s23, 2
    s_add_u32 s60, s60, s21
    s_mul_i32 s60, s60, 589824
    s_mul_i32 s61, s24, 3584
    s_add_u32 s60, s60, s61
    s_add_u32 s76, s60, 0x8000
    s_add_u32 s77, s76, 0x24000
    s_add_u32 s78, s76, 0x48000
    s_add_u32 s79, s76, 0x6c000
    v_pk_fma_f32 v[128:129], v[40:41], v[84:85], v[128:129] op_sel_hi:[0,1,1]
    v_pk_fma_f32 v[130:131], v[40:41], v[86:87], v[130:131] op_sel_hi:[0,1,1]
    v_pk_mul_f32 v[128:129], v[40:41], v[128:129] op_sel:[1,0] op_sel_hi:[1,1]
    v_pk_mul_f32 v[130:131], v[40:41], v[130:131] op_sel:[1,0] op_sel_hi:[1,1]
    v_pk_fma_f32 v[144:145], v[40:41], v[88:89], v[144:145] op_sel_hi:[0,1,1]
    v_pk_fma_f32 v[146:147], v[40:41], v[90:91], v[146:147] op_sel_hi:[0,1,1]
    v_pk_mul_f32 v[144:145], v[40:41], v[144:145] op_sel:[1,0] op_sel_hi:[1,1]
    v_pk_mul_f32 v[146:147], v[40:41], v[146:147] op_sel:[1,0] op_sel_hi:[1,1]
    v_cvt_pk_bf16_f32 v52, v128, v129
    v_cvt_pk_bf16_f32 v53, v130, v131
    v_cvt_pk_bf16_f32 v54, v144, v145
    v_cvt_pk_bf16_f32 v55, v146, v147
    v_pk_max_i16 v52, v52, 0
    v_pk_max_i16 v53, v53, 0
    v_pk_max_i16 v54, v54, 0
    v_pk_max_i16 v55, v55, 0
    s_nop 1
    v_permlane16_swap_b32 v52, v54
    v_permlane16_swap_b32 v53, v55
    s_nop 0
    buffer_store_dwordx4 v[52:55], v34, s[28:31], s76 offen sc1
    s_add_u32 m0, s51, 0x0
    s_nop 0
    buffer_load_dwordx4 v22, s[36:39], s49 offen lds
    s_add_u32 s49, s49, 0x10000
    s_add_u32 s52, s52, 1
    s_cmp_eq_u32 s52, 28
    s_cselect_b32 s36, s8, s36
    s_cselect_b32 s37, s9, s37
    s_cselect_b32 s38, 0x200000, s38
    s_cselect_b32 s49, s55, s49
    v_pk_fma_f32 v[160:161], v[40:41], v[92:93], v[160:161] op_sel_hi:[0,1,1]
    v_pk_fma_f32 v[162:163], v[40:41], v[94:95], v[162:163] op_sel_hi:[0,1,1]
    v_pk_mul_f32 v[160:161], v[40:41], v[160:161] op_sel:[1,0] op_sel_hi:[1,1]
    v_pk_mul_f32 v[162:163], v[40:41], v[162:163] op_sel:[1,0] op_sel_hi:[1,1]
    v_pk_fma_f32 v[176:177], v[40:41], v[96:97], v[176:177] op_sel_hi:[0,1,1]
    v_pk_fma_f32 v[178:179], v[40:41], v[98:99], v[178:179] op_sel_hi:[0,1,1]
    v_pk_mul_f32 v[176:177], v[40:41], v[176:177] op_sel:[1,0] op_sel_hi:[1,1]
    v_pk_mul_f32 v[178:179], v[40:41], v[178:179] op_sel:[1,0] op_sel_hi:[1,1]
    v_cvt_pk_bf16_f32 v56, v160, v161
    v_cvt_pk_bf16_f32 v57, v162, v163
    v_cvt_pk_bf16_f32 v58, v176, v177
    v_cvt_pk_bf16_f32 v59, v178, v179
    v_pk_max_i16 v56, v56, 0
    v_pk_max_i16 v57, v57, 0
    v_pk_max_i16 v58, v58, 0
    v_pk_max_i16 v59, v59, 0
    s_nop 1
    v_permlane16_swap_b32 v56, v58
    v_permlane16_swap_b32 v57, v59
    s_nop 0
    buffer_store_dwordx4 v[56:59], v35, s[28:31], s76 offen sc1
    s_add_u32 m0, s51, 0x6000
    s_nop 0
    buffer_load_dwordx4 v22, s[36:39], s49 offen lds
    s_add_u32 s49, s49, 0x10000
    s_add_u32 s52, s52, 1
    s_cmp_eq_u32 s52, 28
    s_cselect_b32 s36, s8, s36
    s_cselect_b32 s37, s9, s37
    s_cselect_b32 s38, 0x200000, s38
    s_cselect_b32 s49, s55, s49
    v_pk_fma_f32 v[192:193], v[40:41], v[100:101], v[192:193] op_sel_hi:[0,1,1]
    v_pk_fma_f32 v[194:195], v[40:41], v[102:103], v[194:195] op_sel_hi:[0,1,1]
    v_pk_mul_f32 v[192:193], v[40:41], v[192:193] op_sel:[1,0] op_sel_hi:[1,1]
    v_pk_mul_f32 v[194:195], v[40:41], v[194:195] op_sel:[1,0] op_sel_hi:[1,1]
    v_pk_fma_f32 v[208:209], v[40:41], v[104:105], v[208:209] op_sel_hi:[0,1,1]
    v_pk_fma_f32 v[210:211], v[40:41], v[106:107], v[210:211] op_sel_hi:[0,1,1]
    v_pk_mul_f32 v[208:209], v[40:41], v[208:209] op_sel:[1,0] op_sel_hi:[1,1]
    v_pk_mul_f32 v[210:211], v[40:41], v[210:211] op_sel:[1,0] op_sel_hi:[1,1]
    v_cvt_pk_bf16_f32 v60, v192, v193
    v_cvt_pk_bf16_f32 v61, v194, v195
    v_cvt_pk_bf16_f32 v62, v208, v209
    v_cvt_pk_bf16_f32 v63, v210, v211
    v_pk_max_i16 v60, v60, 0
    v_pk_max_i16 v61, v61, 0
    v_pk_max_i16 v62, v62, 0
    v_pk_max_i16 v63, v63, 0
    s_nop 1
    v_permlane16_swap_b32 v60, v62
    v_permlane16_swap_b32 v61, v63
    s_nop 0
    buffer_store_dwordx4 v[60:63], v36, s[28:31], s76 offen sc1
    s_add_u32 m0, s51, 0xc000
    s_nop 0
    buffer_load_dwordx4 v22, s[36:39], s49 offen lds
    s_add_u32 s49, s49, 0x10000
    s_add_u32 s52, s52, 1
    s_cmp_eq_u32 s52, 28
    s_cselect_b32 s36, s8, s36
    s_cselect_b32 s37, s9, s37
    s_cselect_b32 s38, 0x200000, s38
    s_cselect_b32 s49, s55, s49
    v_pk_fma_f32 v[132:133], v[42:43], v[84:85], v[132:133] op_sel_hi:[0,1,1]
    v_pk_fma_f32 v[134:135], v[42:43], v[86:87], v[134:135] op_sel_hi:[0,1,1]
    v_pk_mul_f32 v[132:133], v[42:43], v[132:133] op_sel:[1,0] op_sel_hi:[1,1]
    v_pk_mul_f32 v[134:135], v[42:43], v[134:135] op_sel:[1,0] op_sel_hi:[1,1]
    v_pk_fma_f32 v[148:149], v[42:43], v[88:89], v[148:149] op_sel_hi:[0,1,1]
    v_pk_fma_f32 v[150:151], v[42:43], v[90:91], v[150:151] op_sel_hi:[0,1,1]
    v_pk_mul_f32 v[148:149], v[42:43], v[148:149] op_sel:[1,0] op_sel_hi:[1,1]
    v_pk_mul_f32 v[150:151], v[42:43], v[150:151] op_sel:[1,0] op_sel_hi:[1,1]
    v_cvt_pk_bf16_f32 v64, v132, v133
    v_cvt_pk_bf16_f32 v65, v134, v135
    v_cvt_pk_bf16_f32 v66, v148, v149
    v_cvt_pk_bf16_f32 v67, v150, v151
    v_pk_max_i16 v64, v64, 0
    v_pk_max_i16 v65, v65, 0
    v_pk_max_i16 v66, v66, 0
    v_pk_max_i16 v67, v67, 0
    s_nop 1
    v_permlane16_swap_b32 v64, v66
    v_permlane16_swap_b32 v65, v67
    s_nop 0
    buffer_store_dwordx4 v[64:67], v34, s[28:31], s77 offen sc1
    s_add_u32 m0, s51, 0x12000
    s_nop 0
    buffer_load_dwordx4 v22, s[36:39], s49 offen lds
    s_add_u32 s49, s49, 0x10000
    s_add_u32 s52, s52, 1
    s_cmp_eq_u32 s52, 28
    s_cselect_b32 s36, s8, s36
    s_cselect_b32 s37, s9, s37
    s_cselect_b32 s38, 0x200000, s38
    s_cselect_b32 s49, s55, s49
    v_pk_fma_f32 v[164:165], v[42:43], v[92:93], v[164:165] op_sel_hi:[0,1,1]
    v_pk_fma_f32 v[166:167], v[42:43], v[94:95], v[166:167] op_sel_hi:[0,1,1]
    v_pk_mul_f32 v[164:165], v[42:43], v[164:165] op_sel:[1,0] op_sel_hi:[1,1]
    v_pk_mul_f32 v[166:167], v[42:43], v[166:167] op_sel:[1,0] op_sel_hi:[1,1]
    v_pk_fma_f32 v[180:181], v[42:43], v[96:97], v[180:181] op_sel_hi:[0,1,1]
    v_pk_fma_f32 v[182:183], v[42:43], v[98:99], v[182:183] op_sel_hi:[0,1,1]
    v_pk_mul_f32 v[180:181], v[42:43], v[180:181] op_sel:[1,0] op_sel_hi:[1,1]
    v_pk_mul_f32 v[182:183], v[42:43], v[182:183] op_sel:[1,0] op_sel_hi:[1,1]
    v_cvt_pk_bf16_f32 v68, v164, v165
    v_cvt_pk_bf16_f32 v69, v166, v167
    v_cvt_pk_bf16_f32 v70, v180, v181
    v_cvt_pk_bf16_f32 v71, v182, v183
    v_pk_max_i16 v68, v68, 0
    v_pk_max_i16 v69, v69, 0
    v_pk_max_i16 v70, v70, 0
    v_pk_max_i16 v71, v71, 0
    s_nop 1
    v_permlane16_swap_b32 v68, v70
    v_permlane16_swap_b32 v69, v71
    s_nop 0
    buffer_store_dwordx4 v[68:71], v35, s[28:31], s77 offen sc1
    v_pk_fma_f32 v[196:197], v[42:43], v[100:101], v[196:197] op_sel_hi:[0,1,1]
    v_pk_fma_f32 v[198:199], v[42:43], v[102:103], v[198:199] op_sel_hi:[0,1,1]
    v_pk_mul_f32 v[196:197], v[42:43], v[196:197] op_sel:[1,0] op_sel_hi:[1,1]
    v_pk_mul_f32 v[198:199], v[42:43], v[198:199] op_sel:[1,0] op_sel_hi:[1,1]
    v_pk_fma_f32 v[212:213], v[42:43], v[104:105], v[212:213] op_sel_hi:[0,1,1]
    v_pk_fma_f32 v[214:215], v[42:43], v[106:107], v[214:215] op_sel_hi:[0,1,1]
    v_pk_mul_f32 v[212:213], v[42:43], v[212:213] op_sel:[1,0] op_sel_hi:[1,1]
    v_pk_mul_f32 v[214:215], v[42:43], v[214:215] op_sel:[1,0] op_sel_hi:[1,1]
    v_cvt_pk_bf16_f32 v72, v196, v197
    v_cvt_pk_bf16_f32 v73, v198, v199
    v_cvt_pk_bf16_f32 v74, v212, v213
    v_cvt_pk_bf16_f32 v75, v214, v215
    v_pk_max_i16 v72, v72, 0
    v_pk_max_i16 v73, v73, 0
    v_pk_max_i16 v74, v74, 0
    v_pk_max_i16 v75, v75, 0
    s_nop 1
    v_permlane16_swap_b32 v72, v74
    v_permlane16_swap_b32 v73, v75
    s_nop 0
    buffer_store_dwordx4 v[72:75], v36, s[28:31], s77 offen sc1
    v_pk_fma_f32 v[224:225], v[40:41], v[108:109], v[224:225] op_sel_hi:[0,1,1]
    v_pk_fma_f32 v[226:227], v[40:41], v[110:111], v[226:227] op_sel_hi:[0,1,1]
    v_pk_mul_f32 v[224:225], v[40:41], v[224:225] op_sel:[1,0] op_sel_hi:[1,1]
    v_pk_mul_f32 v[226:227], v[40:41], v[226:227] op_sel:[1,0] op_sel_hi:[1,1]
    v_pk_fma_f32 v[228:229], v[42:43], v[108:109], v[228:229] op_sel_hi:[0,1,1]
    v_pk_fma_f32 v[230:231], v[42:43], v[110:111], v[230:231] op_sel_hi:[0,1,1]
    v_pk_mul_f32 v[228:229], v[42:43], v[228:229] op_sel:[1,0] op_sel_hi:[1,1]
    v_pk_mul_f32 v[230:231], v[42:43], v[230:231] op_sel:[1,0] op_sel_hi:[1,1]
    v_cvt_pk_bf16_f32 v76, v224, v225
    v_cvt_pk_bf16_f32 v77, v226, v227
    v_cvt_pk_bf16_f32 v78, v228, v229
    v_cvt_pk_bf16_f32 v79, v230, v231
    v_pk_max_i16 v76, v76, 0
    v_pk_max_i16 v77, v77, 0
    v_pk_max_i16 v78, v78, 0
    v_pk_max_i16 v79, v79, 0
    s_nop 1
    v_permlane16_swap_b32 v76, v78
    v_permlane16_swap_b32 v77, v79
    s_nop 0
    buffer_store_dwordx4 v[76:79], v33, s[28:31], s76 offen sc1
    v_pk_fma_f32 v[136:137], v[44:45], v[84:85], v[136:137] op_sel_hi:[0,1,1]
    v_pk_fma_f32 v[138:139], v[44:45], v[86:87], v[138:139] op_sel_hi:[0,1,1]
    v_pk_mul_f32 v[136:137], v[44:45], v[136:137] op_sel:[1,0] op_sel_hi:[1,1]
    v_pk_mul_f32 v[138:139], v[44:45], v[138:139] op_sel:[1,0] op_sel_hi:[1,1]
    v_pk_fma_f32 v[152:153], v[44:45], v[88:89], v[152:153] op_sel_hi:[0,1,1]
    v_pk_fma_f32 v[154:155], v[44:45], v[90:91], v[154:155] op_sel_hi:[0,1,1]
    v_pk_mul_f32 v[152:153], v[44:45], v[152:153] op_sel:[1,0] op_sel_hi:[1,1]
    v_pk_mul_f32 v[154:155], v[44:45], v[154:155] op_sel:[1,0] op_sel_hi:[1,1]
    v_cvt_pk_bf16_f32 v80, v136, v137
    v_cvt_pk_bf16_f32 v81, v138, v139
    v_cvt_pk_bf16_f32 v82, v152, v153
    v_cvt_pk_bf16_f32 v83, v154, v155
    v_pk_max_i16 v80, v80, 0
    v_pk_max_i16 v81, v81, 0
    v_pk_max_i16 v82, v82, 0
    v_pk_max_i16 v83, v83, 0
    s_nop 1
    v_permlane16_swap_b32 v80, v82
    v_permlane16_swap_b32 v81, v83
    s_nop 0
    buffer_store_dwordx4 v[80:83], v34, s[28:31], s78 offen sc1
    v_pk_fma_f32 v[168:169], v[44:45], v[92:93], v[168:169] op_sel_hi:[0,1,1]
    v_pk_fma_f32 v[170:171], v[44:45], v[94:95], v[170:171] op_sel_hi:[0,1,1]
    v_pk_mul_f32 v[168:169], v[44:45], v[168:169] op_sel:[1,0] op_sel_hi:[1,1]
    v_pk_mul_f32 v[170:171], v[44:45], v[170:171] op_sel:[1,0] op_sel_hi:[1,1]
    v_pk_fma_f32 v[184:185], v[44:45], v[96:97], v[184:185] op_sel_hi:[0,1,1]
    v_pk_fma_f32 v[186:187], v[44:45], v[98:99], v[186:187] op_sel_hi:[0,1,1]
    v_pk_mul_f32 v[184:185], v[44:45], v[184:185] op_sel:[1,0] op_sel_hi:[1,1]
    v_pk_mul_f32 v[186:187], v[44:45], v[186:187] op_sel:[1,0] op_sel_hi:[1,1]
    v_cvt_pk_bf16_f32 v52, v168, v169
    v_cvt_pk_bf16_f32 v53, v170, v171
    v_cvt_pk_bf16_f32 v54, v184, v185
    v_cvt_pk_bf16_f32 v55, v186, v187
    v_pk_max_i16 v52, v52, 0
    v_pk_max_i16 v53, v53, 0
    v_pk_max_i16 v54, v54, 0
    v_pk_max_i16 v55, v55, 0
    s_nop 1
    v_permlane16_swap_b32 v52, v54
    v_permlane16_swap_b32 v53, v55
    s_nop 0
    buffer_store_dwordx4 v[52:55], v35, s[28:31], s78 offen sc1
    v_pk_fma_f32 v[200:201], v[44:45], v[100:101], v[200:201] op_sel_hi:[0,1,1]
    v_pk_fma_f32 v[202:203], v[44:45], v[102:103], v[202:203] op_sel_hi:[0,1,1]
    v_pk_mul_f32 v[200:201], v[44:45], v[200:201] op_sel:[1,0] op_sel_hi:[1,1]
    v_pk_mul_f32 v[202:203], v[44:45], v[202:203] op_sel:[1,0] op_sel_hi:[1,1]
    v_pk_fma_f32 v[216:217], v[44:45], v[104:105], v[216:217] op_sel_hi:[0,1,1]
    v_pk_fma_f32 v[218:219], v[44:45], v[106:107], v[218:219] op_sel_hi:[0,1,1]
    v_pk_mul_f32 v[216:217], v[44:45], v[216:217] op_sel:[1,0] op_sel_hi:[1,1]
    v_pk_mul_f32 v[218:219], v[44:45], v[218:219] op_sel:[1,0] op_sel_hi:[1,1]
    v_cvt_pk_bf16_f32 v56, v200, v201
    v_cvt_pk_bf16_f32 v57, v202, v203
    v_cvt_pk_bf16_f32 v58, v216, v217
    v_cvt_pk_bf16_f32 v59, v218, v219
    v_pk_max_i16 v56, v56, 0
    v_pk_max_i16 v57, v57, 0
    v_pk_max_i16 v58, v58, 0
    v_pk_max_i16 v59, v59, 0
    s_nop 1
    v_permlane16_swap_b32 v56, v58
    v_permlane16_swap_b32 v57, v59
    s_nop 0
    buffer_store_dwordx4 v[56:59], v36, s[28:31], s78 offen sc1
    v_pk_fma_f32 v[140:141], v[46:47], v[84:85], v[140:141] op_sel_hi:[0,1,1]
    v_pk_fma_f32 v[142:143], v[46:47], v[86:87], v[142:143] op_sel_hi:[0,1,1]
    v_pk_mul_f32 v[140:141], v[46:47], v[140:141] op_sel:[1,0] op_sel_hi:[1,1]
    v_pk_mul_f32 v[142:143], v[46:47], v[142:143] op_sel:[1,0] op_sel_hi:[1,1]
    v_pk_fma_f32 v[156:157], v[46:47], v[88:89], v[156:157] op_sel_hi:[0,1,1]
    v_pk_fma_f32 v[158:159], v[46:47], v[90:91], v[158:159] op_sel_hi:[0,1,1]
    v_pk_mul_f32 v[156:157], v[46:47], v[156:157] op_sel:[1,0] op_sel_hi:[1,1]
    v_pk_mul_f32 v[158:159], v[46:47], v[158:159] op_sel:[1,0] op_sel_hi:[1,1]
    v_cvt_pk_bf16_f32 v60, v140, v141
    v_cvt_pk_bf16_f32 v61, v142, v143
    v_cvt_pk_bf16_f32 v62, v156, v157
    v_cvt_pk_bf16_f32 v63, v158, v159
    v_pk_max_i16 v60, v60, 0
    v_pk_max_i16 v61, v61, 0
    v_pk_max_i16 v62, v62, 0
    v_pk_max_i16 v63, v63, 0
    s_nop 1
    v_permlane16_swap_b32 v60, v62
    v_permlane16_swap_b32 v61, v63
    s_nop 0
    buffer_store_dwordx4 v[60:63], v34, s[28:31], s79 offen sc1
    v_pk_fma_f32 v[172:173], v[46:47], v[92:93], v[172:173] op_sel_hi:[0,1,1]
    v_pk_fma_f32 v[174:175], v[46:47], v[94:95], v[174:175] op_sel_hi:[0,1,1]
    v_pk_mul_f32 v[172:173], v[46:47], v[172:173] op_sel:[1,0] op_sel_hi:[1,1]
    v_pk_mul_f32 v[174:175], v[46:47], v[174:175] op_sel:[1,0] op_sel_hi:[1,1]
    v_pk_fma_f32 v[188:189], v[46:47], v[96:97], v[188:189] op_sel_hi:[0,1,1]
    v_pk_fma_f32 v[190:191], v[46:47], v[98:99], v[190:191] op_sel_hi:[0,1,1]
    v_pk_mul_f32 v[188:189], v[46:47], v[188:189] op_sel:[1,0] op_sel_hi:[1,1]
    v_pk_mul_f32 v[190:191], v[46:47], v[190:191] op_sel:[1,0] op_sel_hi:[1,1]
    v_cvt_pk_bf16_f32 v64, v172, v173
    v_cvt_pk_bf16_f32 v65, v174, v175
    v_cvt_pk_bf16_f32 v66, v188, v189
    v_cvt_pk_bf16_f32 v67, v190, v191
    v_pk_max_i16 v64, v64, 0
    v_pk_max_i16 v65, v65, 0
    v_pk_max_i16 v66, v66, 0
    v_pk_max_i16 v67, v67, 0
    s_nop 1
    v_permlane16_swap_b32 v64, v66
    v_permlane16_swap_b32 v65, v67
    s_nop 0
    buffer_store_dwordx4 v[64:67], v35, s[28:31], s79 offen sc1
    v_pk_fma_f32 v[204:205], v[46:47], v[100:101], v[204:205] op_sel_hi:[0,1,1]
    v_pk_fma_f32 v[206:207], v[46:47], v[102:103], v[206:207] op_sel_hi:[0,1,1]
    v_pk_mul_f32 v[204:205], v[46:47], v[204:205] op_sel:[1,0] op_sel_hi:[1,1]
    v_pk_mul_f32 v[206:207], v[46:47], v[206:207] op_sel:[1,0] op_sel_hi:[1,1]
    v_pk_fma_f32 v[220:221], v[46:47], v[104:105], v[220:221] op_sel_hi:[0,1,1]
    v_pk_fma_f32 v[222:223], v[46:47], v[106:107], v[222:223] op_sel_hi:[0,1,1]
    v_pk_mul_f32 v[220:221], v[46:47], v[220:221] op_sel:[1,0] op_sel_hi:[1,1]
    v_pk_mul_f32 v[222:223], v[46:47], v[222:223] op_sel:[1,0] op_sel_hi:[1,1]
    v_cvt_pk_bf16_f32 v68, v204, v205
    v_cvt_pk_bf16_f32 v69, v206, v207
    v_cvt_pk_bf16_f32 v70, v220, v221
    v_cvt_pk_bf16_f32 v71, v222, v223
    v_pk_max_i16 v68, v68, 0
    v_pk_max_i16 v69, v69, 0
    v_pk_max_i16 v70, v70, 0
    v_pk_max_i16 v71, v71, 0
    s_nop 1
    v_permlane16_swap_b32 v68, v70
    v_permlane16_swap_b32 v69, v71
    s_nop 0
    buffer_store_dwordx4 v[68:71], v36, s[28:31], s79 offen sc1
    v_pk_fma_f32 v[232:233], v[44:45], v[108:109], v[232:233] op_sel_hi:[0,1,1]
    v_pk_fma_f32 v[234:235], v[44:45], v[110:111], v[234:235] op_sel_hi:[0,1,1]
    v_pk_mul_f32 v[232:233], v[44:45], v[232:233] op_sel:[1,0] op_sel_hi:[1,1]
    v_pk_mul_f32 v[234:235], v[44:45], v[234:235] op_sel:[1,0] op_sel_hi:[1,1]
    v_pk_fma_f32 v[236:237], v[46:47], v[108:109], v[236:237] op_sel_hi:[0,1,1]
    v_pk_fma_f32 v[238:239], v[46:47], v[110:111], v[238:239] op_sel_hi:[0,1,1]
    v_pk_mul_f32 v[236:237], v[46:47], v[236:237] op_sel:[1,0] op_sel_hi:[1,1]
    v_pk_mul_f32 v[238:239], v[46:47], v[238:239] op_sel:[1,0] op_sel_hi:[1,1]
    v_cvt_pk_bf16_f32 v72, v232, v233
    v_cvt_pk_bf16_f32 v73, v234, v235
    v_cvt_pk_bf16_f32 v74, v236, v237
    v_cvt_pk_bf16_f32 v75, v238, v239
    v_pk_max_i16 v72, v72, 0
    v_pk_max_i16 v73, v73, 0
    v_pk_max_i16 v74, v74, 0
    v_pk_max_i16 v75, v75, 0
    s_nop 1
    v_permlane16_swap_b32 v72, v74
    v_permlane16_swap_b32 v73, v75
    s_nop 0
    buffer_store_dwordx4 v[72:75], v33, s[28:31], s78 offen sc1
    s_lshl_b32 s58, s23, 2
    s_add_u32 s58, s58, s72
    s_lshl_b32 s58, s58, 8
    s_add_u32 s58, s58, 0x3810000
    s_lshl_b32 s63, s74, 2
    s_add_u32 s83, s63, s58
    s_mul_i32 s61, s23, 2359296
    s_lshl_b32 s60, s72, 13
    s_add_u32 s54, s61, s60
    s_add_u32 s61, s61, 0x8000
    s_mul_i32 s60, s72, 28672
    s_add_u32 s48, s61, s60
    s_mov_b32 s59, 0xff
    v_lshrrev_b32 v25, 5, v2
    v_mul_u32_u24 v25, 0x24000, v25
    v_and_b32 v26, 31, v2
    v_lshl_add_u32 v25, v26, 4, v25
    s_mul_i32 s60, s20, 294912
    v_add_u32 v20, s60, v25
    v_add_u32 v21, 0x200, v20
    v_and_b32 v6, 7, v2
    v_lshlrev_b32 v6, 2, v6
    v_mov_b32 v32, 0x27c00
    v_mov_b32 v33, 1
    v_lshrrev_b32 v23, 1, v4
    v_and_b32 v24, 1, v4
    v_lshlrev_b32 v24, 4, v24
    v_lshl_add_u32 v23, v23, 13, v24
    v_lshl_add_u32 v23, v3, 5, v23
    s_lshl_b32 s60, s85, 11
    s_lshl_b32 s61, s72, 9
    s_add_u32 s60, s60, s61
    v_add_u32 v8, s60, v23
    v_xor_b32 v9, 0x200, v8
    v_xor_b32 v10, 0x400, v8
    v_xor_b32 v11, 0x600, v8
    v_add_u32 v12, 0x12000, v8
    v_add_u32 v13, 0x12000, v9
    v_add_u32 v14, 0x12000, v10
    v_add_u32 v15, 0x12000, v11
    v_lshrrev_b32 v23, 2, v3
    v_lshl_add_u32 v23, v4, 2, v23
    v_and_b32 v24, 6, v23
    v_and_b32 v25, 3, v3
    v_lshlrev_b32 v25, 3, v25
    v_lshl_add_u32 v25, v23, 7, v25
    s_lshl_b32 s60, s86, 12
    s_add_u32 s60, s60, 0x4000
    v_add_u32 v25, s60, v25
    v_xor_b32 v26, 0, v24
    v_lshl_add_u32 v16, v26, 4, v25
    v_add_u32 v28, 0x12000, v16
    v_xor_b32 v26, 2, v24
    v_lshl_add_u32 v17, v26, 4, v25
    v_add_u32 v29, 0x12000, v17
    v_xor_b32 v26, 4, v24
    v_lshl_add_u32 v18, v26, 4, v25
    v_add_u32 v30, 0x12000, v18
    v_xor_b32 v26, 6, v24
    v_lshl_add_u32 v19, v26, 4, v25
    v_add_u32 v31, 0x12000, v19
    s_waitcnt vmcnt(0)
    s_mov_b64 exec, 1
    ds_add_rtn_u32 v7, v32, v33
    s_waitcnt lgkmcnt(0)
    v_readfirstlane_b32 s60, v7
    s_mov_b64 exec, -1
    s_nop 1
    s_cmp_lg_u32 s60, 3
    s_cbranch_scc1 L_h_nopub
    v_mov_b32 v7, 1
    s_mov_b64 exec, 1
    buffer_store_dword v7, off, s[28:31], s83 sc1
    s_mov_b64 exec, -1
    s_mov_b32 s62, 0
L_p2_p1:
    buffer_load_dword v5, v6, s[28:31], s58 offen offset:0 sc1
    s_waitcnt vmcnt(0)
L_p2_p1chk:
    v_cmp_eq_u32 vcc, 1, v5
    s_nop 3
    s_and_b32 s63, vcc_lo, s59
    s_cmp_eq_u32 s63, s59
    s_cbranch_scc1 L_p2_p1ok
    s_sleep 1
    s_add_u32 s62, s62, 1
    s_cmp_lt_u32 s62, 0x20000
    s_cbranch_scc1 L_p2_p1
L_p2_p1ok:
    s_mov_b64 exec, 1
    ds_write_b32 v32, v33 offset:8
    s_mov_b64 exec, -1
    s_branch L_h_go
L_h_nopub:
    s_mov_b32 s61, 0
L_h_spin:
    s_sleep 1
    ds_read_b32 v7, v32 offset:8
    s_waitcnt lgkmcnt(0)
    v_readfirstlane_b32 s60, v7
    s_add_u32 s61, s61, 1
    s_cmp_eq_u32 s60, 1
    s_cbranch_scc1 L_h_go
    s_cmp_lt_u32 s61, 0x200000
    s_cbranch_scc1 L_h_spin
L_h_go:
    s_mul_i32 s60, s21, 589824
    s_mul_i32 s61, s20, 294912
    s_sub_u32 s60, s60, s61
    v_add_u32 v24, s60, v20
    v_add_u32 v25, 0x200, v24
    v_add_u32 v26, 0x48000, v24
    v_add_u32 v27, 0x200, v26
    s_lshl_b32 s60, s21, 11
    s_add_u32 m0, s60, 0x0
    s_nop 0
    buffer_load_dwordx4 v24, s[28:31], s48 offen lds
    s_add_u32 m0, s60, 0x2000
    s_nop 0
    buffer_load_dwordx4 v25, s[28:31], s48 offen lds
    s_add_u32 m0, s60, 0x400
    s_nop 0
    buffer_load_dwordx4 v26, s[28:31], s48 offen lds
    s_add_u32 m0, s60, 0x2400
    s_nop 0
    buffer_load_dwordx4 v27, s[28:31], s48 offen lds
    s_add_u32 s48, s48, 1024
    s_add_u32 m0, s60, 0x6000
    s_nop 0
    buffer_load_dwordx4 v24, s[28:31], s48 offen lds
    s_add_u32 m0, s60, 0x8000
    s_nop 0
    buffer_load_dwordx4 v25, s[28:31], s48 offen lds
    s_add_u32 m0, s60, 0x6400
    s_nop 0
    buffer_load_dwordx4 v26, s[28:31], s48 offen lds
    s_add_u32 m0, s60, 0x8400
    s_nop 0
    buffer_load_dwordx4 v27, s[28:31], s48 offen lds
    s_add_u32 s48, s48, 1024
    s_add_u32 m0, s60, 0xc000
    s_nop 0
    buffer_load_dwordx4 v24, s[28:31], s48 offen lds
    s_add_u32 m0, s60, 0xe000
    s_nop 0
    buffer_load_dwordx4 v25, s[28:31], s48 offen lds
    s_add_u32 m0, s60, 0xc400
    s_nop 0
    buffer_load_dwordx4 v26, s[28:31], s48 offen lds
    s_add_u32 m0, s60, 0xe400
    s_nop 0
    buffer_load_dwordx4 v27, s[28:31], s48 offen lds
    s_add_u32 s48, s48, 1024
    s_mov_b32 s82, 3
    s_setprio 0
    s_branch L_phase2
L_q_start:
    v_lshrrev_b32 v31, 3, v2
    v_and_b32 v32, 7, v2
    v_xor_b32 v33, v32, v31
    v_lshlrev_b32 v33, 4, v33
    s_lshl_b32 s60, s20, 5
    v_add_u32 v34, s60, v31
    v_lshl_add_u32 v24, v34, 11, v33
    v_add_u32 v25, 0x4000, v24
    v_add_u32 v26, 0x8000, v24
    v_add_u32 v27, 0xc000, v24
    s_lshl_b32 s50, s23, 19
    s_lshl_b32 s52, s20, 12
    v_lshrrev_b32 v33, 2, v31
    v_and_b32 v34, 3, v31
    v_lshl_add_u32 v33, v33, 3, v34
    v_and_b32 v34, 6, v31
    v_xor_b32 v34, v34, v32
    v_lshlrev_b32 v34, 4, v34
    s_mov_b32 s62, 6144
    s_and_b32 s60, s21, 1
    s_lshl_b32 s61, s60, 2
    v_add_u32 v33, s61, v33
    v_mul_lo_u32 v33, v33, s62
    v_and_b32 v35, 0x30, v34
    v_lshrrev_b32 v34, 6, v34
    v_lshl_add_u32 v34, v34, 11, v35
    v_add_u32 v36, v33, v34
    v_add_u32 v37, 0x18000, v36
    v_lshrrev_b32 v33, 2, v2
    v_lshrrev_b32 v34, 2, v33
    v_and_b32 v35, 3, v33
    v_lshl_add_u32 v34, v34, 3, v35
    v_mul_lo_u32 v34, v34, s62
    v_lshrrev_b32 v33, 1, v33
    v_and_b32 v33, 2, v33
    v_and_b32 v35, 3, v2
    v_xor_b32 v33, v33, v35
    v_lshl_add_u32 v34, v33, 4, v34
    v_add_u32 v34, 0x1000, v34
    v_add_u32 v35, 0x6000, v34
    s_cmp_ge_u32 s21, 2
    s_cselect_b64 vcc, -1, 0
    v_cndmask_b32 v28, v36, v34, vcc
    v_cndmask_b32 v29, v37, v35, vcc
    s_mul_i32 s61, s60, 7168
    s_cselect_b32 s53, 2048, s61
    s_add_u32 s61, s61, 1024
    s_cmp_ge_u32 s21, 2
    s_cselect_b32 s56, 0x2400, s61
    s_add_u32 s53, s53, 0x19800
    s_add_u32 s56, s56, 0x19800
    s_lshl_b32 s51, s24, 6
    v_and_b32 v35, 1, v31
    s_lshl_b32 s60, s20, 1
    v_add_u32 v33, s60, v35
    v_and_b32 v34, 7, v33
    v_xor_b32 v34, v34, v32
    v_lshlrev_b32 v34, 4, v34
    v_lshl_add_u32 v30, v33, 11, v34
    s_lshl_b32 s55, s23, 8
    s_sub_i32 s55, s55, 16
    s_max_i32 s55, s55, 0
    s_mov_b32 s77, s55
    s_lshl_b32 s55, s55, 11
    s_lshl_b32 s57, s20, 8
    s_add_u32 s57, s57, 0x8000
    s_lshl_b32 s60, s23, 5
    s_add_u32 s60, s60, s24
    s_lshl_b32 s60, s60, 2
    s_add_u32 s60, s60, s21
    s_lshl_b32 s76, s60, 1
    s_lshl_b32 s78, s76, 11
    v_lshlrev_b32 v5, 6, v2
    s_lshl_b32 s60, s2, 2
    s_add_u32 s60, s60, s21
    s_lshl_b32 s91, s60, 13
    s_mul_i32 s89, s60, 2731
    s_lshr_b32 s89, s89, 16
    s_sub_i32 s89, s89, 8
    s_max_i32 s89, s89, 0
    s_and_b32 s90, s60, 15
    s_min_u32 s90, s90, 15
    s_add_u32 s90, s90, 8
    v_lshlrev_b32 v253, 7, v2
    s_waitcnt lgkmcnt(0)
    s_mov_b32 s32, s4
    s_mov_b32 s33, s5
    s_mov_b32 s34, 0x400000
    s_mov_b32 s35, 0x20000
    s_mov_b32 s36, s6
    s_mov_b32 s37, s7
    s_mov_b32 s38, 0x600000
    s_mov_b32 s39, 0x20000
    s_add_u32 m0, s52, 0x0
    s_nop 0
    buffer_load_dwordx4 v24, s[32:35], s50 offen lds
    s_add_u32 m0, s52, 0x400
    s_nop 0
    buffer_load_dwordx4 v25, s[32:35], s50 offen lds
    s_add_u32 m0, s57, 0x0
    s_mov_b64 exec, 0xffff
    buffer_load_dwordx4 v30, s[32:35], s55 offen lds
    s_mov_b64 exec, -1
    s_add_u32 m0, s53, 0x0
    s_nop 0
    buffer_load_dwordx4 v28, s[36:39], s51 offen lds
    s_add_u32 m0, s56, 0x0
    s_nop 0
    buffer_load_dwordx4 v29, s[36:39], s51 offen lds
    s_add_u32 s51, s51, 0x30000
    s_add_u32 m0, s52, 0x800
    s_nop 0
    buffer_load_dwordx4 v26, s[32:35], s50 offen lds
    s_add_u32 m0, s52, 0xc00
    s_nop 0
    buffer_load_dwordx4 v27, s[32:35], s50 offen lds
    s_add_u32 s50, s50, 128
    s_add_u32 s55, s55, 128
    s_add_u32 m0, s53, 0x3800
    s_nop 0
    buffer_load_dwordx4 v28, s[36:39], s51 offen lds
    s_add_u32 m0, s56, 0x3800
    s_nop 0
    buffer_load_dwordx4 v29, s[36:39], s51 offen lds
    s_add_u32 s51, s51, 0x30000
    s_mov_b32 s28, s18
    s_mov_b32 s29, s19
    s_mov_b32 s30, 0x4000000
    s_mov_b32 s31, 0x20000
    s_mov_b32 s40, s16
    s_mov_b32 s41, s17
    s_mov_b32 s42, 0x100
    s_mov_b32 s43, 0x20000
    s_mov_b32 s44, s14
    s_mov_b32 s45, s15
    s_mov_b32 s46, 0x400000
    s_mov_b32 s47, 0x20000
    s_cmp_lg_u32 s20, 0
    s_cbranch_scc1 L_q_nozero
    v_mov_b32 v31, 0
    v_lshlrev_b32 v32, 2, v2
    v_lshlrev_b32 v33, 7, v2
    v_mov_b32 v34, 0x27c00
    s_lshl_b32 s60, s75, 10
    s_add_u32 s60, s60, 0x3820000
    s_lshl_b32 s61, s23, 2
    s_add_u32 s61, s61, s72
    s_lshl_b32 s61, s61, 6
    s_add_u32 s61, s61, s74
    s_lshl_b32 s61, s61, 2
    s_add_u32 s61, s61, 0x3810000
    s_mov_b64 exec, 0xff
    buffer_store_dword v31, v33, s[28:31], s60 offen sc1
    s_mov_b64 exec, 3
    buffer_store_dword v31, v33, s[28:31], s61 offen sc1
    s_mov_b64 exec, 1
    ds_write_b32 v34, v31
    ds_write_b32 v34, v31 offset:4
    ds_write_b32 v34, v31 offset:8
    s_mov_b64 exec, -1
L_q_nozero:
    v_and_b32 v31, 7, v3
    v_xor_b32 v31, v31, v4
    v_lshlrev_b32 v31, 4, v31
    v_lshl_add_u32 v31, v3, 7, v31
    s_lshl_b32 s60, s21, 13
    v_add_u32 v16, s60, v31
    v_xor_b32 v17, 64, v16
    v_add_u32 v20, 0x8000, v31
    v_xor_b32 v21, 64, v20
    v_lshrrev_b32 v31, 2, v3
    v_lshl_add_u32 v31, v4, 2, v31
    v_and_b32 v32, 6, v31
    v_and_b32 v33, 3, v3
    v_lshlrev_b32 v33, 3, v33
    v_lshl_add_u32 v33, v31, 7, v33
    v_add_u32 v33, 0x19800, v33
    v_and_b32 v35, 3, v3
    v_lshlrev_b32 v35, 3, v35
    v_lshl_add_u32 v35, v31, 6, v35
    v_add_u32 v35, 0x1a000, v35
    v_lshrrev_b32 v31, 1, v31
    v_and_b32 v31, 2, v31
    s_add_u32 s60, s21, 2
    s_sub_u32 s61, s60, 6
    s_cmp_ge_u32 s60, 6
    s_cselect_b32 s64, s61, s60
    s_and_b32 s60, s64, 3
    s_lshl_b32 s60, s60, 1
    v_xor_b32 v34, s60, v32
    v_lshl_add_u32 v34, v34, 4, v33
    v_xor_b32 v8, s60, v31
    v_lshl_add_u32 v8, v8, 4, v35
    s_cmp_ge_u32 s64, 4
    s_cselect_b64 vcc, -1, 0
    v_cndmask_b32 v8, v34, v8, vcc
    s_add_u32 s60, s21, 3
    s_sub_u32 s61, s60, 6
    s_cmp_ge_u32 s60, 6
    s_cselect_b32 s65, s61, s60
    s_and_b32 s60, s65, 3
    s_lshl_b32 s60, s60, 1
    v_xor_b32 v34, s60, v32
    v_lshl_add_u32 v34, v34, 4, v33
    v_xor_b32 v9, s60, v31
    v_lshl_add_u32 v9, v9, 4, v35
    s_cmp_ge_u32 s65, 4
    s_cselect_b64 vcc, -1, 0
    v_cndmask_b32 v9, v34, v9, vcc
    s_add_u32 s60, s21, 4
    s_sub_u32 s61, s60, 6
    s_cmp_ge_u32 s60, 6
    s_cselect_b32 s66, s61, s60
    s_and_b32 s60, s66, 3
    s_lshl_b32 s60, s60, 1
    v_xor_b32 v34, s60, v32
    v_lshl_add_u32 v34, v34, 4, v33
    v_xor_b32 v10, s60, v31
    v_lshl_add_u32 v10, v10, 4, v35
    s_cmp_ge_u32 s66, 4
    s_cselect_b64 vcc, -1, 0
    v_cndmask_b32 v10, v34, v10, vcc
    s_add_u32 s60, s21, 5
    s_sub_u32 s61, s60, 6
    s_cmp_ge_u32 s60, 6
    s_cselect_b32 s67, s61, s60
    s_and_b32 s60, s67, 3
    s_lshl_b32 s60, s60, 1
    v_xor_b32 v34, s60, v32
    v_lshl_add_u32 v34, v34, 4, v33
    v_xor_b32 v11, s60, v31
    v_lshl_add_u32 v11, v11, 4, v35
    s_cmp_ge_u32 s67, 4
    s_cselect_b64 vcc, -1, 0
    v_cndmask_b32 v11, v34, v11, vcc
    s_add_u32 s60, s21, 6
    s_sub_u32 s61, s60, 6
    s_cmp_ge_u32 s60, 6
    s_cselect_b32 s68, s61, s60
    s_and_b32 s60, s68, 3
    s_lshl_b32 s60, s60, 1
    v_xor_b32 v34, s60, v32
    v_lshl_add_u32 v34, v34, 4, v33
    v_xor_b32 v12, s60, v31
    v_lshl_add_u32 v12, v12, 4, v35
    s_cmp_ge_u32 s68, 4
    s_cselect_b64 vcc, -1, 0
    v_cndmask_b32 v12, v34, v12, vcc
    s_add_u32 s60, s21, 7
    s_sub_u32 s61, s60, 6
    s_cmp_ge_u32 s60, 6
    s_cselect_b32 s69, s61, s60
    s_and_b32 s60, s69, 3
    s_lshl_b32 s60, s60, 1
    v_xor_b32 v34, s60, v32
    v_lshl_add_u32 v34, v34, 4, v33
    v_xor_b32 v13, s60, v31
    v_lshl_add_u32 v13, v13, 4, v35
    s_cmp_ge_u32 s69, 4
    s_cselect_b64 vcc, -1, 0
    v_cndmask_b32 v13, v34, v13, vcc
    v_mov_b32 v128, 0
    v_mov_b32 v129, 0
    v_mov_b32 v130, 0
    v_mov_b32 v131, 0
    v_mov_b32 v132, 0
    v_mov_b32 v133, 0
    v_mov_b32 v134, 0
    v_mov_b32 v135, 0
    v_mov_b32 v136, 0
    v_mov_b32 v137, 0
    v_mov_b32 v138, 0
    v_mov_b32 v139, 0
    v_mov_b32 v140, 0
    v_mov_b32 v141, 0
    v_mov_b32 v142, 0
    v_mov_b32 v143, 0
    v_mov_b32 v144, 0
    v_mov_b32 v145, 0
    v_mov_b32 v146, 0
    v_mov_b32 v147, 0
    v_mov_b32 v148, 0
    v_mov_b32 v149, 0
    v_mov_b32 v150, 0
    v_mov_b32 v151, 0
    v_mov_b32 v152, 0
    v_mov_b32 v153, 0
    v_mov_b32 v154, 0
    v_mov_b32 v155, 0
    v_mov_b32 v156, 0
    v_mov_b32 v157, 0
    v_mov_b32 v158, 0
    v_mov_b32 v159, 0
    v_mov_b32 v160, 0
    v_mov_b32 v161, 0
    v_mov_b32 v162, 0
    v_mov_b32 v163, 0
    v_mov_b32 v164, 0
    v_mov_b32 v165, 0
    v_mov_b32 v166, 0
    v_mov_b32 v167, 0
    v_mov_b32 v168, 0
    v_mov_b32 v169, 0
    v_mov_b32 v170, 0
    v_mov_b32 v171, 0
    v_mov_b32 v172, 0
    v_mov_b32 v173, 0
    v_mov_b32 v174, 0
    v_mov_b32 v175, 0
    v_mov_b32 v176, 0
    v_mov_b32 v177, 0
    v_mov_b32 v178, 0
    v_mov_b32 v179, 0
    v_mov_b32 v180, 0
    v_mov_b32 v181, 0
    v_mov_b32 v182, 0
    v_mov_b32 v183, 0
    v_mov_b32 v184, 0
    v_mov_b32 v185, 0
    v_mov_b32 v186, 0
    v_mov_b32 v187, 0
    v_mov_b32 v188, 0
    v_mov_b32 v189, 0
    v_mov_b32 v190, 0
    v_mov_b32 v191, 0
    v_mov_b32 v192, 0
    v_mov_b32 v193, 0
    v_mov_b32 v194, 0
    v_mov_b32 v195, 0
    v_mov_b32 v196, 0
    v_mov_b32 v197, 0
    v_mov_b32 v198, 0
    v_mov_b32 v199, 0
    v_mov_b32 v200, 0
    v_mov_b32 v201, 0
    v_mov_b32 v202, 0
    v_mov_b32 v203, 0
    v_mov_b32 v204, 0
    v_mov_b32 v205, 0
    v_mov_b32 v206, 0
    v_mov_b32 v207, 0
    v_mov_b32 v208, 0
    v_mov_b32 v209, 0
    v_mov_b32 v210, 0
    v_mov_b32 v211, 0
    v_mov_b32 v212, 0
    v_mov_b32 v213, 0
    v_mov_b32 v214, 0
    v_mov_b32 v215, 0
    v_mov_b32 v216, 0
    v_mov_b32 v217, 0
    v_mov_b32 v218, 0
    v_mov_b32 v219, 0
    v_mov_b32 v220, 0
    v_mov_b32 v221, 0
    v_mov_b32 v222, 0
    v_mov_b32 v223, 0
    v_mov_b32 v224, 0
    v_mov_b32 v225, 0
    v_mov_b32 v226, 0
    v_mov_b32 v227, 0
    v_mov_b32 v244, 0
    v_mov_b32 v245, 0
    v_mov_b32 v246, 0
    v_mov_b32 v247, 0
    v_mov_b32 v248, 0
    v_mov_b32 v249, 0
    v_mov_b32 v250, 0
    v_mov_b32 v251, 0
    v_mov_b32 v240, s71
    v_mov_b32 v241, s71
    v_mov_b32 v242, s71
    v_mov_b32 v243, s71
    s_waitcnt vmcnt(2)
    s_barrier
    ds_read_b128 v[40:43], v16 offset:0
    ds_read_b128 v[44:47], v16 offset:2048
    ds_read_b128 v[48:51], v16 offset:4096
    ds_read_b128 v[52:55], v16 offset:6144
    ds_read_b128 v[56:59], v20
    ds_read_b64_tr_b16 v[60:61], v8 offset:0
    ds_read_b64_tr_b16 v[62:63], v8 offset:7168
    ds_read_b64_tr_b16 v[64:65], v9 offset:0
    ds_read_b64_tr_b16 v[66:67], v9 offset:7168
    ds_read_b64_tr_b16 v[68:69], v10 offset:0
    ds_read_b64_tr_b16 v[70:71], v10 offset:7168
    ds_read_b64_tr_b16 v[72:73], v11 offset:0
    ds_read_b64_tr_b16 v[74:75], v11 offset:7168
    ds_read_b64_tr_b16 v[76:77], v12 offset:0
    ds_read_b64_tr_b16 v[78:79], v12 offset:7168
    ds_read_b64_tr_b16 v[80:81], v13 offset:0
    ds_read_b64_tr_b16 v[82:83], v13 offset:7168
    s_add_u32 m0, s52, 0x8800
    s_nop 0
    buffer_load_dwordx4 v24, s[32:35], s50 offen lds
    s_add_u32 m0, s52, 0x8c00
    s_nop 0
    buffer_load_dwordx4 v25, s[32:35], s50 offen lds
    s_add_u32 m0, s57, 0x8800
    s_mov_b64 exec, 0xffff
    buffer_load_dwordx4 v30, s[32:35], s55 offen lds
    s_mov_b64 exec, -1
    s_add_u32 m0, s53, 0x7000
    s_nop 0
    buffer_load_dwordx4 v28, s[36:39], s51 offen lds
    s_add_u32 m0, s56, 0x7000
    s_nop 0
    buffer_load_dwordx4 v29, s[36:39], s51 offen lds
    s_add_u32 s51, s51, 0x30000
    s_add_u32 m0, s52, 0x9000
    s_nop 0
    buffer_load_dwordx4 v26, s[32:35], s50 offen lds
    s_add_u32 m0, s52, 0x9400
    s_nop 0
    buffer_load_dwordx4 v27, s[32:35], s50 offen lds
    s_add_u32 s50, s50, 128
    s_add_u32 s55, s55, 128
    buffer_load_dwordx4 v[228:231], v5, s[32:35], s78 offen offset:0
    buffer_load_dwordx4 v[232:235], v5, s[32:35], s78 offen offset:16
    buffer_load_dwordx4 v[236:239], v5, s[32:35], s78 offen offset:32
    buffer_load_dwordx4 v[36:39], v5, s[32:35], s78 offen offset:48
    v_mov_b32 v19, v17
    v_mov_b32 v23, v21
    s_mov_b32 s48, 0
    s_add_u32 s49, s52, 0x11000
    s_mov_b32 s58, 0x11000
    s_lshl_b32 s76, s76, 3
    s_add_u32 s76, s76, 0x3800000
    s_waitcnt vmcnt(11) lgkmcnt(0)
    s_mov_b32 s54, 0
    s_mov_b32 s88, 0
    s_barrier
    v_mfma_f32_16x16x32_bf16 v[128:131], v[60:63], v[40:43], v[128:131]
    s_cmp_lg_u32 s88, s89
    s_cbranch_scc1 L_q_0pfa
    buffer_load_dword v252, v253, s[36:39], s91 offen

L_q_0pfa:
    s_add_u32 s88, s88, 1
    v_mfma_f32_16x16x32_bf16 v[132:135], v[60:63], v[44:47], v[132:135]
    s_add_u32 m0, s53, 0xa800
    ds_read_b128 v[84:87], v19 offset:0
    v_mfma_f32_16x16x32_bf16 v[136:139], v[60:63], v[48:51], v[136:139]
    buffer_load_dwordx4 v28, s[36:39], s51 offen lds
    ds_read_b128 v[88:91], v19 offset:2048
    v_mfma_f32_16x16x32_bf16 v[140:143], v[60:63], v[52:55], v[140:143]
    s_add_u32 m0, s56, 0xa800
    v_mfma_f32_16x16x32_bf16 v[224:227], v[60:63], v[56:59], v[224:227]
    ds_read_b128 v[92:95], v19 offset:4096
    buffer_load_dwordx4 v29, s[36:39], s51 offen lds
    v_mfma_f32_16x16x32_bf16 v[144:147], v[64:67], v[40:43], v[144:147]
    s_add_u32 s51, s51, 0x30000
    ds_read_b128 v[96:99], v19 offset:6144
    v_mfma_f32_16x16x32_bf16 v[148:151], v[64:67], v[44:47], v[148:151]
    s_add_u32 m0, s52, 0x11000
    v_mfma_f32_16x16x32_bf16 v[152:155], v[64:67], v[48:51], v[152:155]
    ds_read_b128 v[100:103], v23
    buffer_load_dwordx4 v24, s[32:35], s50 offen lds
    v_mfma_f32_16x16x32_bf16 v[244:247], v[60:63], v[240:243], v[244:247]
    ds_read_b64_tr_b16 v[104:105], v8 offset:14336
    s_add_u32 m0, s52, 0x11400
    v_mfma_f32_16x16x32_bf16 v[156:159], v[64:67], v[52:55], v[156:159]
    ds_read_b64_tr_b16 v[106:107], v8 offset:21504
    buffer_load_dwordx4 v25, s[32:35], s50 offen lds
    v_mfma_f32_16x16x32_bf16 v[160:163], v[68:71], v[40:43], v[160:163]
    ds_read_b64_tr_b16 v[108:109], v9 offset:14336
    v_mfma_f32_16x16x32_bf16 v[164:167], v[68:71], v[44:47], v[164:167]
    s_add_u32 m0, s57, 0x11000
    ds_read_b64_tr_b16 v[110:111], v9 offset:21504
    v_mfma_f32_16x16x32_bf16 v[168:171], v[68:71], v[48:51], v[168:171]
    s_mov_b64 exec, 0xffff
    buffer_load_dwordx4 v30, s[32:35], s55 offen lds
    s_mov_b64 exec, -1
    ds_read_b64_tr_b16 v[112:113], v10 offset:14336
    v_mfma_f32_16x16x32_bf16 v[172:175], v[68:71], v[52:55], v[172:175]
    s_add_u32 m0, s53, 0x0
    v_mfma_f32_16x16x32_bf16 v[176:179], v[72:75], v[40:43], v[176:179]
    ds_read_b64_tr_b16 v[114:115], v10 offset:21504
    buffer_load_dwordx4 v28, s[36:39], s51 offen lds
    v_mfma_f32_16x16x32_bf16 v[180:183], v[72:75], v[44:47], v[180:183]
    ds_read_b64_tr_b16 v[116:117], v11 offset:14336
    s_add_u32 m0, s56, 0x0
    v_mfma_f32_16x16x32_bf16 v[184:187], v[72:75], v[48:51], v[184:187]
    ds_read_b64_tr_b16 v[118:119], v11 offset:21504
    buffer_load_dwordx4 v29, s[36:39], s51 offen lds
    v_mfma_f32_16x16x32_bf16 v[248:251], v[76:79], v[240:243], v[248:251]
    s_add_u32 s51, s51, 0x30000
    v_mfma_f32_16x16x32_bf16 v[188:191], v[72:75], v[52:55], v[188:191]
    ds_read_b64_tr_b16 v[120:121], v12 offset:14336
    s_add_u32 m0, s49, 0x800
    v_mfma_f32_16x16x32_bf16 v[192:195], v[76:79], v[40:43], v[192:195]
    ds_read_b64_tr_b16 v[122:123], v12 offset:21504
    buffer_load_dwordx4 v26, s[32:35], s50 offen lds
    v_mfma_f32_16x16x32_bf16 v[196:199], v[76:79], v[44:47], v[196:199]
    ds_read_b64_tr_b16 v[124:125], v13 offset:14336
    v_mfma_f32_16x16x32_bf16 v[200:203], v[76:79], v[48:51], v[200:203]
    s_add_u32 m0, s49, 0xc00
    ds_read_b64_tr_b16 v[126:127], v13 offset:21504
    v_mfma_f32_16x16x32_bf16 v[204:207], v[76:79], v[52:55], v[204:207]
    buffer_load_dwordx4 v27, s[32:35], s50 offen lds
    s_add_u32 s50, s50, 128
    v_mfma_f32_16x16x32_bf16 v[208:211], v[80:83], v[40:43], v[208:211]
    s_add_u32 s55, s55, 128
    v_mfma_f32_16x16x32_bf16 v[212:215], v[80:83], v[44:47], v[212:215]
    v_mfma_f32_16x16x32_bf16 v[216:219], v[80:83], v[48:51], v[216:219]
    v_mfma_f32_16x16x32_bf16 v[220:223], v[80:83], v[52:55], v[220:223]
    s_waitcnt vmcnt(13) lgkmcnt(0)
    s_barrier
    v_mfma_f32_16x16x32_bf16 v[128:131], v[104:107], v[84:87], v[128:131]
    s_cmp_lg_u32 s88, s89
    s_cbranch_scc1 L_q_1pfa
    buffer_load_dword v252, v253, s[36:39], s91 offen

L_q_1pfa:
    s_add_u32 s88, s88, 1
    v_mfma_f32_16x16x32_bf16 v[132:135], v[104:107], v[88:91], v[132:135]
    s_mov_b32 s58, s48
    s_add_u32 s49, s48, s52
    v_mfma_f32_16x16x32_bf16 v[136:139], v[104:107], v[92:95], v[136:139]
    s_add_u32 s48, s48, 0x8800
    v_mfma_f32_16x16x32_bf16 v[140:143], v[104:107], v[96:99], v[140:143]
    s_cmp_eq_u32 s48, 0x19800
    s_cselect_b32 s48, 0, s48
    v_mfma_f32_16x16x32_bf16 v[224:227], v[104:107], v[100:103], v[224:227]
    v_add_u32 v18, s48, v16
    v_add_u32 v19, s48, v17
    v_mfma_f32_16x16x32_bf16 v[144:147], v[108:111], v[84:87], v[144:147]
    v_add_u32 v22, s48, v20
    v_mfma_f32_16x16x32_bf16 v[148:151], v[108:111], v[88:91], v[148:151]
    v_add_u32 v23, s48, v21
    s_add_u32 m0, s53, 0x3800
    v_mfma_f32_16x16x32_bf16 v[152:155], v[108:111], v[92:95], v[152:155]
    ds_read_b128 v[40:43], v18 offset:0
    v_mfma_f32_16x16x32_bf16 v[244:247], v[104:107], v[240:243], v[244:247]
    buffer_load_dwordx4 v28, s[36:39], s51 offen lds
    ds_read_b128 v[44:47], v18 offset:2048
    v_mfma_f32_16x16x32_bf16 v[156:159], v[108:111], v[96:99], v[156:159]
    ds_read_b128 v[48:51], v18 offset:4096
    s_add_u32 m0, s56, 0x3800
    v_mfma_f32_16x16x32_bf16 v[160:163], v[112:115], v[84:87], v[160:163]
    ds_read_b128 v[52:55], v18 offset:6144
    v_mfma_f32_16x16x32_bf16 v[164:167], v[112:115], v[88:91], v[164:167]
    buffer_load_dwordx4 v29, s[36:39], s51 offen lds
    s_add_u32 s51, s51, 0x30000
    v_mfma_f32_16x16x32_bf16 v[168:171], v[112:115], v[92:95], v[168:171]
    ds_read_b128 v[56:59], v22
    ds_read_b64_tr_b16 v[60:61], v8 offset:28672
    v_mfma_f32_16x16x32_bf16 v[172:175], v[112:115], v[96:99], v[172:175]
    s_add_u32 m0, s49, 0x0
    v_mfma_f32_16x16x32_bf16 v[176:179], v[116:119], v[84:87], v[176:179]
    ds_read_b64_tr_b16 v[62:63], v8 offset:35840
    buffer_load_dwordx4 v24, s[32:35], s50 offen lds
    v_mfma_f32_16x16x32_bf16 v[180:183], v[116:119], v[88:91], v[180:183]
    ds_read_b64_tr_b16 v[64:65], v9 offset:28672
    v_mfma_f32_16x16x32_bf16 v[184:187], v[116:119], v[92:95], v[184:187]
    ds_read_b64_tr_b16 v[66:67], v9 offset:35840
    s_add_u32 m0, s49, 0x400
    v_mfma_f32_16x16x32_bf16 v[248:251], v[120:123], v[240:243], v[248:251]
    ds_read_b64_tr_b16 v[68:69], v10 offset:28672
    buffer_load_dwordx4 v25, s[32:35], s50 offen lds
    v_mfma_f32_16x16x32_bf16 v[188:191], v[116:119], v[96:99], v[188:191]
    ds_read_b64_tr_b16 v[70:71], v10 offset:35840
    v_mfma_f32_16x16x32_bf16 v[192:195], v[120:123], v[84:87], v[192:195]
    ds_read_b64_tr_b16 v[72:73], v11 offset:28672
    s_add_u32 m0, s57, s58
    v_mfma_f32_16x16x32_bf16 v[196:199], v[120:123], v[88:91], v[196:199]
    ds_read_b64_tr_b16 v[74:75], v11 offset:35840
    s_mov_b64 exec, 0xffff
    buffer_load_dwordx4 v30, s[32:35], s55 offen lds
    s_mov_b64 exec, -1
    v_mfma_f32_16x16x32_bf16 v[200:203], v[120:123], v[92:95], v[200:203]
    ds_read_b64_tr_b16 v[76:77], v12 offset:28672
    v_mfma_f32_16x16x32_bf16 v[204:207], v[120:123], v[96:99], v[204:207]
    ds_read_b64_tr_b16 v[78:79], v12 offset:35840
    ds_read_b64_tr_b16 v[80:81], v13 offset:28672
    v_mfma_f32_16x16x32_bf16 v[208:211], v[124:127], v[84:87], v[208:211]
    ds_read_b64_tr_b16 v[82:83], v13 offset:35840
    v_mfma_f32_16x16x32_bf16 v[212:215], v[124:127], v[88:91], v[212:215]
    v_mfma_f32_16x16x32_bf16 v[216:219], v[124:127], v[92:95], v[216:219]
    v_mfma_f32_16x16x32_bf16 v[220:223], v[124:127], v[96:99], v[220:223]
    s_waitcnt vmcnt(12) lgkmcnt(0)
    s_barrier
    v_mfma_f32_16x16x32_bf16 v[128:131], v[60:63], v[40:43], v[128:131]
    s_cmp_lg_u32 s88, s89
    s_cbranch_scc1 L_q_2pfa
    buffer_load_dword v252, v253, s[36:39], s91 offen

L_q_2pfa:
    s_add_u32 s88, s88, 1
    s_add_u32 m0, s53, 0x7000
    v_mfma_f32_16x16x32_bf16 v[132:135], v[60:63], v[44:47], v[132:135]
    ds_read_b128 v[84:87], v19 offset:0
    v_lshlrev_b32 v31, 16, v228
    v_mfma_f32_16x16x32_bf16 v[136:139], v[60:63], v[48:51], v[136:139]
    buffer_load_dwordx4 v28, s[36:39], s51 offen lds
    v_and_b32 v32, s84, v228
    v_mfma_f32_16x16x32_bf16 v[140:143], v[60:63], v[52:55], v[140:143]
    ds_read_b128 v[88:91], v19 offset:2048
    v_add_f32 v34, v31, v32
    v_mfma_f32_16x16x32_bf16 v[224:227], v[60:63], v[56:59], v[224:227]
    ds_read_b128 v[92:95], v19 offset:4096
    v_lshlrev_b32 v31, 16, v229
    v_mfma_f32_16x16x32_bf16 v[144:147], v[64:67], v[40:43], v[144:147]
    ds_read_b128 v[96:99], v19 offset:6144
    s_add_u32 m0, s56, 0x7000
    v_mfma_f32_16x16x32_bf16 v[148:151], v[64:67], v[44:47], v[148:151]
    v_and_b32 v32, s84, v229
    ds_read_b128 v[100:103], v23
    v_mfma_f32_16x16x32_bf16 v[152:155], v[64:67], v[48:51], v[152:155]
    v_add_f32 v31, v31, v32
    buffer_load_dwordx4 v29, s[36:39], s51 offen lds
    v_mfma_f32_16x16x32_bf16 v[244:247], v[60:63], v[240:243], v[244:247]
    v_add_f32 v34, v34, v31
    s_add_u32 s51, s51, 0x30000
    ds_read_b64_tr_b16 v[104:105], v8 offset:43008
    v_mfma_f32_16x16x32_bf16 v[156:159], v[64:67], v[52:55], v[156:159]
    v_lshlrev_b32 v31, 16, v230
    ds_read_b64_tr_b16 v[106:107], v8 offset:50176
    v_mfma_f32_16x16x32_bf16 v[160:163], v[68:71], v[40:43], v[160:163]
    v_and_b32 v32, s84, v230
    ds_read_b64_tr_b16 v[108:109], v9 offset:43008
    v_mfma_f32_16x16x32_bf16 v[164:167], v[68:71], v[44:47], v[164:167]
    v_add_f32 v31, v31, v32
    s_add_u32 m0, s49, 0x800
    v_mfma_f32_16x16x32_bf16 v[168:171], v[68:71], v[48:51], v[168:171]
    v_add_f32 v34, v34, v31
    ds_read_b64_tr_b16 v[110:111], v9 offset:50176
    v_mfma_f32_16x16x32_bf16 v[172:175], v[68:71], v[52:55], v[172:175]
    buffer_load_dwordx4 v26, s[32:35], s50 offen lds
    v_lshlrev_b32 v31, 16, v231
    v_mfma_f32_16x16x32_bf16 v[176:179], v[72:75], v[40:43], v[176:179]
    ds_read_b64_tr_b16 v[112:113], v10 offset:43008
    v_and_b32 v32, s84, v231
    v_mfma_f32_16x16x32_bf16 v[180:183], v[72:75], v[44:47], v[180:183]
    ds_read_b64_tr_b16 v[114:115], v10 offset:50176
    v_add_f32 v31, v31, v32
    v_mfma_f32_16x16x32_bf16 v[184:187], v[72:75], v[48:51], v[184:187]
    ds_read_b64_tr_b16 v[116:117], v11 offset:43008
    s_add_u32 m0, s49, 0xc00
    v_add_f32 v34, v34, v31
    v_mfma_f32_16x16x32_bf16 v[248:251], v[76:79], v[240:243], v[248:251]
    ds_read_b64_tr_b16 v[118:119], v11 offset:50176
    v_lshlrev_b32 v31, 16, v232
    v_mfma_f32_16x16x32_bf16 v[188:191], v[72:75], v[52:55], v[188:191]
    buffer_load_dwordx4 v27, s[32:35], s50 offen lds
    v_and_b32 v32, s84, v232
    v_mfma_f32_16x16x32_bf16 v[192:195], v[76:79], v[40:43], v[192:195]
    s_add_u32 s50, s50, 128
    v_add_f32 v31, v31, v32
    v_mfma_f32_16x16x32_bf16 v[196:199], v[76:79], v[44:47], v[196:199]
    s_add_u32 s55, s55, 128
    ds_read_b64_tr_b16 v[120:121], v12 offset:43008
    v_mfma_f32_16x16x32_bf16 v[200:203], v[76:79], v[48:51], v[200:203]
    v_add_f32 v34, v34, v31
    ds_read_b64_tr_b16 v[122:123], v12 offset:50176
    v_mfma_f32_16x16x32_bf16 v[204:207], v[76:79], v[52:55], v[204:207]
    v_lshlrev_b32 v31, 16, v233
    ds_read_b64_tr_b16 v[124:125], v13 offset:43008
    v_mfma_f32_16x16x32_bf16 v[208:211], v[80:83], v[40:43], v[208:211]
    v_and_b32 v32, s84, v233
    ds_read_b64_tr_b16 v[126:127], v13 offset:50176
    v_mfma_f32_16x16x32_bf16 v[212:215], v[80:83], v[44:47], v[212:215]
    v_mfma_f32_16x16x32_bf16 v[216:219], v[80:83], v[48:51], v[216:219]
    v_mfma_f32_16x16x32_bf16 v[220:223], v[80:83], v[52:55], v[220:223]
    s_waitcnt vmcnt(9) lgkmcnt(0)
    s_barrier
    v_mfma_f32_16x16x32_bf16 v[128:131], v[104:107], v[84:87], v[128:131]
    s_cmp_lg_u32 s88, s89
    s_cbranch_scc1 L_q_3pfa
    buffer_load_dword v252, v253, s[36:39], s91 offen

L_q_3pfa:
    s_add_u32 s88, s88, 1
    s_mov_b32 s58, s48
    v_mfma_f32_16x16x32_bf16 v[132:135], v[104:107], v[88:91], v[132:135]
    s_add_u32 s49, s48, s52
    s_add_u32 s48, s48, 0x8800
    v_mfma_f32_16x16x32_bf16 v[136:139], v[104:107], v[92:95], v[136:139]
    s_cmp_eq_u32 s48, 0x19800
    s_cselect_b32 s48, 0, s48
    v_add_u32 v18, s48, v16
    v_mfma_f32_16x16x32_bf16 v[140:143], v[104:107], v[96:99], v[140:143]
    v_add_u32 v19, s48, v17
    v_add_u32 v22, s48, v20
    v_mfma_f32_16x16x32_bf16 v[224:227], v[104:107], v[100:103], v[224:227]
    v_add_u32 v23, s48, v21
    s_add_u32 m0, s53, 0xa800
    ds_read_b128 v[40:43], v18 offset:0
    v_mfma_f32_16x16x32_bf16 v[144:147], v[108:111], v[84:87], v[144:147]
    v_add_f32 v31, v31, v32
    buffer_load_dwordx4 v28, s[36:39], s51 offen lds
    v_mfma_f32_16x16x32_bf16 v[148:151], v[108:111], v[88:91], v[148:151]
    v_add_f32 v34, v34, v31
    ds_read_b128 v[44:47], v18 offset:2048
    v_lshlrev_b32 v31, 16, v234
    v_mfma_f32_16x16x32_bf16 v[152:155], v[108:111], v[92:95], v[152:155]
    ds_read_b128 v[48:51], v18 offset:4096
    v_and_b32 v32, s84, v234
    v_mfma_f32_16x16x32_bf16 v[244:247], v[104:107], v[240:243], v[244:247]
    s_add_u32 m0, s56, 0xa800
    ds_read_b128 v[52:55], v18 offset:6144
    v_add_f32 v31, v31, v32
    v_mfma_f32_16x16x32_bf16 v[156:159], v[108:111], v[96:99], v[156:159]
    buffer_load_dwordx4 v29, s[36:39], s51 offen lds
    v_add_f32 v34, v34, v31
    v_mfma_f32_16x16x32_bf16 v[160:163], v[112:115], v[84:87], v[160:163]
    s_add_u32 s51, s51, 0x30000
    v_lshlrev_b32 v31, 16, v235
    ds_read_b128 v[56:59], v22
    v_mfma_f32_16x16x32_bf16 v[164:167], v[112:115], v[88:91], v[164:167]
    ds_read_b64_tr_b16 v[60:61], v8 offset:0
    v_and_b32 v32, s84, v235
    v_mfma_f32_16x16x32_bf16 v[168:171], v[112:115], v[92:95], v[168:171]
    s_add_u32 m0, s49, 0x0
    v_add_f32 v31, v31, v32
    ds_read_b64_tr_b16 v[62:63], v8 offset:7168
    v_mfma_f32_16x16x32_bf16 v[172:175], v[112:115], v[96:99], v[172:175]
    v_add_f32 v34, v34, v31
    buffer_load_dwordx4 v24, s[32:35], s50 offen lds
    v_mfma_f32_16x16x32_bf16 v[176:179], v[116:119], v[84:87], v[176:179]
    v_lshlrev_b32 v31, 16, v236
    ds_read_b64_tr_b16 v[64:65], v9 offset:0
    ds_read_b64_tr_b16 v[66:67], v9 offset:7168
    v_mfma_f32_16x16x32_bf16 v[180:183], v[116:119], v[88:91], v[180:183]
    v_and_b32 v32, s84, v236
    s_add_u32 m0, s49, 0x400
    v_mfma_f32_16x16x32_bf16 v[184:187], v[116:119], v[92:95], v[184:187]
    v_add_f32 v31, v31, v32
    ds_read_b64_tr_b16 v[68:69], v10 offset:0
    v_add_f32 v34, v34, v31
    v_mfma_f32_16x16x32_bf16 v[248:251], v[120:123], v[240:243], v[248:251]
    buffer_load_dwordx4 v25, s[32:35], s50 offen lds
    ds_read_b64_tr_b16 v[70:71], v10 offset:7168
    v_mfma_f32_16x16x32_bf16 v[188:191], v[116:119], v[96:99], v[188:191]
    v_lshlrev_b32 v31, 16, v237
    ds_read_b64_tr_b16 v[72:73], v11 offset:0
    v_and_b32 v32, s84, v237
    v_mfma_f32_16x16x32_bf16 v[192:195], v[120:123], v[84:87], v[192:195]
    s_add_u32 m0, s57, s58
    v_add_f32 v31, v31, v32
    v_mfma_f32_16x16x32_bf16 v[196:199], v[120:123], v[88:91], v[196:199]
    ds_read_b64_tr_b16 v[74:75], v11 offset:7168
    v_add_f32 v34, v34, v31
    s_mov_b64 exec, 0xffff
    buffer_load_dwordx4 v30, s[32:35], s55 offen lds
    s_mov_b64 exec, -1
    v_mfma_f32_16x16x32_bf16 v[200:203], v[120:123], v[92:95], v[200:203]
    ds_read_b64_tr_b16 v[76:77], v12 offset:0
    v_lshlrev_b32 v31, 16, v238
    v_mfma_f32_16x16x32_bf16 v[204:207], v[120:123], v[96:99], v[204:207]
    ds_read_b64_tr_b16 v[78:79], v12 offset:7168
    v_and_b32 v32, s84, v238
    ds_read_b64_tr_b16 v[80:81], v13 offset:0
    v_mfma_f32_16x16x32_bf16 v[208:211], v[124:127], v[84:87], v[208:211]
    v_add_f32 v31, v31, v32
    ds_read_b64_tr_b16 v[82:83], v13 offset:7168
    v_mfma_f32_16x16x32_bf16 v[212:215], v[124:127], v[88:91], v[212:215]
    v_mfma_f32_16x16x32_bf16 v[216:219], v[124:127], v[92:95], v[216:219]
    v_mfma_f32_16x16x32_bf16 v[220:223], v[124:127], v[96:99], v[220:223]
    s_waitcnt vmcnt(12) lgkmcnt(0)
    s_barrier
    v_mfma_f32_16x16x32_bf16 v[128:131], v[60:63], v[40:43], v[128:131]
    s_cmp_lg_u32 s88, s89
    s_cbranch_scc1 L_q_4pfa
    buffer_load_dword v252, v253, s[36:39], s91 offen

L_q_4pfa:
    s_add_u32 s88, s88, 1
    s_add_u32 m0, s53, 0x0
    v_mfma_f32_16x16x32_bf16 v[132:135], v[60:63], v[44:47], v[132:135]
    ds_read_b128 v[84:87], v19 offset:0
    v_add_f32 v34, v34, v31
    v_mfma_f32_16x16x32_bf16 v[136:139], v[60:63], v[48:51], v[136:139]
    buffer_load_dwordx4 v28, s[36:39], s51 offen lds
    v_lshlrev_b32 v31, 16, v239
    v_mfma_f32_16x16x32_bf16 v[140:143], v[60:63], v[52:55], v[140:143]
    ds_read_b128 v[88:91], v19 offset:2048
    v_and_b32 v32, s84, v239
    v_mfma_f32_16x16x32_bf16 v[224:227], v[60:63], v[56:59], v[224:227]
    ds_read_b128 v[92:95], v19 offset:4096
    v_add_f32 v31, v31, v32
    v_mfma_f32_16x16x32_bf16 v[144:147], v[64:67], v[40:43], v[144:147]
    ds_read_b128 v[96:99], v19 offset:6144
    s_add_u32 m0, s56, 0x0
    v_mfma_f32_16x16x32_bf16 v[148:151], v[64:67], v[44:47], v[148:151]
    v_add_f32 v34, v34, v31
    ds_read_b128 v[100:103], v23
    v_mfma_f32_16x16x32_bf16 v[152:155], v[64:67], v[48:51], v[152:155]
    v_lshlrev_b32 v31, 16, v36
    buffer_load_dwordx4 v29, s[36:39], s51 offen lds
    v_mfma_f32_16x16x32_bf16 v[244:247], v[60:63], v[240:243], v[244:247]
    v_and_b32 v32, s84, v36
    s_add_u32 s51, s51, 0x30000
    ds_read_b64_tr_b16 v[104:105], v8 offset:14336
    v_mfma_f32_16x16x32_bf16 v[156:159], v[64:67], v[52:55], v[156:159]
    v_add_f32 v31, v31, v32
    ds_read_b64_tr_b16 v[106:107], v8 offset:21504
    v_mfma_f32_16x16x32_bf16 v[160:163], v[68:71], v[40:43], v[160:163]
    v_add_f32 v34, v34, v31
    ds_read_b64_tr_b16 v[108:109], v9 offset:14336
    v_mfma_f32_16x16x32_bf16 v[164:167], v[68:71], v[44:47], v[164:167]
    v_lshlrev_b32 v31, 16, v37
    s_add_u32 m0, s49, 0x800
    v_mfma_f32_16x16x32_bf16 v[168:171], v[68:71], v[48:51], v[168:171]
    v_and_b32 v32, s84, v37
    ds_read_b64_tr_b16 v[110:111], v9 offset:21504
    v_mfma_f32_16x16x32_bf16 v[172:175], v[68:71], v[52:55], v[172:175]
    buffer_load_dwordx4 v26, s[32:35], s50 offen lds
    v_add_f32 v31, v31, v32
    v_mfma_f32_16x16x32_bf16 v[176:179], v[72:75], v[40:43], v[176:179]
    ds_read_b64_tr_b16 v[112:113], v10 offset:14336
    v_add_f32 v34, v34, v31
    v_mfma_f32_16x16x32_bf16 v[180:183], v[72:75], v[44:47], v[180:183]
    ds_read_b64_tr_b16 v[114:115], v10 offset:21504
    v_lshlrev_b32 v31, 16, v38
    v_mfma_f32_16x16x32_bf16 v[184:187], v[72:75], v[48:51], v[184:187]
    ds_read_b64_tr_b16 v[116:117], v11 offset:14336
    s_add_u32 m0, s49, 0xc00
    v_and_b32 v32, s84, v38
    v_mfma_f32_16x16x32_bf16 v[248:251], v[76:79], v[240:243], v[248:251]
    ds_read_b64_tr_b16 v[118:119], v11 offset:21504
    v_add_f32 v31, v31, v32
    v_mfma_f32_16x16x32_bf16 v[188:191], v[72:75], v[52:55], v[188:191]
    buffer_load_dwordx4 v27, s[32:35], s50 offen lds
    v_add_f32 v34, v34, v31
    v_mfma_f32_16x16x32_bf16 v[192:195], v[76:79], v[40:43], v[192:195]
    s_add_u32 s50, s50, 128
    v_lshlrev_b32 v31, 16, v39
    v_mfma_f32_16x16x32_bf16 v[196:199], v[76:79], v[44:47], v[196:199]
    s_add_u32 s55, s55, 128
    ds_read_b64_tr_b16 v[120:121], v12 offset:14336
    v_mfma_f32_16x16x32_bf16 v[200:203], v[76:79], v[48:51], v[200:203]
    v_and_b32 v32, s84, v39
    ds_read_b64_tr_b16 v[122:123], v12 offset:21504
    v_mfma_f32_16x16x32_bf16 v[204:207], v[76:79], v[52:55], v[204:207]
    v_add_f32 v31, v31, v32
    ds_read_b64_tr_b16 v[124:125], v13 offset:14336
    v_mfma_f32_16x16x32_bf16 v[208:211], v[80:83], v[40:43], v[208:211]
    v_add_f32 v34, v34, v31
    ds_read_b64_tr_b16 v[126:127], v13 offset:21504
    v_mfma_f32_16x16x32_bf16 v[212:215], v[80:83], v[44:47], v[212:215]
    v_mfma_f32_16x16x32_bf16 v[216:219], v[80:83], v[48:51], v[216:219]
    v_mfma_f32_16x16x32_bf16 v[220:223], v[80:83], v[52:55], v[220:223]
    s_waitcnt vmcnt(9) lgkmcnt(0)
    s_barrier
    v_mfma_f32_16x16x32_bf16 v[128:131], v[104:107], v[84:87], v[128:131]
    s_cmp_lg_u32 s88, s89
    s_cbranch_scc1 L_q_5pfa
    buffer_load_dword v252, v253, s[36:39], s91 offen

L_q_5pfa:
    s_add_u32 s88, s88, 1
    s_mov_b32 s58, s48
    v_mfma_f32_16x16x32_bf16 v[132:135], v[104:107], v[88:91], v[132:135]
    s_add_u32 s49, s48, s52
    s_add_u32 s48, s48, 0x8800
    v_mfma_f32_16x16x32_bf16 v[136:139], v[104:107], v[92:95], v[136:139]
    s_cmp_eq_u32 s48, 0x19800
    s_cselect_b32 s48, 0, s48
    v_add_u32 v18, s48, v16
    v_mfma_f32_16x16x32_bf16 v[140:143], v[104:107], v[96:99], v[140:143]
    v_add_u32 v19, s48, v17
    v_add_u32 v22, s48, v20
    v_mfma_f32_16x16x32_bf16 v[224:227], v[104:107], v[100:103], v[224:227]
    v_add_u32 v23, s48, v21
    s_add_u32 m0, s53, 0x3800
    ds_read_b128 v[40:43], v18 offset:0
    v_mfma_f32_16x16x32_bf16 v[144:147], v[108:111], v[84:87], v[144:147]
    s_nop 1
    buffer_load_dwordx4 v28, s[36:39], s51 offen lds
    v_mfma_f32_16x16x32_bf16 v[148:151], v[108:111], v[88:91], v[148:151]
    v_add_f32_dpp v34, v34, v34 quad_perm:[1,0,3,2] row_mask:0xf bank_mask:0xf
    ds_read_b128 v[44:47], v18 offset:2048
    s_nop 1
    v_mfma_f32_16x16x32_bf16 v[152:155], v[108:111], v[92:95], v[152:155]
    ds_read_b128 v[48:51], v18 offset:4096
    v_add_f32_dpp v34, v34, v34 quad_perm:[2,3,0,1] row_mask:0xf bank_mask:0xf
    v_mfma_f32_16x16x32_bf16 v[244:247], v[104:107], v[240:243], v[244:247]
    s_add_u32 m0, s56, 0x3800
    ds_read_b128 v[52:55], v18 offset:6144
    s_nop 1
    v_mfma_f32_16x16x32_bf16 v[156:159], v[108:111], v[96:99], v[156:159]
    buffer_load_dwordx4 v29, s[36:39], s51 offen lds
    v_add_f32_dpp v34, v34, v34 row_half_mirror row_mask:0xf bank_mask:0xf
    v_mfma_f32_16x16x32_bf16 v[160:163], v[112:115], v[84:87], v[160:163]
    s_add_u32 s51, s51, 0x30000
    s_nop 1
    ds_read_b128 v[56:59], v22
    v_mfma_f32_16x16x32_bf16 v[164:167], v[112:115], v[88:91], v[164:167]
    ds_read_b64_tr_b16 v[60:61], v8 offset:28672
    v_add_f32_dpp v34, v34, v34 row_mirror row_mask:0xf bank_mask:0xf
    v_mfma_f32_16x16x32_bf16 v[168:171], v[112:115], v[92:95], v[168:171]
    s_add_u32 m0, s49, 0x0
    v_mov_b32 v33, v34
    ds_read_b64_tr_b16 v[62:63], v8 offset:35840
    v_mfma_f32_16x16x32_bf16 v[172:175], v[112:115], v[96:99], v[172:175]
    s_nop 1
    buffer_load_dwordx4 v24, s[32:35], s50 offen lds
    v_mfma_f32_16x16x32_bf16 v[176:179], v[116:119], v[84:87], v[176:179]
    v_permlane16_swap_b32 v34, v33
    ds_read_b64_tr_b16 v[64:65], v9 offset:28672
    ds_read_b64_tr_b16 v[66:67], v9 offset:35840
    v_mfma_f32_16x16x32_bf16 v[180:183], v[116:119], v[88:91], v[180:183]
    s_nop 1
    s_add_u32 m0, s49, 0x400
    v_mfma_f32_16x16x32_bf16 v[184:187], v[116:119], v[92:95], v[184:187]
    v_add_f32 v34, v34, v33
    ds_read_b64_tr_b16 v[68:69], v10 offset:28672
    v_mul_f32 v34, 0x3a800000, v34
    v_mfma_f32_16x16x32_bf16 v[248:251], v[120:123], v[240:243], v[248:251]
    buffer_load_dwordx4 v25, s[32:35], s50 offen lds
    ds_read_b64_tr_b16 v[70:71], v10 offset:35840
    v_mfma_f32_16x16x32_bf16 v[188:191], v[116:119], v[96:99], v[188:191]
    v_lshlrev_b32 v31, 16, v228
    ds_read_b64_tr_b16 v[72:73], v11 offset:28672
    v_and_b32 v32, s84, v228
    v_mfma_f32_16x16x32_bf16 v[192:195], v[120:123], v[84:87], v[192:195]
    s_add_u32 m0, s57, s58
    v_sub_f32 v31, v31, v34
    v_mfma_f32_16x16x32_bf16 v[196:199], v[120:123], v[88:91], v[196:199]
    ds_read_b64_tr_b16 v[74:75], v11 offset:35840
    v_sub_f32 v32, v32, v34
    s_mov_b64 exec, 0xffff
    buffer_load_dwordx4 v30, s[32:35], s55 offen lds
    s_mov_b64 exec, -1
    v_mfma_f32_16x16x32_bf16 v[200:203], v[120:123], v[92:95], v[200:203]
    ds_read_b64_tr_b16 v[76:77], v12 offset:28672
    v_mul_f32 v35, v31, v31
    v_mfma_f32_16x16x32_bf16 v[204:207], v[120:123], v[96:99], v[204:207]
    ds_read_b64_tr_b16 v[78:79], v12 offset:35840
    v_mul_f32 v33, v32, v32
    ds_read_b64_tr_b16 v[80:81], v13 offset:28672
    v_mfma_f32_16x16x32_bf16 v[208:211], v[124:127], v[84:87], v[208:211]
    v_lshlrev_b32 v31, 16, v229
    ds_read_b64_tr_b16 v[82:83], v13 offset:35840
    v_mfma_f32_16x16x32_bf16 v[212:215], v[124:127], v[88:91], v[212:215]
    v_mfma_f32_16x16x32_bf16 v[216:219], v[124:127], v[92:95], v[216:219]
    v_mfma_f32_16x16x32_bf16 v[220:223], v[124:127], v[96:99], v[220:223]
    s_waitcnt vmcnt(12) lgkmcnt(0)
    s_barrier
    v_mfma_f32_16x16x32_bf16 v[128:131], v[60:63], v[40:43], v[128:131]
    s_cmp_lg_u32 s88, s89
    s_cbranch_scc1 L_q_6pfa
    buffer_load_dword v252, v253, s[36:39], s91 offen

L_q_6pfa:
    s_add_u32 s88, s88, 1
    s_add_u32 m0, s53, 0x7000
    v_mfma_f32_16x16x32_bf16 v[132:135], v[60:63], v[44:47], v[132:135]
    ds_read_b128 v[84:87], v19 offset:0
    v_and_b32 v32, s84, v229
    v_mfma_f32_16x16x32_bf16 v[136:139], v[60:63], v[48:51], v[136:139]
    buffer_load_dwordx4 v28, s[36:39], s51 offen lds
    v_sub_f32 v31, v31, v34
    v_mfma_f32_16x16x32_bf16 v[140:143], v[60:63], v[52:55], v[140:143]
    ds_read_b128 v[88:91], v19 offset:2048
    v_sub_f32 v32, v32, v34
    v_mfma_f32_16x16x32_bf16 v[224:227], v[60:63], v[56:59], v[224:227]
    ds_read_b128 v[92:95], v19 offset:4096
    v_fmac_f32 v35, v31, v31
    v_mfma_f32_16x16x32_bf16 v[144:147], v[64:67], v[40:43], v[144:147]
    ds_read_b128 v[96:99], v19 offset:6144
    s_add_u32 m0, s56, 0x7000
    v_mfma_f32_16x16x32_bf16 v[148:151], v[64:67], v[44:47], v[148:151]
    v_fmac_f32 v33, v32, v32
    ds_read_b128 v[100:103], v23
    v_mfma_f32_16x16x32_bf16 v[152:155], v[64:67], v[48:51], v[152:155]
    v_lshlrev_b32 v31, 16, v230
    buffer_load_dwordx4 v29, s[36:39], s51 offen lds
    v_mfma_f32_16x16x32_bf16 v[244:247], v[60:63], v[240:243], v[244:247]
    v_and_b32 v32, s84, v230
    s_add_u32 s51, s51, 0x30000
    ds_read_b64_tr_b16 v[104:105], v8 offset:43008
    v_mfma_f32_16x16x32_bf16 v[156:159], v[64:67], v[52:55], v[156:159]
    v_sub_f32 v31, v31, v34
    ds_read_b64_tr_b16 v[106:107], v8 offset:50176
    v_mfma_f32_16x16x32_bf16 v[160:163], v[68:71], v[40:43], v[160:163]
    v_sub_f32 v32, v32, v34
    ds_read_b64_tr_b16 v[108:109], v9 offset:43008
    v_mfma_f32_16x16x32_bf16 v[164:167], v[68:71], v[44:47], v[164:167]
    v_fmac_f32 v35, v31, v31
    s_add_u32 m0, s49, 0x800
    v_mfma_f32_16x16x32_bf16 v[168:171], v[68:71], v[48:51], v[168:171]
    v_fmac_f32 v33, v32, v32
    ds_read_b64_tr_b16 v[110:111], v9 offset:50176
    v_mfma_f32_16x16x32_bf16 v[172:175], v[68:71], v[52:55], v[172:175]
    buffer_load_dwordx4 v26, s[32:35], s50 offen lds
    v_lshlrev_b32 v31, 16, v231
    v_mfma_f32_16x16x32_bf16 v[176:179], v[72:75], v[40:43], v[176:179]
    ds_read_b64_tr_b16 v[112:113], v10 offset:43008
    v_and_b32 v32, s84, v231
    v_mfma_f32_16x16x32_bf16 v[180:183], v[72:75], v[44:47], v[180:183]
    ds_read_b64_tr_b16 v[114:115], v10 offset:50176
    v_sub_f32 v31, v31, v34
    v_mfma_f32_16x16x32_bf16 v[184:187], v[72:75], v[48:51], v[184:187]
    ds_read_b64_tr_b16 v[116:117], v11 offset:43008
    s_add_u32 m0, s49, 0xc00
    v_sub_f32 v32, v32, v34
    v_mfma_f32_16x16x32_bf16 v[248:251], v[76:79], v[240:243], v[248:251]
    ds_read_b64_tr_b16 v[118:119], v11 offset:50176
    v_fmac_f32 v35, v31, v31
    v_mfma_f32_16x16x32_bf16 v[188:191], v[72:75], v[52:55], v[188:191]
    buffer_load_dwordx4 v27, s[32:35], s50 offen lds
    v_fmac_f32 v33, v32, v32
    v_mfma_f32_16x16x32_bf16 v[192:195], v[76:79], v[40:43], v[192:195]
    s_add_u32 s50, s50, 128
    v_lshlrev_b32 v31, 16, v232
    v_mfma_f32_16x16x32_bf16 v[196:199], v[76:79], v[44:47], v[196:199]
    s_add_u32 s55, s55, 128
    ds_read_b64_tr_b16 v[120:121], v12 offset:43008
    v_mfma_f32_16x16x32_bf16 v[200:203], v[76:79], v[48:51], v[200:203]
    v_and_b32 v32, s84, v232
    ds_read_b64_tr_b16 v[122:123], v12 offset:50176
    v_mfma_f32_16x16x32_bf16 v[204:207], v[76:79], v[52:55], v[204:207]
    v_sub_f32 v31, v31, v34
    ds_read_b64_tr_b16 v[124:125], v13 offset:43008
    v_mfma_f32_16x16x32_bf16 v[208:211], v[80:83], v[40:43], v[208:211]
    v_sub_f32 v32, v32, v34
    ds_read_b64_tr_b16 v[126:127], v13 offset:50176
    v_mfma_f32_16x16x32_bf16 v[212:215], v[80:83], v[44:47], v[212:215]
    v_mfma_f32_16x16x32_bf16 v[216:219], v[80:83], v[48:51], v[216:219]
    v_mfma_f32_16x16x32_bf16 v[220:223], v[80:83], v[52:55], v[220:223]
    s_waitcnt vmcnt(9) lgkmcnt(0)
    s_barrier
    v_mfma_f32_16x16x32_bf16 v[128:131], v[104:107], v[84:87], v[128:131]
    s_cmp_lg_u32 s88, s89
    s_cbranch_scc1 L_q_7pfa
    buffer_load_dword v252, v253, s[36:39], s91 offen

L_q_7pfa:
    s_add_u32 s88, s88, 1
    s_mov_b32 s58, s48
    v_mfma_f32_16x16x32_bf16 v[132:135], v[104:107], v[88:91], v[132:135]
    s_add_u32 s49, s48, s52
    s_add_u32 s48, s48, 0x8800
    v_mfma_f32_16x16x32_bf16 v[136:139], v[104:107], v[92:95], v[136:139]
    s_cmp_eq_u32 s48, 0x19800
    s_cselect_b32 s48, 0, s48
    v_add_u32 v18, s48, v16
    v_mfma_f32_16x16x32_bf16 v[140:143], v[104:107], v[96:99], v[140:143]
    v_add_u32 v19, s48, v17
    v_add_u32 v22, s48, v20
    v_mfma_f32_16x16x32_bf16 v[224:227], v[104:107], v[100:103], v[224:227]
    v_add_u32 v23, s48, v21
    s_add_u32 m0, s53, 0xa800
    ds_read_b128 v[40:43], v18 offset:0
    v_mfma_f32_16x16x32_bf16 v[144:147], v[108:111], v[84:87], v[144:147]
    v_fmac_f32 v35, v31, v31
    buffer_load_dwordx4 v28, s[36:39], s51 offen lds
    v_mfma_f32_16x16x32_bf16 v[148:151], v[108:111], v[88:91], v[148:151]
    v_fmac_f32 v33, v32, v32
    ds_read_b128 v[44:47], v18 offset:2048
    v_lshlrev_b32 v31, 16, v233
    v_mfma_f32_16x16x32_bf16 v[152:155], v[108:111], v[92:95], v[152:155]
    ds_read_b128 v[48:51], v18 offset:4096
    v_and_b32 v32, s84, v233
    v_mfma_f32_16x16x32_bf16 v[244:247], v[104:107], v[240:243], v[244:247]
    s_add_u32 m0, s56, 0xa800
    ds_read_b128 v[52:55], v18 offset:6144
    v_sub_f32 v31, v31, v34
    v_mfma_f32_16x16x32_bf16 v[156:159], v[108:111], v[96:99], v[156:159]
    buffer_load_dwordx4 v29, s[36:39], s51 offen lds
    v_sub_f32 v32, v32, v34
    v_mfma_f32_16x16x32_bf16 v[160:163], v[112:115], v[84:87], v[160:163]
    s_add_u32 s51, s51, 0x30000
    v_fmac_f32 v35, v31, v31
    ds_read_b128 v[56:59], v22
    v_mfma_f32_16x16x32_bf16 v[164:167], v[112:115], v[88:91], v[164:167]
    ds_read_b64_tr_b16 v[60:61], v8 offset:0
    v_fmac_f32 v33, v32, v32
    v_mfma_f32_16x16x32_bf16 v[168:171], v[112:115], v[92:95], v[168:171]
    s_add_u32 m0, s49, 0x0
    v_lshlrev_b32 v31, 16, v234
    ds_read_b64_tr_b16 v[62:63], v8 offset:7168
    v_mfma_f32_16x16x32_bf16 v[172:175], v[112:115], v[96:99], v[172:175]
    v_and_b32 v32, s84, v234
    buffer_load_dwordx4 v24, s[32:35], s50 offen lds
    v_mfma_f32_16x16x32_bf16 v[176:179], v[116:119], v[84:87], v[176:179]
    v_sub_f32 v31, v31, v34
    ds_read_b64_tr_b16 v[64:65], v9 offset:0
    ds_read_b64_tr_b16 v[66:67], v9 offset:7168
    v_mfma_f32_16x16x32_bf16 v[180:183], v[116:119], v[88:91], v[180:183]
    v_sub_f32 v32, v32, v34
    s_add_u32 m0, s49, 0x400
    v_mfma_f32_16x16x32_bf16 v[184:187], v[116:119], v[92:95], v[184:187]
    v_fmac_f32 v35, v31, v31
    ds_read_b64_tr_b16 v[68:69], v10 offset:0
    v_fmac_f32 v33, v32, v32
    v_mfma_f32_16x16x32_bf16 v[248:251], v[120:123], v[240:243], v[248:251]
    buffer_load_dwordx4 v25, s[32:35], s50 offen lds
    ds_read_b64_tr_b16 v[70:71], v10 offset:7168
    v_mfma_f32_16x16x32_bf16 v[188:191], v[116:119], v[96:99], v[188:191]
    v_lshlrev_b32 v31, 16, v235
    ds_read_b64_tr_b16 v[72:73], v11 offset:0
    v_and_b32 v32, s84, v235
    v_mfma_f32_16x16x32_bf16 v[192:195], v[120:123], v[84:87], v[192:195]
    s_add_u32 m0, s57, s58
    v_sub_f32 v31, v31, v34
    v_mfma_f32_16x16x32_bf16 v[196:199], v[120:123], v[88:91], v[196:199]
    ds_read_b64_tr_b16 v[74:75], v11 offset:7168
    v_sub_f32 v32, v32, v34
    s_mov_b64 exec, 0xffff
    buffer_load_dwordx4 v30, s[32:35], s55 offen lds
    s_mov_b64 exec, -1
    v_mfma_f32_16x16x32_bf16 v[200:203], v[120:123], v[92:95], v[200:203]
    ds_read_b64_tr_b16 v[76:77], v12 offset:0
    v_fmac_f32 v35, v31, v31
    v_mfma_f32_16x16x32_bf16 v[204:207], v[120:123], v[96:99], v[204:207]
    ds_read_b64_tr_b16 v[78:79], v12 offset:7168
    v_fmac_f32 v33, v32, v32
    ds_read_b64_tr_b16 v[80:81], v13 offset:0
    v_mfma_f32_16x16x32_bf16 v[208:211], v[124:127], v[84:87], v[208:211]
    v_lshlrev_b32 v31, 16, v236
    ds_read_b64_tr_b16 v[82:83], v13 offset:7168
    v_mfma_f32_16x16x32_bf16 v[212:215], v[124:127], v[88:91], v[212:215]
    v_mfma_f32_16x16x32_bf16 v[216:219], v[124:127], v[92:95], v[216:219]
    v_mfma_f32_16x16x32_bf16 v[220:223], v[124:127], v[96:99], v[220:223]
    s_waitcnt vmcnt(12) lgkmcnt(0)
    s_barrier
    v_mfma_f32_16x16x32_bf16 v[128:131], v[60:63], v[40:43], v[128:131]
    s_cmp_lg_u32 s88, s89
    s_cbranch_scc1 L_q_8pfa
    buffer_load_dword v252, v253, s[36:39], s91 offen

L_q_8pfa:
    s_cmp_lg_u32 s88, s90
    s_cbranch_scc1 L_q_8pfb
    s_lshl_b32 s60, s2, 3
    s_add_u32 s60, s60, s20
    s_lshl_b32 s60, s60, 13
    s_mov_b32 s80, s12
    s_mov_b32 s81, s13
    s_mov_b32 s82, 0x700000
    s_mov_b32 s83, 0x20000
    buffer_load_dword v252, v253, s[80:83], s60 offen
    s_sub_u32 s60, s60, 0x800000
    s_mov_b32 s80, s8
    s_mov_b32 s81, s9
    s_mov_b32 s82, 0x200000
    buffer_load_dword v252, v253, s[80:83], s60 offen
L_q_8pfb:
    s_add_u32 s88, s88, 1
    v_mfma_f32_16x16x32_bf16 v[132:135], v[60:63], v[44:47], v[132:135]
    s_add_u32 m0, s53, 0x0
    ds_read_b128 v[84:87], v19 offset:0
    v_mfma_f32_16x16x32_bf16 v[136:139], v[60:63], v[48:51], v[136:139]
    v_and_b32 v32, s84, v236
    buffer_load_dwordx4 v28, s[36:39], s51 offen lds
    v_mfma_f32_16x16x32_bf16 v[140:143], v[60:63], v[52:55], v[140:143]
    v_sub_f32 v31, v31, v34
    ds_read_b128 v[88:91], v19 offset:2048
    v_mfma_f32_16x16x32_bf16 v[224:227], v[60:63], v[56:59], v[224:227]
    v_sub_f32 v32, v32, v34
    ds_read_b128 v[92:95], v19 offset:4096
    v_mfma_f32_16x16x32_bf16 v[144:147], v[64:67], v[40:43], v[144:147]
    v_fmac_f32 v35, v31, v31
    ds_read_b128 v[96:99], v19 offset:6144
    v_mfma_f32_16x16x32_bf16 v[148:151], v[64:67], v[44:47], v[148:151]
    s_add_u32 m0, s56, 0x0
    v_fmac_f32 v33, v32, v32
    ds_read_b128 v[100:103], v23
    v_mfma_f32_16x16x32_bf16 v[152:155], v[64:67], v[48:51], v[152:155]
    v_lshlrev_b32 v31, 16, v237
    buffer_load_dwordx4 v29, s[36:39], s51 offen lds
    v_mfma_f32_16x16x32_bf16 v[244:247], v[60:63], v[240:243], v[244:247]
    v_and_b32 v32, s84, v237
    s_add_u32 s51, s51, 0x30000
    v_mfma_f32_16x16x32_bf16 v[156:159], v[64:67], v[52:55], v[156:159]
    ds_read_b64_tr_b16 v[104:105], v8 offset:14336
    v_sub_f32 v31, v31, v34
    v_mfma_f32_16x16x32_bf16 v[160:163], v[68:71], v[40:43], v[160:163]
    ds_read_b64_tr_b16 v[106:107], v8 offset:21504
    v_sub_f32 v32, v32, v34
    v_mfma_f32_16x16x32_bf16 v[164:167], v[68:71], v[44:47], v[164:167]
    ds_read_b64_tr_b16 v[108:109], v9 offset:14336
    v_fmac_f32 v35, v31, v31
    v_mfma_f32_16x16x32_bf16 v[168:171], v[68:71], v[48:51], v[168:171]
    s_add_u32 m0, s49, 0x800
    v_fmac_f32 v33, v32, v32
    ds_read_b64_tr_b16 v[110:111], v9 offset:21504
    v_mfma_f32_16x16x32_bf16 v[172:175], v[68:71], v[52:55], v[172:175]
    buffer_load_dwordx4 v26, s[32:35], s50 offen lds
    v_lshlrev_b32 v31, 16, v238
    v_mfma_f32_16x16x32_bf16 v[176:179], v[72:75], v[40:43], v[176:179]
    ds_read_b64_tr_b16 v[112:113], v10 offset:14336
    v_and_b32 v32, s84, v238
    v_mfma_f32_16x16x32_bf16 v[180:183], v[72:75], v[44:47], v[180:183]
    ds_read_b64_tr_b16 v[114:115], v10 offset:21504
    v_sub_f32 v31, v31, v34
    v_mfma_f32_16x16x32_bf16 v[184:187], v[72:75], v[48:51], v[184:187]
    ds_read_b64_tr_b16 v[116:117], v11 offset:14336
    s_add_u32 m0, s49, 0xc00
    v_mfma_f32_16x16x32_bf16 v[248:251], v[76:79], v[240:243], v[248:251]
    v_sub_f32 v32, v32, v34
    ds_read_b64_tr_b16 v[118:119], v11 offset:21504
    v_mfma_f32_16x16x32_bf16 v[188:191], v[72:75], v[52:55], v[188:191]
    v_fmac_f32 v35, v31, v31
    buffer_load_dwordx4 v27, s[32:35], s50 offen lds
    v_fmac_f32 v33, v32, v32
    v_mfma_f32_16x16x32_bf16 v[192:195], v[76:79], v[40:43], v[192:195]
    s_add_u32 s50, s50, 128
    v_lshlrev_b32 v31, 16, v239
    v_mfma_f32_16x16x32_bf16 v[196:199], v[76:79], v[44:47], v[196:199]
    s_add_u32 s55, s55, 128
    ds_read_b64_tr_b16 v[120:121], v12 offset:14336
    v_mfma_f32_16x16x32_bf16 v[200:203], v[76:79], v[48:51], v[200:203]
    v_and_b32 v32, s84, v239
    ds_read_b64_tr_b16 v[122:123], v12 offset:21504
    v_mfma_f32_16x16x32_bf16 v[204:207], v[76:79], v[52:55], v[204:207]
    v_sub_f32 v31, v31, v34
    ds_read_b64_tr_b16 v[124:125], v13 offset:14336
    v_mfma_f32_16x16x32_bf16 v[208:211], v[80:83], v[40:43], v[208:211]
    v_sub_f32 v32, v32, v34
    ds_read_b64_tr_b16 v[126:127], v13 offset:21504
    v_mfma_f32_16x16x32_bf16 v[212:215], v[80:83], v[44:47], v[212:215]
    v_mfma_f32_16x16x32_bf16 v[216:219], v[80:83], v[48:51], v[216:219]
    v_mfma_f32_16x16x32_bf16 v[220:223], v[80:83], v[52:55], v[220:223]
    s_waitcnt vmcnt(9) lgkmcnt(0)
    s_barrier
    v_mfma_f32_16x16x32_bf16 v[128:131], v[104:107], v[84:87], v[128:131]
    s_cmp_lg_u32 s88, s89
    s_cbranch_scc1 L_q_9pfa
    buffer_load_dword v252, v253, s[36:39], s91 offen

L_q_9pfa:
    s_cmp_lg_u32 s88, s90
    s_cbranch_scc1 L_q_9pfb
    s_lshl_b32 s60, s2, 3
    s_add_u32 s60, s60, s20
    s_lshl_b32 s60, s60, 13
    s_mov_b32 s80, s12
    s_mov_b32 s81, s13
    s_mov_b32 s82, 0x700000
    s_mov_b32 s83, 0x20000
    buffer_load_dword v252, v253, s[80:83], s60 offen
    s_sub_u32 s60, s60, 0x800000
    s_mov_b32 s80, s8
    s_mov_b32 s81, s9
    s_mov_b32 s82, 0x200000
    buffer_load_dword v252, v253, s[80:83], s60 offen
L_q_9pfb:
    s_add_u32 s88, s88, 1
    v_mfma_f32_16x16x32_bf16 v[132:135], v[104:107], v[88:91], v[132:135]
    s_mov_b32 s58, s48
    s_add_u32 s49, s48, s52
    s_add_u32 s48, s48, 0x8800
    v_mfma_f32_16x16x32_bf16 v[136:139], v[104:107], v[92:95], v[136:139]
    s_cmp_eq_u32 s48, 0x19800
    s_cselect_b32 s48, 0, s48
    v_mfma_f32_16x16x32_bf16 v[140:143], v[104:107], v[96:99], v[140:143]
    v_add_u32 v18, s48, v16
    v_add_u32 v19, s48, v17
    v_add_u32 v22, s48, v20
    v_mfma_f32_16x16x32_bf16 v[224:227], v[104:107], v[100:103], v[224:227]
    v_add_u32 v23, s48, v21
    s_add_u32 m0, s53, 0x3800
    v_mfma_f32_16x16x32_bf16 v[144:147], v[108:111], v[84:87], v[144:147]
    ds_read_b128 v[40:43], v18 offset:0
    v_fmac_f32 v35, v31, v31
    buffer_load_dwordx4 v28, s[36:39], s51 offen lds
    v_mfma_f32_16x16x32_bf16 v[148:151], v[108:111], v[88:91], v[148:151]
    v_fmac_f32 v33, v32, v32
    ds_read_b128 v[44:47], v18 offset:2048
    v_mfma_f32_16x16x32_bf16 v[152:155], v[108:111], v[92:95], v[152:155]
    v_lshlrev_b32 v31, 16, v36
    ds_read_b128 v[48:51], v18 offset:4096
    v_and_b32 v32, s84, v36
    v_mfma_f32_16x16x32_bf16 v[244:247], v[104:107], v[240:243], v[244:247]
    s_add_u32 m0, s56, 0x3800
    ds_read_b128 v[52:55], v18 offset:6144
    v_mfma_f32_16x16x32_bf16 v[156:159], v[108:111], v[96:99], v[156:159]
    v_sub_f32 v31, v31, v34
    buffer_load_dwordx4 v29, s[36:39], s51 offen lds
    v_sub_f32 v32, v32, v34
    v_mfma_f32_16x16x32_bf16 v[160:163], v[112:115], v[84:87], v[160:163]
    s_add_u32 s51, s51, 0x30000
    v_fmac_f32 v35, v31, v31
    v_mfma_f32_16x16x32_bf16 v[164:167], v[112:115], v[88:91], v[164:167]
    ds_read_b128 v[56:59], v22
    ds_read_b64_tr_b16 v[60:61], v8 offset:28672
    v_fmac_f32 v33, v32, v32
    v_mfma_f32_16x16x32_bf16 v[168:171], v[112:115], v[92:95], v[168:171]
    s_add_u32 m0, s49, 0x0
    v_lshlrev_b32 v31, 16, v37
    ds_read_b64_tr_b16 v[62:63], v8 offset:35840
    v_mfma_f32_16x16x32_bf16 v[172:175], v[112:115], v[96:99], v[172:175]
    v_and_b32 v32, s84, v37
    buffer_load_dwordx4 v24, s[32:35], s50 offen lds
    v_mfma_f32_16x16x32_bf16 v[176:179], v[116:119], v[84:87], v[176:179]
    v_sub_f32 v31, v31, v34
    ds_read_b64_tr_b16 v[64:65], v9 offset:28672
    ds_read_b64_tr_b16 v[66:67], v9 offset:35840
    v_mfma_f32_16x16x32_bf16 v[180:183], v[116:119], v[88:91], v[180:183]
    v_sub_f32 v32, v32, v34
    s_add_u32 m0, s49, 0x400
    v_mfma_f32_16x16x32_bf16 v[184:187], v[116:119], v[92:95], v[184:187]
    v_fmac_f32 v35, v31, v31
    ds_read_b64_tr_b16 v[68:69], v10 offset:28672
    v_fmac_f32 v33, v32, v32
    v_mfma_f32_16x16x32_bf16 v[248:251], v[120:123], v[240:243], v[248:251]
    buffer_load_dwordx4 v25, s[32:35], s50 offen lds
    ds_read_b64_tr_b16 v[70:71], v10 offset:35840
    v_mfma_f32_16x16x32_bf16 v[188:191], v[116:119], v[96:99], v[188:191]
    v_lshlrev_b32 v31, 16, v38
    ds_read_b64_tr_b16 v[72:73], v11 offset:28672
    v_and_b32 v32, s84, v38
    v_mfma_f32_16x16x32_bf16 v[192:195], v[120:123], v[84:87], v[192:195]
    s_add_u32 m0, s57, s58
    v_sub_f32 v31, v31, v34
    v_mfma_f32_16x16x32_bf16 v[196:199], v[120:123], v[88:91], v[196:199]
    ds_read_b64_tr_b16 v[74:75], v11 offset:35840
    v_sub_f32 v32, v32, v34
    s_mov_b64 exec, 0xffff
    buffer_load_dwordx4 v30, s[32:35], s55 offen lds
    s_mov_b64 exec, -1
    v_mfma_f32_16x16x32_bf16 v[200:203], v[120:123], v[92:95], v[200:203]
    ds_read_b64_tr_b16 v[76:77], v12 offset:28672
    v_fmac_f32 v35, v31, v31
    v_mfma_f32_16x16x32_bf16 v[204:207], v[120:123], v[96:99], v[204:207]
    ds_read_b64_tr_b16 v[78:79], v12 offset:35840
    v_fmac_f32 v33, v32, v32
    ds_read_b64_tr_b16 v[80:81], v13 offset:28672
    v_mfma_f32_16x16x32_bf16 v[208:211], v[124:127], v[84:87], v[208:211]
    v_lshlrev_b32 v31, 16, v39
    ds_read_b64_tr_b16 v[82:83], v13 offset:35840
    v_mfma_f32_16x16x32_bf16 v[212:215], v[124:127], v[88:91], v[212:215]
    v_mfma_f32_16x16x32_bf16 v[216:219], v[124:127], v[92:95], v[216:219]
    v_mfma_f32_16x16x32_bf16 v[220:223], v[124:127], v[96:99], v[220:223]
    s_waitcnt vmcnt(12) lgkmcnt(0)
    s_barrier
    v_mfma_f32_16x16x32_bf16 v[128:131], v[60:63], v[40:43], v[128:131]
    s_cmp_lg_u32 s88, s89
    s_cbranch_scc1 L_q_10pfa
    buffer_load_dword v252, v253, s[36:39], s91 offen

L_q_10pfa:
    s_cmp_lg_u32 s88, s90
    s_cbranch_scc1 L_q_10pfb
    s_lshl_b32 s60, s2, 3
    s_add_u32 s60, s60, s20
    s_lshl_b32 s60, s60, 13
    s_mov_b32 s80, s12
    s_mov_b32 s81, s13
    s_mov_b32 s82, 0x700000
    s_mov_b32 s83, 0x20000
    buffer_load_dword v252, v253, s[80:83], s60 offen
    s_sub_u32 s60, s60, 0x800000
    s_mov_b32 s80, s8
    s_mov_b32 s81, s9
    s_mov_b32 s82, 0x200000
    buffer_load_dword v252, v253, s[80:83], s60 offen
L_q_10pfb:
    s_add_u32 s88, s88, 1
    v_mfma_f32_16x16x32_bf16 v[132:135], v[60:63], v[44:47], v[132:135]
    s_add_u32 m0, s53, 0x7000
    ds_read_b128 v[84:87], v19 offset:0
    v_mfma_f32_16x16x32_bf16 v[136:139], v[60:63], v[48:51], v[136:139]
    v_and_b32 v32, s84, v39
    buffer_load_dwordx4 v28, s[36:39], s51 offen lds
    v_mfma_f32_16x16x32_bf16 v[140:143], v[60:63], v[52:55], v[140:143]
    v_sub_f32 v31, v31, v34
    ds_read_b128 v[88:91], v19 offset:2048
    v_mfma_f32_16x16x32_bf16 v[224:227], v[60:63], v[56:59], v[224:227]
    v_sub_f32 v32, v32, v34
    ds_read_b128 v[92:95], v19 offset:4096
    v_mfma_f32_16x16x32_bf16 v[144:147], v[64:67], v[40:43], v[144:147]
    v_fmac_f32 v35, v31, v31
    ds_read_b128 v[96:99], v19 offset:6144
    v_mfma_f32_16x16x32_bf16 v[148:151], v[64:67], v[44:47], v[148:151]
    s_add_u32 m0, s56, 0x7000
    v_fmac_f32 v33, v32, v32
    ds_read_b128 v[100:103], v23
    v_mfma_f32_16x16x32_bf16 v[152:155], v[64:67], v[48:51], v[152:155]
    v_add_f32 v35, v35, v33
    buffer_load_dwordx4 v29, s[36:39], s51 offen lds
    v_mfma_f32_16x16x32_bf16 v[244:247], v[60:63], v[240:243], v[244:247]
    s_nop 1
    s_add_u32 s51, s51, 0x30000
    v_mfma_f32_16x16x32_bf16 v[156:159], v[64:67], v[52:55], v[156:159]
    ds_read_b64_tr_b16 v[104:105], v8 offset:43008
    v_add_f32_dpp v35, v35, v35 quad_perm:[1,0,3,2] row_mask:0xf bank_mask:0xf
    v_mfma_f32_16x16x32_bf16 v[160:163], v[68:71], v[40:43], v[160:163]
    ds_read_b64_tr_b16 v[106:107], v8 offset:50176
    s_nop 1
    v_mfma_f32_16x16x32_bf16 v[164:167], v[68:71], v[44:47], v[164:167]
    ds_read_b64_tr_b16 v[108:109], v9 offset:43008
    v_add_f32_dpp v35, v35, v35 quad_perm:[2,3,0,1] row_mask:0xf bank_mask:0xf
    v_mfma_f32_16x16x32_bf16 v[168:171], v[68:71], v[48:51], v[168:171]
    s_add_u32 m0, s49, 0x800
    s_nop 1
    ds_read_b64_tr_b16 v[110:111], v9 offset:50176
    v_mfma_f32_16x16x32_bf16 v[172:175], v[68:71], v[52:55], v[172:175]
    buffer_load_dwordx4 v26, s[32:35], s50 offen lds
    v_add_f32_dpp v35, v35, v35 row_half_mirror row_mask:0xf bank_mask:0xf
    v_mfma_f32_16x16x32_bf16 v[176:179], v[72:75], v[40:43], v[176:179]
    ds_read_b64_tr_b16 v[112:113], v10 offset:43008
    s_nop 1
    v_mfma_f32_16x16x32_bf16 v[180:183], v[72:75], v[44:47], v[180:183]
    ds_read_b64_tr_b16 v[114:115], v10 offset:50176
    v_add_f32_dpp v35, v35, v35 row_mirror row_mask:0xf bank_mask:0xf
    v_mfma_f32_16x16x32_bf16 v[184:187], v[72:75], v[48:51], v[184:187]
    ds_read_b64_tr_b16 v[116:117], v11 offset:43008
    s_add_u32 m0, s49, 0xc00
    v_mfma_f32_16x16x32_bf16 v[248:251], v[76:79], v[240:243], v[248:251]
    v_mov_b32 v33, v35
    ds_read_b64_tr_b16 v[118:119], v11 offset:50176
    v_mfma_f32_16x16x32_bf16 v[188:191], v[72:75], v[52:55], v[188:191]
    s_nop 1
    buffer_load_dwordx4 v27, s[32:35], s50 offen lds
    v_permlane16_swap_b32 v35, v33
    v_mfma_f32_16x16x32_bf16 v[192:195], v[76:79], v[40:43], v[192:195]
    s_add_u32 s50, s50, 128
    s_nop 1
    v_mfma_f32_16x16x32_bf16 v[196:199], v[76:79], v[44:47], v[196:199]
    s_add_u32 s55, s55, 128
    ds_read_b64_tr_b16 v[120:121], v12 offset:43008
    v_mfma_f32_16x16x32_bf16 v[200:203], v[76:79], v[48:51], v[200:203]
    v_add_f32 v35, v35, v33
    ds_read_b64_tr_b16 v[122:123], v12 offset:50176
    v_mfma_f32_16x16x32_bf16 v[204:207], v[76:79], v[52:55], v[204:207]
    v_mul_f32 v35, 0x3a800000, v35
    ds_read_b64_tr_b16 v[124:125], v13 offset:43008
    v_mfma_f32_16x16x32_bf16 v[208:211], v[80:83], v[40:43], v[208:211]
    v_cvt_pk_bf16_f32 v35, v35, v35
    ds_read_b64_tr_b16 v[126:127], v13 offset:50176
    v_mfma_f32_16x16x32_bf16 v[212:215], v[80:83], v[44:47], v[212:215]
    v_mfma_f32_16x16x32_bf16 v[216:219], v[80:83], v[48:51], v[216:219]
    v_mfma_f32_16x16x32_bf16 v[220:223], v[80:83], v[52:55], v[220:223]
    s_waitcnt vmcnt(9) lgkmcnt(0)
    s_barrier
    v_mfma_f32_16x16x32_bf16 v[128:131], v[104:107], v[84:87], v[128:131]
    s_cmp_lg_u32 s88, s89
    s_cbranch_scc1 L_q_11pfa
    buffer_load_dword v252, v253, s[36:39], s91 offen

L_q_11pfa:
    s_cmp_lg_u32 s88, s90
    s_cbranch_scc1 L_q_11pfb
    s_lshl_b32 s60, s2, 3
    s_add_u32 s60, s60, s20
    s_lshl_b32 s60, s60, 13
    s_mov_b32 s80, s12
    s_mov_b32 s81, s13
    s_mov_b32 s82, 0x700000
    s_mov_b32 s83, 0x20000
    buffer_load_dword v252, v253, s[80:83], s60 offen
    s_sub_u32 s60, s60, 0x800000
    s_mov_b32 s80, s8
    s_mov_b32 s81, s9
    s_mov_b32 s82, 0x200000
    buffer_load_dword v252, v253, s[80:83], s60 offen
L_q_11pfb:
    s_add_u32 s88, s88, 1
    v_mfma_f32_16x16x32_bf16 v[132:135], v[104:107], v[88:91], v[132:135]
    s_mov_b32 s58, s48
    s_add_u32 s49, s48, s52
    v_mfma_f32_16x16x32_bf16 v[136:139], v[104:107], v[92:95], v[136:139]
    s_add_u32 s48, s48, 0x8800
    s_cmp_eq_u32 s48, 0x19800
    s_cselect_b32 s48, 0, s48
    v_mfma_f32_16x16x32_bf16 v[140:143], v[104:107], v[96:99], v[140:143]
    v_add_u32 v18, s48, v16
    v_add_u32 v19, s48, v17
    v_mfma_f32_16x16x32_bf16 v[224:227], v[104:107], v[100:103], v[224:227]
    v_add_u32 v22, s48, v20
    v_add_u32 v23, s48, v21
    v_mfma_f32_16x16x32_bf16 v[144:147], v[108:111], v[84:87], v[144:147]
    s_add_u32 m0, s53, 0xa800
    ds_read_b128 v[40:43], v18 offset:0
    v_lshlrev_b32 v35, 16, v35
    v_mfma_f32_16x16x32_bf16 v[148:151], v[108:111], v[88:91], v[148:151]
    buffer_load_dwordx4 v28, s[36:39], s51 offen lds
    v_add_f32 v35, 0x3727c5ac, v35
    v_mfma_f32_16x16x32_bf16 v[152:155], v[108:111], v[92:95], v[152:155]
    ds_read_b128 v[44:47], v18 offset:2048
    ds_read_b128 v[48:51], v18 offset:4096
    v_mfma_f32_16x16x32_bf16 v[244:247], v[104:107], v[240:243], v[244:247]
    v_cvt_pk_bf16_f32 v35, v35, v35
    s_add_u32 m0, s56, 0xa800
    v_lshlrev_b32 v35, 16, v35
    v_mfma_f32_16x16x32_bf16 v[156:159], v[108:111], v[96:99], v[156:159]
    ds_read_b128 v[52:55], v18 offset:6144
    buffer_load_dwordx4 v29, s[36:39], s51 offen lds
    v_mfma_f32_16x16x32_bf16 v[160:163], v[112:115], v[84:87], v[160:163]
    v_sqrt_f32 v35, v35
    s_add_u32 s51, s51, 0x30000
    s_nop 0
    v_mfma_f32_16x16x32_bf16 v[164:167], v[112:115], v[88:91], v[164:167]
    ds_read_b128 v[56:59], v22
    ds_read_b64_tr_b16 v[60:61], v8 offset:0
    v_mfma_f32_16x16x32_bf16 v[168:171], v[112:115], v[92:95], v[168:171]
    v_cvt_pk_bf16_f32 v35, v35, v35
    s_add_u32 m0, s49, 0x0
    v_mfma_f32_16x16x32_bf16 v[172:175], v[112:115], v[96:99], v[172:175]
    ds_read_b64_tr_b16 v[62:63], v8 offset:7168
    v_lshlrev_b32 v35, 16, v35
    buffer_load_dwordx4 v24, s[32:35], s50 offen lds
    v_mfma_f32_16x16x32_bf16 v[176:179], v[116:119], v[84:87], v[176:179]
    v_rcp_f32 v33, v35
    ds_read_b64_tr_b16 v[64:65], v9 offset:0
    v_mfma_f32_16x16x32_bf16 v[180:183], v[116:119], v[88:91], v[180:183]
    ds_read_b64_tr_b16 v[66:67], v9 offset:7168
    v_cvt_pk_bf16_f32 v34, v34, v34
    v_mfma_f32_16x16x32_bf16 v[184:187], v[116:119], v[92:95], v[184:187]
    s_add_u32 m0, s49, 0x400
    v_lshlrev_b32 v34, 16, v34
    ds_read_b64_tr_b16 v[68:69], v10 offset:0
    v_mfma_f32_16x16x32_bf16 v[248:251], v[120:123], v[240:243], v[248:251]
    buffer_load_dwordx4 v25, s[32:35], s50 offen lds
    v_fma_f32 v35, -v33, v35, 1.0
    v_mfma_f32_16x16x32_bf16 v[188:191], v[116:119], v[96:99], v[188:191]
    ds_read_b64_tr_b16 v[70:71], v10 offset:7168
    ds_read_b64_tr_b16 v[72:73], v11 offset:0
    v_fma_f32 v35, v35, v33, v33
    v_mfma_f32_16x16x32_bf16 v[192:195], v[120:123], v[84:87], v[192:195]
    s_add_u32 m0, s57, s58
    v_xor_b32 v34, 0x80000000, v34
    v_mfma_f32_16x16x32_bf16 v[196:199], v[120:123], v[88:91], v[196:199]
    ds_read_b64_tr_b16 v[74:75], v11 offset:7168
    s_mov_b64 exec, 0xffff
    buffer_load_dwordx4 v30, s[32:35], s55 offen lds
    s_mov_b64 exec, -1
    v_mfma_f32_16x16x32_bf16 v[200:203], v[120:123], v[92:95], v[200:203]
    v_lshrrev_b32 v31, 5, v2
    ds_read_b64_tr_b16 v[76:77], v12 offset:0
    v_lshlrev_b32 v31, 3, v31
    v_mfma_f32_16x16x32_bf16 v[204:207], v[120:123], v[96:99], v[204:207]
    ds_read_b64_tr_b16 v[78:79], v12 offset:7168
    ds_read_b64_tr_b16 v[80:81], v13 offset:0
    v_mfma_f32_16x16x32_bf16 v[208:211], v[124:127], v[84:87], v[208:211]
    s_mov_b32 exec_lo, 1
    s_mov_b32 exec_hi, 1
    buffer_store_dwordx2 v[34:35], v31, s[28:31], s76 offen sc1
    s_mov_b64 exec, -1
    ds_read_b64_tr_b16 v[82:83], v13 offset:7168
    v_mfma_f32_16x16x32_bf16 v[212:215], v[124:127], v[88:91], v[212:215]
    v_mfma_f32_16x16x32_bf16 v[216:219], v[124:127], v[92:95], v[216:219]
    v_mfma_f32_16x16x32_bf16 v[220:223], v[124:127], v[96:99], v[220:223]
    s_waitcnt vmcnt(12) lgkmcnt(0)
.p2align 6
L_q_loop:
    s_barrier
    v_mfma_f32_16x16x32_bf16 v[128:131], v[60:63], v[40:43], v[128:131]
    s_cmp_lg_u32 s88, s89
    s_cbranch_scc1 L_q_12pfa
    buffer_load_dword v252, v253, s[36:39], s91 offen

L_q_12pfa:
    s_cmp_lg_u32 s88, s90
    s_cbranch_scc1 L_q_12pfb
    s_lshl_b32 s60, s2, 3
    s_add_u32 s60, s60, s20
    s_lshl_b32 s60, s60, 13
    s_mov_b32 s80, s12
    s_mov_b32 s81, s13
    s_mov_b32 s82, 0x700000
    s_mov_b32 s83, 0x20000
    buffer_load_dword v252, v253, s[80:83], s60 offen
    s_sub_u32 s60, s60, 0x800000
    s_mov_b32 s80, s8
    s_mov_b32 s81, s9
    s_mov_b32 s82, 0x200000
    buffer_load_dword v252, v253, s[80:83], s60 offen
L_q_12pfb:
    v_mfma_f32_16x16x32_bf16 v[132:135], v[60:63], v[44:47], v[132:135]
    s_add_u32 s88, s88, 1
    v_mfma_f32_16x16x32_bf16 v[136:139], v[60:63], v[48:51], v[136:139]
    s_add_u32 m0, s53, 0x0
    v_mfma_f32_16x16x32_bf16 v[140:143], v[60:63], v[52:55], v[140:143]
    ds_read_b128 v[84:87], v19 offset:0
    buffer_load_dwordx4 v28, s[36:39], s51 offen lds
    v_mfma_f32_16x16x32_bf16 v[224:227], v[60:63], v[56:59], v[224:227]
    ds_read_b128 v[88:91], v19 offset:2048
    v_mfma_f32_16x16x32_bf16 v[144:147], v[64:67], v[40:43], v[144:147]
    ds_read_b128 v[92:95], v19 offset:4096
    v_mfma_f32_16x16x32_bf16 v[148:151], v[64:67], v[44:47], v[148:151]
    ds_read_b128 v[96:99], v19 offset:6144
    s_add_u32 m0, s56, 0x0
    v_mfma_f32_16x16x32_bf16 v[152:155], v[64:67], v[48:51], v[152:155]
    ds_read_b128 v[100:103], v23
    v_mfma_f32_16x16x32_bf16 v[244:247], v[60:63], v[240:243], v[244:247]
    buffer_load_dwordx4 v29, s[36:39], s51 offen lds
    v_mfma_f32_16x16x32_bf16 v[156:159], v[64:67], v[52:55], v[156:159]
    s_add_u32 s51, s51, 0x30000
    v_mfma_f32_16x16x32_bf16 v[160:163], v[68:71], v[40:43], v[160:163]
    ds_read_b64_tr_b16 v[104:105], v8 offset:14336
    ds_read_b64_tr_b16 v[106:107], v8 offset:21504
    v_mfma_f32_16x16x32_bf16 v[164:167], v[68:71], v[44:47], v[164:167]
    ds_read_b64_tr_b16 v[108:109], v9 offset:14336
    v_mfma_f32_16x16x32_bf16 v[168:171], v[68:71], v[48:51], v[168:171]
    s_add_u32 m0, s49, 0x800
    v_mfma_f32_16x16x32_bf16 v[172:175], v[68:71], v[52:55], v[172:175]
    ds_read_b64_tr_b16 v[110:111], v9 offset:21504
    buffer_load_dwordx4 v26, s[32:35], s50 offen lds
    v_mfma_f32_16x16x32_bf16 v[176:179], v[72:75], v[40:43], v[176:179]
    ds_read_b64_tr_b16 v[112:113], v10 offset:14336
    v_mfma_f32_16x16x32_bf16 v[180:183], v[72:75], v[44:47], v[180:183]
    ds_read_b64_tr_b16 v[114:115], v10 offset:21504
    v_mfma_f32_16x16x32_bf16 v[184:187], v[72:75], v[48:51], v[184:187]
    ds_read_b64_tr_b16 v[116:117], v11 offset:14336
    v_mfma_f32_16x16x32_bf16 v[248:251], v[76:79], v[240:243], v[248:251]
    s_add_u32 m0, s49, 0xc00
    ds_read_b64_tr_b16 v[118:119], v11 offset:21504
    v_mfma_f32_16x16x32_bf16 v[188:191], v[72:75], v[52:55], v[188:191]
    buffer_load_dwordx4 v27, s[32:35], s50 offen lds
    v_mfma_f32_16x16x32_bf16 v[192:195], v[76:79], v[40:43], v[192:195]
    s_add_u32 s50, s50, 128
    v_mfma_f32_16x16x32_bf16 v[196:199], v[76:79], v[44:47], v[196:199]
    s_add_u32 s55, s55, 128
    ds_read_b64_tr_b16 v[120:121], v12 offset:14336
    v_mfma_f32_16x16x32_bf16 v[200:203], v[76:79], v[48:51], v[200:203]
    ds_read_b64_tr_b16 v[122:123], v12 offset:21504
    v_mfma_f32_16x16x32_bf16 v[204:207], v[76:79], v[52:55], v[204:207]
    ds_read_b64_tr_b16 v[124:125], v13 offset:14336
    v_mfma_f32_16x16x32_bf16 v[208:211], v[80:83], v[40:43], v[208:211]
    ds_read_b64_tr_b16 v[126:127], v13 offset:21504
    v_mfma_f32_16x16x32_bf16 v[212:215], v[80:83], v[44:47], v[212:215]
    v_mfma_f32_16x16x32_bf16 v[216:219], v[80:83], v[48:51], v[216:219]
    v_mfma_f32_16x16x32_bf16 v[220:223], v[80:83], v[52:55], v[220:223]
    s_waitcnt vmcnt(9) lgkmcnt(0)
    s_barrier
    v_mfma_f32_16x16x32_bf16 v[128:131], v[104:107], v[84:87], v[128:131]
    s_cmp_lg_u32 s88, s89
    s_cbranch_scc1 L_q_13pfa
    buffer_load_dword v252, v253, s[36:39], s91 offen

L_q_13pfa:
    s_cmp_lg_u32 s88, s90
    s_cbranch_scc1 L_q_13pfb
    s_lshl_b32 s60, s2, 3
    s_add_u32 s60, s60, s20
    s_lshl_b32 s60, s60, 13
    s_mov_b32 s80, s12
    s_mov_b32 s81, s13
    s_mov_b32 s82, 0x700000
    s_mov_b32 s83, 0x20000
    buffer_load_dword v252, v253, s[80:83], s60 offen
    s_sub_u32 s60, s60, 0x800000
    s_mov_b32 s80, s8
    s_mov_b32 s81, s9
    s_mov_b32 s82, 0x200000
    buffer_load_dword v252, v253, s[80:83], s60 offen
L_q_13pfb:
    v_mfma_f32_16x16x32_bf16 v[132:135], v[104:107], v[88:91], v[132:135]
    s_add_u32 s88, s88, 1
    s_mov_b32 s58, s48
    v_mfma_f32_16x16x32_bf16 v[136:139], v[104:107], v[92:95], v[136:139]
    s_add_u32 s49, s48, s52
    v_mfma_f32_16x16x32_bf16 v[140:143], v[104:107], v[96:99], v[140:143]
    s_add_u32 s48, s48, 0x8800
    s_cmp_eq_u32 s48, 0x19800
    v_mfma_f32_16x16x32_bf16 v[224:227], v[104:107], v[100:103], v[224:227]
    s_cselect_b32 s48, 0, s48
    v_add_u32 v18, s48, v16
    v_mfma_f32_16x16x32_bf16 v[144:147], v[108:111], v[84:87], v[144:147]
    v_add_u32 v19, s48, v17
    v_mfma_f32_16x16x32_bf16 v[148:151], v[108:111], v[88:91], v[148:151]
    v_add_u32 v22, s48, v20
    v_add_u32 v23, s48, v21
    v_mfma_f32_16x16x32_bf16 v[152:155], v[108:111], v[92:95], v[152:155]
    s_add_u32 m0, s53, 0x3800
    ds_read_b128 v[40:43], v18 offset:0
    v_mfma_f32_16x16x32_bf16 v[244:247], v[104:107], v[240:243], v[244:247]
    buffer_load_dwordx4 v28, s[36:39], s51 offen lds
    v_mfma_f32_16x16x32_bf16 v[156:159], v[108:111], v[96:99], v[156:159]
    ds_read_b128 v[44:47], v18 offset:2048
    ds_read_b128 v[48:51], v18 offset:4096
    v_mfma_f32_16x16x32_bf16 v[160:163], v[112:115], v[84:87], v[160:163]
    s_add_u32 m0, s56, 0x3800
    ds_read_b128 v[52:55], v18 offset:6144
    v_mfma_f32_16x16x32_bf16 v[164:167], v[112:115], v[88:91], v[164:167]
    buffer_load_dwordx4 v29, s[36:39], s51 offen lds
    v_mfma_f32_16x16x32_bf16 v[168:171], v[112:115], v[92:95], v[168:171]
    s_add_u32 s51, s51, 0x30000
    ds_read_b128 v[56:59], v22
    v_mfma_f32_16x16x32_bf16 v[172:175], v[112:115], v[96:99], v[172:175]
    ds_read_b64_tr_b16 v[60:61], v8 offset:28672
    s_add_u32 m0, s49, 0x0
    v_mfma_f32_16x16x32_bf16 v[176:179], v[116:119], v[84:87], v[176:179]
    ds_read_b64_tr_b16 v[62:63], v8 offset:35840
    v_mfma_f32_16x16x32_bf16 v[180:183], v[116:119], v[88:91], v[180:183]
    buffer_load_dwordx4 v24, s[32:35], s50 offen lds
    ds_read_b64_tr_b16 v[64:65], v9 offset:28672
    v_mfma_f32_16x16x32_bf16 v[184:187], v[116:119], v[92:95], v[184:187]
    ds_read_b64_tr_b16 v[66:67], v9 offset:35840
    s_add_u32 m0, s49, 0x400
    v_mfma_f32_16x16x32_bf16 v[248:251], v[120:123], v[240:243], v[248:251]
    ds_read_b64_tr_b16 v[68:69], v10 offset:28672
    v_mfma_f32_16x16x32_bf16 v[188:191], v[116:119], v[96:99], v[188:191]
    buffer_load_dwordx4 v25, s[32:35], s50 offen lds
    ds_read_b64_tr_b16 v[70:71], v10 offset:35840
    v_mfma_f32_16x16x32_bf16 v[192:195], v[120:123], v[84:87], v[192:195]
    ds_read_b64_tr_b16 v[72:73], v11 offset:28672
    s_add_u32 m0, s57, s58
    v_mfma_f32_16x16x32_bf16 v[196:199], v[120:123], v[88:91], v[196:199]
    ds_read_b64_tr_b16 v[74:75], v11 offset:35840
    v_mfma_f32_16x16x32_bf16 v[200:203], v[120:123], v[92:95], v[200:203]
    s_mov_b64 exec, 0xffff
    buffer_load_dwordx4 v30, s[32:35], s55 offen lds
    s_mov_b64 exec, -1
    ds_read_b64_tr_b16 v[76:77], v12 offset:28672
    v_mfma_f32_16x16x32_bf16 v[204:207], v[120:123], v[96:99], v[204:207]
    ds_read_b64_tr_b16 v[78:79], v12 offset:35840
    ds_read_b64_tr_b16 v[80:81], v13 offset:28672
    v_mfma_f32_16x16x32_bf16 v[208:211], v[124:127], v[84:87], v[208:211]
    ds_read_b64_tr_b16 v[82:83], v13 offset:35840
    v_mfma_f32_16x16x32_bf16 v[212:215], v[124:127], v[88:91], v[212:215]
    v_mfma_f32_16x16x32_bf16 v[216:219], v[124:127], v[92:95], v[216:219]
    v_mfma_f32_16x16x32_bf16 v[220:223], v[124:127], v[96:99], v[220:223]
    s_waitcnt vmcnt(12) lgkmcnt(0)
    s_barrier
    v_mfma_f32_16x16x32_bf16 v[128:131], v[60:63], v[40:43], v[128:131]
    s_or_b32 s60, s54, s20
    s_cbranch_scc1 L_q_noarr
    v_mov_b32 v7, 1
    s_lshl_b32 s60, s23, 2
    s_mov_b64 exec, 1
    buffer_atomic_add v7, off, s[40:43], s60 offset:4 sc1
    s_mov_b64 exec, -1
L_q_noarr:
    s_cmp_lg_u32 s88, s89
    s_cbranch_scc1 L_q_14pfa
    buffer_load_dword v252, v253, s[36:39], s91 offen

L_q_14pfa:
    v_mfma_f32_16x16x32_bf16 v[132:135], v[60:63], v[44:47], v[132:135]
    s_cmp_lg_u32 s88, s90
    s_cbranch_scc1 L_q_14pfb
    s_lshl_b32 s60, s2, 3
    s_add_u32 s60, s60, s20
    s_lshl_b32 s60, s60, 13
    s_mov_b32 s80, s12
    s_mov_b32 s81, s13
    s_mov_b32 s82, 0x700000
    s_mov_b32 s83, 0x20000
    buffer_load_dword v252, v253, s[80:83], s60 offen
    s_sub_u32 s60, s60, 0x800000
    s_mov_b32 s80, s8
    s_mov_b32 s81, s9
    s_mov_b32 s82, 0x200000
    buffer_load_dword v252, v253, s[80:83], s60 offen
L_q_14pfb:
    v_mfma_f32_16x16x32_bf16 v[136:139], v[60:63], v[48:51], v[136:139]
    s_add_u32 s88, s88, 1
    v_mfma_f32_16x16x32_bf16 v[140:143], v[60:63], v[52:55], v[140:143]
    s_add_u32 m0, s53, 0x7000
    ds_read_b128 v[84:87], v19 offset:0
    v_mfma_f32_16x16x32_bf16 v[224:227], v[60:63], v[56:59], v[224:227]
    buffer_load_dwordx4 v28, s[36:39], s51 offen lds
    v_mfma_f32_16x16x32_bf16 v[144:147], v[64:67], v[40:43], v[144:147]
    ds_read_b128 v[88:91], v19 offset:2048
    v_mfma_f32_16x16x32_bf16 v[148:151], v[64:67], v[44:47], v[148:151]
    ds_read_b128 v[92:95], v19 offset:4096
    ds_read_b128 v[96:99], v19 offset:6144
    v_mfma_f32_16x16x32_bf16 v[152:155], v[64:67], v[48:51], v[152:155]
    s_add_u32 m0, s56, 0x7000
    v_mfma_f32_16x16x32_bf16 v[244:247], v[60:63], v[240:243], v[244:247]
    ds_read_b128 v[100:103], v23
    v_mfma_f32_16x16x32_bf16 v[156:159], v[64:67], v[52:55], v[156:159]
    buffer_load_dwordx4 v29, s[36:39], s51 offen lds
    s_add_u32 s51, s51, 0x30000
    v_mfma_f32_16x16x32_bf16 v[160:163], v[68:71], v[40:43], v[160:163]
    ds_read_b64_tr_b16 v[104:105], v8 offset:43008
    v_mfma_f32_16x16x32_bf16 v[164:167], v[68:71], v[44:47], v[164:167]
    ds_read_b64_tr_b16 v[106:107], v8 offset:50176
    v_mfma_f32_16x16x32_bf16 v[168:171], v[68:71], v[48:51], v[168:171]
    ds_read_b64_tr_b16 v[108:109], v9 offset:43008
    s_add_u32 m0, s49, 0x800
    v_mfma_f32_16x16x32_bf16 v[172:175], v[68:71], v[52:55], v[172:175]
    ds_read_b64_tr_b16 v[110:111], v9 offset:50176
    v_mfma_f32_16x16x32_bf16 v[176:179], v[72:75], v[40:43], v[176:179]
    buffer_load_dwordx4 v26, s[32:35], s50 offen lds
    v_mfma_f32_16x16x32_bf16 v[180:183], v[72:75], v[44:47], v[180:183]
    ds_read_b64_tr_b16 v[112:113], v10 offset:43008
    ds_read_b64_tr_b16 v[114:115], v10 offset:50176
    v_mfma_f32_16x16x32_bf16 v[184:187], v[72:75], v[48:51], v[184:187]
    ds_read_b64_tr_b16 v[116:117], v11 offset:43008
    v_mfma_f32_16x16x32_bf16 v[248:251], v[76:79], v[240:243], v[248:251]
    s_add_u32 m0, s49, 0xc00
    v_mfma_f32_16x16x32_bf16 v[188:191], v[72:75], v[52:55], v[188:191]
    ds_read_b64_tr_b16 v[118:119], v11 offset:50176
    buffer_load_dwordx4 v27, s[32:35], s50 offen lds
    v_mfma_f32_16x16x32_bf16 v[192:195], v[76:79], v[40:43], v[192:195]
    s_add_u32 s50, s50, 128
    v_mfma_f32_16x16x32_bf16 v[196:199], v[76:79], v[44:47], v[196:199]
    s_add_u32 s55, s55, 128
    v_mfma_f32_16x16x32_bf16 v[200:203], v[76:79], v[48:51], v[200:203]
    ds_read_b64_tr_b16 v[120:121], v12 offset:43008
    ds_read_b64_tr_b16 v[122:123], v12 offset:50176
    v_mfma_f32_16x16x32_bf16 v[204:207], v[76:79], v[52:55], v[204:207]
    ds_read_b64_tr_b16 v[124:125], v13 offset:43008
    v_mfma_f32_16x16x32_bf16 v[208:211], v[80:83], v[40:43], v[208:211]
    ds_read_b64_tr_b16 v[126:127], v13 offset:50176
    v_mfma_f32_16x16x32_bf16 v[212:215], v[80:83], v[44:47], v[212:215]
    v_mfma_f32_16x16x32_bf16 v[216:219], v[80:83], v[48:51], v[216:219]
    v_mfma_f32_16x16x32_bf16 v[220:223], v[80:83], v[52:55], v[220:223]
    s_waitcnt vmcnt(9) lgkmcnt(0)
    s_barrier
    v_mfma_f32_16x16x32_bf16 v[128:131], v[104:107], v[84:87], v[128:131]
    s_cmp_lg_u32 s88, s89
    s_cbranch_scc1 L_q_15pfa
    buffer_load_dword v252, v253, s[36:39], s91 offen

L_q_15pfa:
    s_cmp_lg_u32 s88, s90
    s_cbranch_scc1 L_q_15pfb
    s_lshl_b32 s60, s2, 3
    s_add_u32 s60, s60, s20
    s_lshl_b32 s60, s60, 13
    s_mov_b32 s80, s12
    s_mov_b32 s81, s13
    s_mov_b32 s82, 0x700000
    s_mov_b32 s83, 0x20000
    buffer_load_dword v252, v253, s[80:83], s60 offen
    s_sub_u32 s60, s60, 0x800000
    s_mov_b32 s80, s8
    s_mov_b32 s81, s9
    s_mov_b32 s82, 0x200000
    buffer_load_dword v252, v253, s[80:83], s60 offen
L_q_15pfb:
    v_mfma_f32_16x16x32_bf16 v[132:135], v[104:107], v[88:91], v[132:135]
    s_add_u32 s88, s88, 1
    s_mov_b32 s58, s48
    v_mfma_f32_16x16x32_bf16 v[136:139], v[104:107], v[92:95], v[136:139]
    s_add_u32 s49, s48, s52
    v_mfma_f32_16x16x32_bf16 v[140:143], v[104:107], v[96:99], v[140:143]
    s_add_u32 s48, s48, 0x8800
    s_cmp_eq_u32 s48, 0x19800
    v_mfma_f32_16x16x32_bf16 v[224:227], v[104:107], v[100:103], v[224:227]
    s_cselect_b32 s48, 0, s48
    v_add_u32 v18, s48, v16
    v_mfma_f32_16x16x32_bf16 v[144:147], v[108:111], v[84:87], v[144:147]
    v_add_u32 v19, s48, v17
    v_mfma_f32_16x16x32_bf16 v[148:151], v[108:111], v[88:91], v[148:151]
    v_add_u32 v22, s48, v20
    v_add_u32 v23, s48, v21
    v_mfma_f32_16x16x32_bf16 v[152:155], v[108:111], v[92:95], v[152:155]
    s_add_u32 m0, s53, 0xa800
    ds_read_b128 v[40:43], v18 offset:0
    v_mfma_f32_16x16x32_bf16 v[244:247], v[104:107], v[240:243], v[244:247]
    buffer_load_dwordx4 v28, s[36:39], s51 offen lds
    v_mfma_f32_16x16x32_bf16 v[156:159], v[108:111], v[96:99], v[156:159]
    ds_read_b128 v[44:47], v18 offset:2048
    ds_read_b128 v[48:51], v18 offset:4096
    v_mfma_f32_16x16x32_bf16 v[160:163], v[112:115], v[84:87], v[160:163]
    s_add_u32 m0, s56, 0xa800
    ds_read_b128 v[52:55], v18 offset:6144
    v_mfma_f32_16x16x32_bf16 v[164:167], v[112:115], v[88:91], v[164:167]
    buffer_load_dwordx4 v29, s[36:39], s51 offen lds
    v_mfma_f32_16x16x32_bf16 v[168:171], v[112:115], v[92:95], v[168:171]
    s_add_u32 s51, s51, 0x30000
    ds_read_b128 v[56:59], v22
    v_mfma_f32_16x16x32_bf16 v[172:175], v[112:115], v[96:99], v[172:175]
    ds_read_b64_tr_b16 v[60:61], v8 offset:0
    s_add_u32 m0, s49, 0x0
    v_mfma_f32_16x16x32_bf16 v[176:179], v[116:119], v[84:87], v[176:179]
    ds_read_b64_tr_b16 v[62:63], v8 offset:7168
    v_mfma_f32_16x16x32_bf16 v[180:183], v[116:119], v[88:91], v[180:183]
    buffer_load_dwordx4 v24, s[32:35], s50 offen lds
    ds_read_b64_tr_b16 v[64:65], v9 offset:0
    v_mfma_f32_16x16x32_bf16 v[184:187], v[116:119], v[92:95], v[184:187]
    ds_read_b64_tr_b16 v[66:67], v9 offset:7168
    s_add_u32 m0, s49, 0x400
    v_mfma_f32_16x16x32_bf16 v[248:251], v[120:123], v[240:243], v[248:251]
    ds_read_b64_tr_b16 v[68:69], v10 offset:0
    v_mfma_f32_16x16x32_bf16 v[188:191], v[116:119], v[96:99], v[188:191]
    buffer_load_dwordx4 v25, s[32:35], s50 offen lds
    ds_read_b64_tr_b16 v[70:71], v10 offset:7168
    v_mfma_f32_16x16x32_bf16 v[192:195], v[120:123], v[84:87], v[192:195]
    ds_read_b64_tr_b16 v[72:73], v11 offset:0
    s_add_u32 m0, s57, s58
    v_mfma_f32_16x16x32_bf16 v[196:199], v[120:123], v[88:91], v[196:199]
    ds_read_b64_tr_b16 v[74:75], v11 offset:7168
    v_mfma_f32_16x16x32_bf16 v[200:203], v[120:123], v[92:95], v[200:203]
    s_mov_b64 exec, 0xffff
    buffer_load_dwordx4 v30, s[32:35], s55 offen lds
    s_mov_b64 exec, -1
    ds_read_b64_tr_b16 v[76:77], v12 offset:0
    v_mfma_f32_16x16x32_bf16 v[204:207], v[120:123], v[96:99], v[204:207]
    ds_read_b64_tr_b16 v[78:79], v12 offset:7168
    ds_read_b64_tr_b16 v[80:81], v13 offset:0
    v_mfma_f32_16x16x32_bf16 v[208:211], v[124:127], v[84:87], v[208:211]
    ds_read_b64_tr_b16 v[82:83], v13 offset:7168
    v_mfma_f32_16x16x32_bf16 v[212:215], v[124:127], v[88:91], v[212:215]
    v_mfma_f32_16x16x32_bf16 v[216:219], v[124:127], v[92:95], v[216:219]
    v_mfma_f32_16x16x32_bf16 v[220:223], v[124:127], v[96:99], v[220:223]
    s_waitcnt vmcnt(12) lgkmcnt(0)
    s_add_u32 s54, s54, 1
    s_cmp_lt_u32 s54, 3
    s_cbranch_scc1 L_q_loop
    s_barrier
    v_mfma_f32_16x16x32_bf16 v[128:131], v[60:63], v[40:43], v[128:131]
    s_lshl_b32 s79, s23, 2
    buffer_load_dwordx2 v[252:253], off, s[40:43], s79 sc1
    s_add_u32 m0, s53, 0x0
    v_mfma_f32_16x16x32_bf16 v[132:135], v[60:63], v[44:47], v[132:135]
    ds_read_b128 v[84:87], v19 offset:0
    v_mfma_f32_16x16x32_bf16 v[136:139], v[60:63], v[48:51], v[136:139]
    buffer_load_dwordx4 v28, s[36:39], s51 offen lds
    v_mfma_f32_16x16x32_bf16 v[140:143], v[60:63], v[52:55], v[140:143]
    ds_read_b128 v[88:91], v19 offset:2048
    v_mfma_f32_16x16x32_bf16 v[224:227], v[60:63], v[56:59], v[224:227]
    ds_read_b128 v[92:95], v19 offset:4096
    ds_read_b128 v[96:99], v19 offset:6144
    v_mfma_f32_16x16x32_bf16 v[144:147], v[64:67], v[40:43], v[144:147]
    s_add_u32 m0, s56, 0x0
    v_mfma_f32_16x16x32_bf16 v[148:151], v[64:67], v[44:47], v[148:151]
    ds_read_b128 v[100:103], v23
    v_mfma_f32_16x16x32_bf16 v[152:155], v[64:67], v[48:51], v[152:155]
    buffer_load_dwordx4 v29, s[36:39], s51 offen lds
    v_mfma_f32_16x16x32_bf16 v[244:247], v[60:63], v[240:243], v[244:247]
    s_add_u32 s51, s51, 0x30000
    v_mfma_f32_16x16x32_bf16 v[156:159], v[64:67], v[52:55], v[156:159]
    ds_read_b64_tr_b16 v[104:105], v8 offset:14336
    ds_read_b64_tr_b16 v[106:107], v8 offset:21504
    v_mfma_f32_16x16x32_bf16 v[160:163], v[68:71], v[40:43], v[160:163]
    ds_read_b64_tr_b16 v[108:109], v9 offset:14336
    v_mfma_f32_16x16x32_bf16 v[164:167], v[68:71], v[44:47], v[164:167]
    s_add_u32 m0, s49, 0x800
    v_mfma_f32_16x16x32_bf16 v[168:171], v[68:71], v[48:51], v[168:171]
    ds_read_b64_tr_b16 v[110:111], v9 offset:21504
    v_mfma_f32_16x16x32_bf16 v[172:175], v[68:71], v[52:55], v[172:175]
    buffer_load_dwordx4 v26, s[32:35], s50 offen lds
    v_mfma_f32_16x16x32_bf16 v[176:179], v[72:75], v[40:43], v[176:179]
    ds_read_b64_tr_b16 v[112:113], v10 offset:14336
    ds_read_b64_tr_b16 v[114:115], v10 offset:21504
    v_mfma_f32_16x16x32_bf16 v[180:183], v[72:75], v[44:47], v[180:183]
    ds_read_b64_tr_b16 v[116:117], v11 offset:14336
    v_mfma_f32_16x16x32_bf16 v[184:187], v[72:75], v[48:51], v[184:187]
    s_add_u32 m0, s49, 0xc00
    v_mfma_f32_16x16x32_bf16 v[248:251], v[76:79], v[240:243], v[248:251]
    ds_read_b64_tr_b16 v[118:119], v11 offset:21504
    v_mfma_f32_16x16x32_bf16 v[188:191], v[72:75], v[52:55], v[188:191]
    buffer_load_dwordx4 v27, s[32:35], s50 offen lds
    v_mfma_f32_16x16x32_bf16 v[192:195], v[76:79], v[40:43], v[192:195]
    s_add_u32 s50, s50, 128
    s_add_u32 s55, s55, 128
    v_mfma_f32_16x16x32_bf16 v[196:199], v[76:79], v[44:47], v[196:199]
    ds_read_b64_tr_b16 v[120:121], v12 offset:14336
    v_mfma_f32_16x16x32_bf16 v[200:203], v[76:79], v[48:51], v[200:203]
    ds_read_b64_tr_b16 v[122:123], v12 offset:21504
    v_mfma_f32_16x16x32_bf16 v[204:207], v[76:79], v[52:55], v[204:207]
    ds_read_b64_tr_b16 v[124:125], v13 offset:14336
    v_mfma_f32_16x16x32_bf16 v[208:211], v[80:83], v[40:43], v[208:211]
    ds_read_b64_tr_b16 v[126:127], v13 offset:21504
    v_mfma_f32_16x16x32_bf16 v[212:215], v[80:83], v[44:47], v[212:215]
    v_mfma_f32_16x16x32_bf16 v[216:219], v[80:83], v[48:51], v[216:219]
    v_mfma_f32_16x16x32_bf16 v[220:223], v[80:83], v[52:55], v[220:223]
    s_waitcnt vmcnt(9) lgkmcnt(0)
    s_barrier
    v_mfma_f32_16x16x32_bf16 v[128:131], v[104:107], v[84:87], v[128:131]
    s_mov_b32 s58, s48
    s_add_u32 s49, s48, s52
    v_mfma_f32_16x16x32_bf16 v[132:135], v[104:107], v[88:91], v[132:135]
    s_add_u32 s48, s48, 0x8800
    s_cmp_eq_u32 s48, 0x19800
    v_mfma_f32_16x16x32_bf16 v[136:139], v[104:107], v[92:95], v[136:139]
    s_cselect_b32 s48, 0, s48
    v_mfma_f32_16x16x32_bf16 v[140:143], v[104:107], v[96:99], v[140:143]
    v_add_u32 v18, s48, v16
    v_add_u32 v19, s48, v17
    v_mfma_f32_16x16x32_bf16 v[224:227], v[104:107], v[100:103], v[224:227]
    v_add_u32 v22, s48, v20
    v_mfma_f32_16x16x32_bf16 v[144:147], v[108:111], v[84:87], v[144:147]
    v_add_u32 v23, s48, v21
    s_add_u32 m0, s53, 0x3800
    v_mfma_f32_16x16x32_bf16 v[148:151], v[108:111], v[88:91], v[148:151]
    ds_read_b128 v[40:43], v18 offset:0
    v_mfma_f32_16x16x32_bf16 v[152:155], v[108:111], v[92:95], v[152:155]
    buffer_load_dwordx4 v28, s[36:39], s51 offen lds
    ds_read_b128 v[44:47], v18 offset:2048
    v_mfma_f32_16x16x32_bf16 v[244:247], v[104:107], v[240:243], v[244:247]
    ds_read_b128 v[48:51], v18 offset:4096
    v_mfma_f32_16x16x32_bf16 v[156:159], v[108:111], v[96:99], v[156:159]
    s_add_u32 m0, s56, 0x3800
    ds_read_b128 v[52:55], v18 offset:6144
    v_mfma_f32_16x16x32_bf16 v[160:163], v[112:115], v[84:87], v[160:163]
    buffer_load_dwordx4 v29, s[36:39], s51 offen lds
    v_mfma_f32_16x16x32_bf16 v[164:167], v[112:115], v[88:91], v[164:167]
    s_add_u32 s51, s51, 0x30000
    ds_read_b128 v[56:59], v22
    v_mfma_f32_16x16x32_bf16 v[168:171], v[112:115], v[92:95], v[168:171]
    ds_read_b64_tr_b16 v[60:61], v8 offset:28672
    s_add_u32 m0, s49, 0x0
    v_mfma_f32_16x16x32_bf16 v[172:175], v[112:115], v[96:99], v[172:175]
    ds_read_b64_tr_b16 v[62:63], v8 offset:35840
    v_mfma_f32_16x16x32_bf16 v[176:179], v[116:119], v[84:87], v[176:179]
    buffer_load_dwordx4 v24, s[32:35], s50 offen lds
    ds_read_b64_tr_b16 v[64:65], v9 offset:28672
    v_mfma_f32_16x16x32_bf16 v[180:183], v[116:119], v[88:91], v[180:183]
    ds_read_b64_tr_b16 v[66:67], v9 offset:35840
    v_mfma_f32_16x16x32_bf16 v[184:187], v[116:119], v[92:95], v[184:187]
    s_add_u32 m0, s49, 0x400
    ds_read_b64_tr_b16 v[68:69], v10 offset:28672
    v_mfma_f32_16x16x32_bf16 v[248:251], v[120:123], v[240:243], v[248:251]
    buffer_load_dwordx4 v25, s[32:35], s50 offen lds
    v_mfma_f32_16x16x32_bf16 v[188:191], v[116:119], v[96:99], v[188:191]
    ds_read_b64_tr_b16 v[70:71], v10 offset:35840
    ds_read_b64_tr_b16 v[72:73], v11 offset:28672
    v_mfma_f32_16x16x32_bf16 v[192:195], v[120:123], v[84:87], v[192:195]
    s_add_u32 m0, s57, s58
    v_mfma_f32_16x16x32_bf16 v[196:199], v[120:123], v[88:91], v[196:199]
    ds_read_b64_tr_b16 v[74:75], v11 offset:35840
    s_mov_b64 exec, 0xffff
    buffer_load_dwordx4 v30, s[32:35], s55 offen lds
    s_mov_b64 exec, -1
    v_mfma_f32_16x16x32_bf16 v[200:203], v[120:123], v[92:95], v[200:203]
    ds_read_b64_tr_b16 v[76:77], v12 offset:28672
    v_mfma_f32_16x16x32_bf16 v[204:207], v[120:123], v[96:99], v[204:207]
    ds_read_b64_tr_b16 v[78:79], v12 offset:35840
    ds_read_b64_tr_b16 v[80:81], v13 offset:28672
    v_mfma_f32_16x16x32_bf16 v[208:211], v[124:127], v[84:87], v[208:211]
    ds_read_b64_tr_b16 v[82:83], v13 offset:35840
    v_mfma_f32_16x16x32_bf16 v[212:215], v[124:127], v[88:91], v[212:215]
    v_mfma_f32_16x16x32_bf16 v[216:219], v[124:127], v[92:95], v[216:219]
    v_mfma_f32_16x16x32_bf16 v[220:223], v[124:127], v[96:99], v[220:223]
    s_waitcnt vmcnt(12) lgkmcnt(0)
    s_barrier
    v_mfma_f32_16x16x32_bf16 v[128:131], v[60:63], v[40:43], v[128:131]
    s_add_u32 m0, s53, 0x7000
    ds_read_b128 v[84:87], v19 offset:0
    v_mfma_f32_16x16x32_bf16 v[132:135], v[60:63], v[44:47], v[132:135]
    buffer_load_dwordx4 v28, s[36:39], s51 offen lds
    v_mfma_f32_16x16x32_bf16 v[136:139], v[60:63], v[48:51], v[136:139]
    ds_read_b128 v[88:91], v19 offset:2048
    v_mfma_f32_16x16x32_bf16 v[140:143], v[60:63], v[52:55], v[140:143]
    ds_read_b128 v[92:95], v19 offset:4096
    v_mfma_f32_16x16x32_bf16 v[224:227], v[60:63], v[56:59], v[224:227]
    ds_read_b128 v[96:99], v19 offset:6144
    v_mfma_f32_16x16x32_bf16 v[144:147], v[64:67], v[40:43], v[144:147]
    s_add_u32 m0, s56, 0x7000
    v_mfma_f32_16x16x32_bf16 v[148:151], v[64:67], v[44:47], v[148:151]
    ds_read_b128 v[100:103], v23
    buffer_load_dwordx4 v29, s[36:39], s51 offen lds
    v_mfma_f32_16x16x32_bf16 v[152:155], v[64:67], v[48:51], v[152:155]
    s_add_u32 s51, s51, 0x30000
    v_mfma_f32_16x16x32_bf16 v[244:247], v[60:63], v[240:243], v[244:247]
    ds_read_b64_tr_b16 v[104:105], v8 offset:43008
    v_mfma_f32_16x16x32_bf16 v[156:159], v[64:67], v[52:55], v[156:159]
    ds_read_b64_tr_b16 v[106:107], v8 offset:50176
    v_mfma_f32_16x16x32_bf16 v[160:163], v[68:71], v[40:43], v[160:163]
    ds_read_b64_tr_b16 v[108:109], v9 offset:43008
    v_mfma_f32_16x16x32_bf16 v[164:167], v[68:71], v[44:47], v[164:167]
    s_add_u32 m0, s49, 0x800
    v_mfma_f32_16x16x32_bf16 v[168:171], v[68:71], v[48:51], v[168:171]
    ds_read_b64_tr_b16 v[110:111], v9 offset:50176
    buffer_load_dwordx4 v26, s[32:35], s50 offen lds
    v_mfma_f32_16x16x32_bf16 v[172:175], v[68:71], v[52:55], v[172:175]
    ds_read_b64_tr_b16 v[112:113], v10 offset:43008
    v_mfma_f32_16x16x32_bf16 v[176:179], v[72:75], v[40:43], v[176:179]
    ds_read_b64_tr_b16 v[114:115], v10 offset:50176
    v_mfma_f32_16x16x32_bf16 v[180:183], v[72:75], v[44:47], v[180:183]
    ds_read_b64_tr_b16 v[116:117], v11 offset:43008
    v_mfma_f32_16x16x32_bf16 v[184:187], v[72:75], v[48:51], v[184:187]
    s_add_u32 m0, s49, 0xc00
    v_mfma_f32_16x16x32_bf16 v[248:251], v[76:79], v[240:243], v[248:251]
    ds_read_b64_tr_b16 v[118:119], v11 offset:50176
    v_mfma_f32_16x16x32_bf16 v[188:191], v[72:75], v[52:55], v[188:191]
    buffer_load_dwordx4 v27, s[32:35], s50 offen lds
    s_add_u32 s50, s50, 128
    v_mfma_f32_16x16x32_bf16 v[192:195], v[76:79], v[40:43], v[192:195]
    s_add_u32 s55, s55, 128
    v_mfma_f32_16x16x32_bf16 v[196:199], v[76:79], v[44:47], v[196:199]
    ds_read_b64_tr_b16 v[120:121], v12 offset:43008
    v_mfma_f32_16x16x32_bf16 v[200:203], v[76:79], v[48:51], v[200:203]
    ds_read_b64_tr_b16 v[122:123], v12 offset:50176
    v_mfma_f32_16x16x32_bf16 v[204:207], v[76:79], v[52:55], v[204:207]
    ds_read_b64_tr_b16 v[124:125], v13 offset:43008
    v_mfma_f32_16x16x32_bf16 v[208:211], v[80:83], v[40:43], v[208:211]
    ds_read_b64_tr_b16 v[126:127], v13 offset:50176
    v_mfma_f32_16x16x32_bf16 v[212:215], v[80:83], v[44:47], v[212:215]
    v_mfma_f32_16x16x32_bf16 v[216:219], v[80:83], v[48:51], v[216:219]
    v_mfma_f32_16x16x32_bf16 v[220:223], v[80:83], v[52:55], v[220:223]
    s_waitcnt vmcnt(9) lgkmcnt(0)
    s_barrier
    v_mfma_f32_16x16x32_bf16 v[128:131], v[104:107], v[84:87], v[128:131]
    s_mov_b32 s58, s48
    s_add_u32 s49, s48, s52
    v_mfma_f32_16x16x32_bf16 v[132:135], v[104:107], v[88:91], v[132:135]
    s_add_u32 s48, s48, 0x8800
    v_mfma_f32_16x16x32_bf16 v[136:139], v[104:107], v[92:95], v[136:139]
    s_cmp_eq_u32 s48, 0x19800
    v_mfma_f32_16x16x32_bf16 v[140:143], v[104:107], v[96:99], v[140:143]
    s_cselect_b32 s48, 0, s48
    v_add_u32 v18, s48, v16
    v_mfma_f32_16x16x32_bf16 v[224:227], v[104:107], v[100:103], v[224:227]
    v_add_u32 v19, s48, v17
    v_mfma_f32_16x16x32_bf16 v[144:147], v[108:111], v[84:87], v[144:147]
    v_add_u32 v22, s48, v20
    v_mfma_f32_16x16x32_bf16 v[148:151], v[108:111], v[88:91], v[148:151]
    v_add_u32 v23, s48, v21
    s_mov_b32 s61, 0
L_q_chk:
    v_readfirstlane_b32 s60, v253
    v_readfirstlane_b32 s62, v252
    s_cmp_eq_u32 s23, 0
    s_cselect_b32 s62, 32, s62
    s_min_u32 s60, s60, s62
    s_cmp_ge_u32 s60, 32
    s_cbranch_scc1 L_q_chkok
    s_sleep 2
    buffer_load_dwordx2 v[252:253], off, s[40:43], s79 sc1
    s_waitcnt vmcnt(0)
    s_add_u32 s61, s61, 1
    s_cmp_lt_u32 s61, 0x20000
    s_cbranch_scc1 L_q_chk
L_q_chkok:
    v_mfma_f32_16x16x32_bf16 v[152:155], v[108:111], v[92:95], v[152:155]
    s_add_u32 m0, s53, 0xa800
    v_mfma_f32_16x16x32_bf16 v[244:247], v[104:107], v[240:243], v[244:247]
    ds_read_b128 v[40:43], v18 offset:0
    v_mfma_f32_16x16x32_bf16 v[156:159], v[108:111], v[96:99], v[156:159]
    buffer_load_dwordx4 v28, s[36:39], s51 offen lds
    ds_read_b128 v[44:47], v18 offset:2048
    v_mfma_f32_16x16x32_bf16 v[160:163], v[112:115], v[84:87], v[160:163]
    ds_read_b128 v[48:51], v18 offset:4096
    v_mfma_f32_16x16x32_bf16 v[164:167], v[112:115], v[88:91], v[164:167]
    ds_read_b128 v[52:55], v18 offset:6144
    v_mfma_f32_16x16x32_bf16 v[168:171], v[112:115], v[92:95], v[168:171]
    ds_read_b128 v[56:59], v22
    ds_read_b64_tr_b16 v[60:61], v8 offset:0
    v_mfma_f32_16x16x32_bf16 v[172:175], v[112:115], v[96:99], v[172:175]
    s_add_u32 m0, s56, 0xa800
    v_mfma_f32_16x16x32_bf16 v[176:179], v[116:119], v[84:87], v[176:179]
    ds_read_b64_tr_b16 v[62:63], v8 offset:7168
    v_mfma_f32_16x16x32_bf16 v[180:183], v[116:119], v[88:91], v[180:183]
    buffer_load_dwordx4 v29, s[36:39], s51 offen lds
    s_add_u32 s51, s51, 0x30000
    v_mfma_f32_16x16x32_bf16 v[184:187], v[116:119], v[92:95], v[184:187]
    ds_read_b64_tr_b16 v[64:65], v9 offset:0
    v_mfma_f32_16x16x32_bf16 v[248:251], v[120:123], v[240:243], v[248:251]
    ds_read_b64_tr_b16 v[66:67], v9 offset:7168
    v_mfma_f32_16x16x32_bf16 v[188:191], v[116:119], v[96:99], v[188:191]
    ds_read_b64_tr_b16 v[68:69], v10 offset:0
    ds_read_b64_tr_b16 v[70:71], v10 offset:7168
    v_mfma_f32_16x16x32_bf16 v[192:195], v[120:123], v[84:87], v[192:195]
    ds_read_b64_tr_b16 v[72:73], v11 offset:0
    v_mfma_f32_16x16x32_bf16 v[196:199], v[120:123], v[88:91], v[196:199]
    ds_read_b64_tr_b16 v[74:75], v11 offset:7168
    v_mfma_f32_16x16x32_bf16 v[200:203], v[120:123], v[92:95], v[200:203]
    ds_read_b64_tr_b16 v[76:77], v12 offset:0
    ds_read_b64_tr_b16 v[78:79], v12 offset:7168
    v_mfma_f32_16x16x32_bf16 v[204:207], v[120:123], v[96:99], v[204:207]
    ds_read_b64_tr_b16 v[80:81], v13 offset:0
    v_mfma_f32_16x16x32_bf16 v[208:211], v[124:127], v[84:87], v[208:211]
    ds_read_b64_tr_b16 v[82:83], v13 offset:7168
    v_mfma_f32_16x16x32_bf16 v[212:215], v[124:127], v[88:91], v[212:215]
    v_mfma_f32_16x16x32_bf16 v[216:219], v[124:127], v[92:95], v[216:219]
    v_mfma_f32_16x16x32_bf16 v[220:223], v[124:127], v[96:99], v[220:223]
    s_waitcnt vmcnt(9) lgkmcnt(0)
    s_barrier
    v_mfma_f32_16x16x32_bf16 v[128:131], v[60:63], v[40:43], v[128:131]
    ds_read_b128 v[84:87], v19 offset:0
    v_mfma_f32_16x16x32_bf16 v[132:135], v[60:63], v[44:47], v[132:135]
    ds_read_b128 v[88:91], v19 offset:2048
    v_mfma_f32_16x16x32_bf16 v[136:139], v[60:63], v[48:51], v[136:139]
    ds_read_b128 v[92:95], v19 offset:4096
    v_mfma_f32_16x16x32_bf16 v[140:143], v[60:63], v[52:55], v[140:143]
    v_mfma_f32_16x16x32_bf16 v[224:227], v[60:63], v[56:59], v[224:227]
    ds_read_b128 v[96:99], v19 offset:6144
    v_mfma_f32_16x16x32_bf16 v[144:147], v[64:67], v[40:43], v[144:147]
    ds_read_b128 v[100:103], v23
    v_mfma_f32_16x16x32_bf16 v[148:151], v[64:67], v[44:47], v[148:151]
    v_mfma_f32_16x16x32_bf16 v[152:155], v[64:67], v[48:51], v[152:155]
    ds_read_b64_tr_b16 v[104:105], v8 offset:14336
    v_mfma_f32_16x16x32_bf16 v[244:247], v[60:63], v[240:243], v[244:247]
    ds_read_b64_tr_b16 v[106:107], v8 offset:21504
    v_mfma_f32_16x16x32_bf16 v[156:159], v[64:67], v[52:55], v[156:159]
    ds_read_b64_tr_b16 v[108:109], v9 offset:14336
    v_mfma_f32_16x16x32_bf16 v[160:163], v[68:71], v[40:43], v[160:163]
    v_mfma_f32_16x16x32_bf16 v[164:167], v[68:71], v[44:47], v[164:167]
    ds_read_b64_tr_b16 v[110:111], v9 offset:21504
    v_mfma_f32_16x16x32_bf16 v[168:171], v[68:71], v[48:51], v[168:171]
    ds_read_b64_tr_b16 v[112:113], v10 offset:14336
    v_mfma_f32_16x16x32_bf16 v[172:175], v[68:71], v[52:55], v[172:175]
    v_mfma_f32_16x16x32_bf16 v[176:179], v[72:75], v[40:43], v[176:179]
    ds_read_b64_tr_b16 v[114:115], v10 offset:21504
    v_mfma_f32_16x16x32_bf16 v[180:183], v[72:75], v[44:47], v[180:183]
    ds_read_b64_tr_b16 v[116:117], v11 offset:14336
    v_mfma_f32_16x16x32_bf16 v[184:187], v[72:75], v[48:51], v[184:187]
    ds_read_b64_tr_b16 v[118:119], v11 offset:21504
    v_mfma_f32_16x16x32_bf16 v[248:251], v[76:79], v[240:243], v[248:251]
    v_mfma_f32_16x16x32_bf16 v[188:191], v[72:75], v[52:55], v[188:191]
    ds_read_b64_tr_b16 v[120:121], v12 offset:14336
    v_mfma_f32_16x16x32_bf16 v[192:195], v[76:79], v[40:43], v[192:195]
    ds_read_b64_tr_b16 v[122:123], v12 offset:21504
    v_mfma_f32_16x16x32_bf16 v[196:199], v[76:79], v[44:47], v[196:199]
    v_mfma_f32_16x16x32_bf16 v[200:203], v[76:79], v[48:51], v[200:203]
    ds_read_b64_tr_b16 v[124:125], v13 offset:14336
    v_mfma_f32_16x16x32_bf16 v[204:207], v[76:79], v[52:55], v[204:207]
    ds_read_b64_tr_b16 v[126:127], v13 offset:21504
    v_mfma_f32_16x16x32_bf16 v[208:211], v[80:83], v[40:43], v[208:211]
    v_mfma_f32_16x16x32_bf16 v[212:215], v[80:83], v[44:47], v[212:215]
    v_mfma_f32_16x16x32_bf16 v[216:219], v[80:83], v[48:51], v[216:219]
    v_mfma_f32_16x16x32_bf16 v[220:223], v[80:83], v[52:55], v[220:223]
    s_waitcnt vmcnt(2) lgkmcnt(0)
    s_barrier
    v_mfma_f32_16x16x32_bf16 v[128:131], v[104:107], v[84:87], v[128:131]
    s_mov_b32 s58, s48
    s_add_u32 s49, s48, s52
    v_mfma_f32_16x16x32_bf16 v[132:135], v[104:107], v[88:91], v[132:135]
    s_add_u32 s48, s48, 0x8800
    v_mfma_f32_16x16x32_bf16 v[136:139], v[104:107], v[92:95], v[136:139]
    s_cmp_eq_u32 s48, 0x19800
    v_mfma_f32_16x16x32_bf16 v[140:143], v[104:107], v[96:99], v[140:143]
    s_cselect_b32 s48, 0, s48
    v_mfma_f32_16x16x32_bf16 v[224:227], v[104:107], v[100:103], v[224:227]
    v_add_u32 v18, s48, v16
    v_mfma_f32_16x16x32_bf16 v[144:147], v[108:111], v[84:87], v[144:147]
    v_add_u32 v19, s48, v17
    v_mfma_f32_16x16x32_bf16 v[148:151], v[108:111], v[88:91], v[148:151]
    v_add_u32 v22, s48, v20
    v_mfma_f32_16x16x32_bf16 v[152:155], v[108:111], v[92:95], v[152:155]
    v_add_u32 v23, s48, v21
    v_mfma_f32_16x16x32_bf16 v[244:247], v[104:107], v[240:243], v[244:247]
    ds_read_b128 v[40:43], v18 offset:0
    v_mfma_f32_16x16x32_bf16 v[156:159], v[108:111], v[96:99], v[156:159]
    ds_read_b128 v[44:47], v18 offset:2048
    v_mfma_f32_16x16x32_bf16 v[160:163], v[112:115], v[84:87], v[160:163]
    ds_read_b128 v[48:51], v18 offset:4096
    v_mfma_f32_16x16x32_bf16 v[164:167], v[112:115], v[88:91], v[164:167]
    ds_read_b128 v[52:55], v18 offset:6144
    v_mfma_f32_16x16x32_bf16 v[168:171], v[112:115], v[92:95], v[168:171]
    ds_read_b128 v[56:59], v22
    ds_read_b64_tr_b16 v[60:61], v8 offset:28672
    v_mfma_f32_16x16x32_bf16 v[172:175], v[112:115], v[96:99], v[172:175]
    ds_read_b64_tr_b16 v[62:63], v8 offset:35840
    v_mfma_f32_16x16x32_bf16 v[176:179], v[116:119], v[84:87], v[176:179]
    ds_read_b64_tr_b16 v[64:65], v9 offset:28672
    v_mfma_f32_16x16x32_bf16 v[180:183], v[116:119], v[88:91], v[180:183]
    ds_read_b64_tr_b16 v[66:67], v9 offset:35840
    v_mfma_f32_16x16x32_bf16 v[184:187], v[116:119], v[92:95], v[184:187]
    ds_read_b64_tr_b16 v[68:69], v10 offset:28672
    v_mfma_f32_16x16x32_bf16 v[248:251], v[120:123], v[240:243], v[248:251]
    ds_read_b64_tr_b16 v[70:71], v10 offset:35840
    v_mfma_f32_16x16x32_bf16 v[188:191], v[116:119], v[96:99], v[188:191]
    ds_read_b64_tr_b16 v[72:73], v11 offset:28672
    v_mfma_f32_16x16x32_bf16 v[192:195], v[120:123], v[84:87], v[192:195]
    ds_read_b64_tr_b16 v[74:75], v11 offset:35840
    v_mfma_f32_16x16x32_bf16 v[196:199], v[120:123], v[88:91], v[196:199]
    ds_read_b64_tr_b16 v[76:77], v12 offset:28672
    v_mfma_f32_16x16x32_bf16 v[200:203], v[120:123], v[92:95], v[200:203]
    ds_read_b64_tr_b16 v[78:79], v12 offset:35840
    v_mfma_f32_16x16x32_bf16 v[204:207], v[120:123], v[96:99], v[204:207]
    ds_read_b64_tr_b16 v[80:81], v13 offset:28672
    v_mfma_f32_16x16x32_bf16 v[208:211], v[124:127], v[84:87], v[208:211]
    ds_read_b64_tr_b16 v[82:83], v13 offset:35840
    v_mfma_f32_16x16x32_bf16 v[212:215], v[124:127], v[88:91], v[212:215]
    v_mfma_f32_16x16x32_bf16 v[216:219], v[124:127], v[92:95], v[216:219]
    v_mfma_f32_16x16x32_bf16 v[220:223], v[124:127], v[96:99], v[220:223]
    s_waitcnt vmcnt(0) lgkmcnt(0)
    s_barrier
    v_mfma_f32_16x16x32_bf16 v[128:131], v[60:63], v[40:43], v[128:131]
    ds_read_b128 v[84:87], v19 offset:0
    v_mfma_f32_16x16x32_bf16 v[132:135], v[60:63], v[44:47], v[132:135]
    ds_read_b128 v[88:91], v19 offset:2048
    v_mfma_f32_16x16x32_bf16 v[136:139], v[60:63], v[48:51], v[136:139]
    ds_read_b128 v[92:95], v19 offset:4096
    v_mfma_f32_16x16x32_bf16 v[140:143], v[60:63], v[52:55], v[140:143]
    v_mfma_f32_16x16x32_bf16 v[224:227], v[60:63], v[56:59], v[224:227]
    ds_read_b128 v[96:99], v19 offset:6144
    v_mfma_f32_16x16x32_bf16 v[144:147], v[64:67], v[40:43], v[144:147]
    ds_read_b128 v[100:103], v23
    v_mfma_f32_16x16x32_bf16 v[148:151], v[64:67], v[44:47], v[148:151]
    v_mfma_f32_16x16x32_bf16 v[152:155], v[64:67], v[48:51], v[152:155]
    ds_read_b64_tr_b16 v[104:105], v8 offset:43008
    v_mfma_f32_16x16x32_bf16 v[244:247], v[60:63], v[240:243], v[244:247]
    ds_read_b64_tr_b16 v[106:107], v8 offset:50176
    v_mfma_f32_16x16x32_bf16 v[156:159], v[64:67], v[52:55], v[156:159]
    ds_read_b64_tr_b16 v[108:109], v9 offset:43008
    v_mfma_f32_16x16x32_bf16 v[160:163], v[68:71], v[40:43], v[160:163]
    v_mfma_f32_16x16x32_bf16 v[164:167], v[68:71], v[44:47], v[164:167]
    ds_read_b64_tr_b16 v[110:111], v9 offset:50176
    v_mfma_f32_16x16x32_bf16 v[168:171], v[68:71], v[48:51], v[168:171]
    ds_read_b64_tr_b16 v[112:113], v10 offset:43008
    v_mfma_f32_16x16x32_bf16 v[172:175], v[68:71], v[52:55], v[172:175]
    v_mfma_f32_16x16x32_bf16 v[176:179], v[72:75], v[40:43], v[176:179]
    ds_read_b64_tr_b16 v[114:115], v10 offset:50176
    v_mfma_f32_16x16x32_bf16 v[180:183], v[72:75], v[44:47], v[180:183]
    ds_read_b64_tr_b16 v[116:117], v11 offset:43008
    v_mfma_f32_16x16x32_bf16 v[184:187], v[72:75], v[48:51], v[184:187]
    ds_read_b64_tr_b16 v[118:119], v11 offset:50176
    v_mfma_f32_16x16x32_bf16 v[248:251], v[76:79], v[240:243], v[248:251]
    v_mfma_f32_16x16x32_bf16 v[188:191], v[72:75], v[52:55], v[188:191]
    ds_read_b64_tr_b16 v[120:121], v12 offset:43008
    v_mfma_f32_16x16x32_bf16 v[192:195], v[76:79], v[40:43], v[192:195]
    ds_read_b64_tr_b16 v[122:123], v12 offset:50176
    v_mfma_f32_16x16x32_bf16 v[196:199], v[76:79], v[44:47], v[196:199]
    v_mfma_f32_16x16x32_bf16 v[200:203], v[76:79], v[48:51], v[200:203]
    ds_read_b64_tr_b16 v[124:125], v13 offset:43008
    v_mfma_f32_16x16x32_bf16 v[204:207], v[76:79], v[52:55], v[204:207]
    ds_read_b64_tr_b16 v[126:127], v13 offset:50176
    v_mfma_f32_16x16x32_bf16 v[208:211], v[80:83], v[40:43], v[208:211]
    v_mfma_f32_16x16x32_bf16 v[212:215], v[80:83], v[44:47], v[212:215]
    v_mfma_f32_16x16x32_bf16 v[216:219], v[80:83], v[48:51], v[216:219]
    v_mfma_f32_16x16x32_bf16 v[220:223], v[80:83], v[52:55], v[220:223]
    s_waitcnt lgkmcnt(0)
    s_barrier
    v_mfma_f32_16x16x32_bf16 v[128:131], v[104:107], v[84:87], v[128:131]
    s_lshl_b32 s60, s23, 2
    s_add_u32 s60, s60, s21
    s_lshl_b32 s60, s60, 9
    s_add_u32 s60, s60, 0x3800000
    v_lshlrev_b32 v253, 3, v3
    v_mfma_f32_16x16x32_bf16 v[132:135], v[104:107], v[88:91], v[132:135]
    v_mfma_f32_16x16x32_bf16 v[136:139], v[104:107], v[92:95], v[136:139]
    v_mfma_f32_16x16x32_bf16 v[140:143], v[104:107], v[96:99], v[140:143]
    v_mfma_f32_16x16x32_bf16 v[224:227], v[104:107], v[100:103], v[224:227]
    buffer_load_dwordx2 v[40:41], v253, s[28:31], s60 offen offset:0 sc1
    v_mfma_f32_16x16x32_bf16 v[144:147], v[108:111], v[84:87], v[144:147]
    v_mfma_f32_16x16x32_bf16 v[148:151], v[108:111], v[88:91], v[148:151]
    v_mfma_f32_16x16x32_bf16 v[152:155], v[108:111], v[92:95], v[152:155]
    v_mfma_f32_16x16x32_bf16 v[244:247], v[104:107], v[240:243], v[244:247]
    buffer_load_dwordx2 v[42:43], v253, s[28:31], s60 offen offset:128 sc1
    v_mfma_f32_16x16x32_bf16 v[156:159], v[108:111], v[96:99], v[156:159]
    v_mfma_f32_16x16x32_bf16 v[160:163], v[112:115], v[84:87], v[160:163]
    v_mfma_f32_16x16x32_bf16 v[164:167], v[112:115], v[88:91], v[164:167]
    v_mfma_f32_16x16x32_bf16 v[168:171], v[112:115], v[92:95], v[168:171]
    buffer_load_dwordx2 v[44:45], v253, s[28:31], s60 offen offset:256 sc1
    v_mfma_f32_16x16x32_bf16 v[172:175], v[112:115], v[96:99], v[172:175]
    v_mfma_f32_16x16x32_bf16 v[176:179], v[116:119], v[84:87], v[176:179]
    v_mfma_f32_16x16x32_bf16 v[180:183], v[116:119], v[88:91], v[180:183]
    v_mfma_f32_16x16x32_bf16 v[184:187], v[116:119], v[92:95], v[184:187]
    buffer_load_dwordx2 v[46:47], v253, s[28:31], s60 offen offset:384 sc1
    v_mfma_f32_16x16x32_bf16 v[248:251], v[120:123], v[240:243], v[248:251]
    v_mfma_f32_16x16x32_bf16 v[188:191], v[116:119], v[96:99], v[188:191]
    v_mfma_f32_16x16x32_bf16 v[192:195], v[120:123], v[84:87], v[192:195]
    v_mfma_f32_16x16x32_bf16 v[196:199], v[120:123], v[88:91], v[196:199]
    s_lshl_b32 s61, s77, 3
    s_add_u32 s61, s61, 0x3800000
    buffer_load_dwordx2 v[48:49], v253, s[28:31], s61 offen sc1
    v_mfma_f32_16x16x32_bf16 v[200:203], v[120:123], v[92:95], v[200:203]
    v_mfma_f32_16x16x32_bf16 v[204:207], v[120:123], v[96:99], v[204:207]
    v_mfma_f32_16x16x32_bf16 v[208:211], v[124:127], v[84:87], v[208:211]
    v_mfma_f32_16x16x32_bf16 v[212:215], v[124:127], v[88:91], v[212:215]
    v_mfma_f32_16x16x32_bf16 v[216:219], v[124:127], v[92:95], v[216:219]
    v_mfma_f32_16x16x32_bf16 v[220:223], v[124:127], v[96:99], v[220:223]
    s_mov_b32 s62, 0x27800
    v_lshl_add_u32 v34, v4, 4, s62
    s_mov_b32 exec_lo, 0x10001
    s_mov_b32 exec_hi, 0x10001
    s_lshl_b32 s60, s64, 6
    v_add_u32 v35, s60, v34
    ds_write_b128 v35, v[244:247]
    s_lshl_b32 s60, s68, 6
    v_add_u32 v36, s60, v34
    ds_write_b128 v36, v[248:251]
    s_mov_b64 exec, -1
    s_waitcnt lgkmcnt(0)
    s_barrier
    s_lshl_b32 s60, s64, 6
    v_add_u32 v35, s60, v34
    ds_read_b128 v[84:87], v35
    s_lshl_b32 s60, s65, 6
    v_add_u32 v35, s60, v34
    ds_read_b128 v[88:91], v35
    s_lshl_b32 s60, s66, 6
    v_add_u32 v35, s60, v34
    ds_read_b128 v[92:95], v35
    s_lshl_b32 s60, s67, 6
    v_add_u32 v35, s60, v34
    ds_read_b128 v[96:99], v35
    s_lshl_b32 s60, s68, 6
    v_add_u32 v35, s60, v34
    ds_read_b128 v[100:103], v35
    s_lshl_b32 s60, s69, 6
    v_add_u32 v35, s60, v34
    ds_read_b128 v[104:107], v35
    s_waitcnt vmcnt(0) lgkmcnt(0)
    v_lshrrev_b32 v31, 2, v3
    v_and_b32 v31, 2, v31
    v_lshrrev_b32 v32, 1, v3
    v_and_b32 v32, 2, v32
    v_lshrrev_b32 v34, 1, v4
    v_xor_b32 v31, v31, v34
    v_xor_b32 v32, v32, v34
    v_and_b32 v34, 1, v4
    v_lshlrev_b32 v34, 3, v34
    v_lshl_add_u32 v33, v3, 6, v34
    s_mov_b32 s62, 0x18000
    s_lshl_b32 s63, s21, 12
    s_add_u32 s63, s63, 1024
    s_lshr_b32 s60, s64, 1
    s_cmp_eq_u32 s60, 2
    s_cselect_b64 vcc, -1, 0
    s_mul_i32 s60, s60, 17408
    s_add_u32 s60, s60, s62
    s_and_b32 s61, s64, 1
    s_lshl_b32 s61, s61, 1
    v_cndmask_b32 v34, v31, v32, vcc
    v_xor_b32 v34, s61, v34
    v_lshl_add_u32 v34, v34, 4, v33
    v_add_u32 v35, s60, v34
    v_add_u32 v36, s63, v35
    v_pk_fma_f32 v[128:129], v[40:41], v[84:85], v[128:129] op_sel_hi:[0,1,1]
    v_pk_fma_f32 v[130:131], v[40:41], v[86:87], v[130:131] op_sel_hi:[0,1,1]
    v_pk_mul_f32 v[128:129], v[40:41], v[128:129] op_sel:[1,0] op_sel_hi:[1,1]
    v_pk_mul_f32 v[130:131], v[40:41], v[130:131] op_sel:[1,0] op_sel_hi:[1,1]
    v_cvt_pk_bf16_f32 v52, v128, v129
    v_cvt_pk_bf16_f32 v53, v130, v131
    ds_write_b64 v36, v[52:53] offset:0
    v_pk_fma_f32 v[132:133], v[42:43], v[84:85], v[132:133] op_sel_hi:[0,1,1]
    v_pk_fma_f32 v[134:135], v[42:43], v[86:87], v[134:135] op_sel_hi:[0,1,1]
    v_pk_mul_f32 v[132:133], v[42:43], v[132:133] op_sel:[1,0] op_sel_hi:[1,1]
    v_pk_mul_f32 v[134:135], v[42:43], v[134:135] op_sel:[1,0] op_sel_hi:[1,1]
    v_cvt_pk_bf16_f32 v54, v132, v133
    v_cvt_pk_bf16_f32 v55, v134, v135
    ds_write_b64 v36, v[54:55] offset:1024
    v_pk_fma_f32 v[136:137], v[44:45], v[84:85], v[136:137] op_sel_hi:[0,1,1]
    v_pk_fma_f32 v[138:139], v[44:45], v[86:87], v[138:139] op_sel_hi:[0,1,1]
    v_pk_mul_f32 v[136:137], v[44:45], v[136:137] op_sel:[1,0] op_sel_hi:[1,1]
    v_pk_mul_f32 v[138:139], v[44:45], v[138:139] op_sel:[1,0] op_sel_hi:[1,1]
    v_cvt_pk_bf16_f32 v56, v136, v137
    v_cvt_pk_bf16_f32 v57, v138, v139
    ds_write_b64 v36, v[56:57] offset:2048
    v_pk_fma_f32 v[140:141], v[46:47], v[84:85], v[140:141] op_sel_hi:[0,1,1]
    v_pk_fma_f32 v[142:143], v[46:47], v[86:87], v[142:143] op_sel_hi:[0,1,1]
    v_pk_mul_f32 v[140:141], v[46:47], v[140:141] op_sel:[1,0] op_sel_hi:[1,1]
    v_pk_mul_f32 v[142:143], v[46:47], v[142:143] op_sel:[1,0] op_sel_hi:[1,1]
    v_cvt_pk_bf16_f32 v58, v140, v141
    v_cvt_pk_bf16_f32 v59, v142, v143
    ds_write_b64 v36, v[58:59] offset:3072
    v_pk_fma_f32 v[224:225], v[48:49], v[84:85], v[224:225] op_sel_hi:[0,1,1]
    v_pk_fma_f32 v[226:227], v[48:49], v[86:87], v[226:227] op_sel_hi:[0,1,1]
    v_pk_mul_f32 v[224:225], v[48:49], v[224:225] op_sel:[1,0] op_sel_hi:[1,1]
    v_pk_mul_f32 v[226:227], v[48:49], v[226:227] op_sel:[1,0] op_sel_hi:[1,1]
    v_cvt_pk_bf16_f32 v50, v224, v225
    v_cvt_pk_bf16_f32 v51, v226, v227
    ds_write_b64 v35, v[50:51]
    s_lshr_b32 s60, s65, 1
    s_cmp_eq_u32 s60, 2
    s_cselect_b64 vcc, -1, 0
    s_mul_i32 s60, s60, 17408
    s_add_u32 s60, s60, s62
    s_and_b32 s61, s65, 1
    s_lshl_b32 s61, s61, 1
    v_cndmask_b32 v34, v31, v32, vcc
    v_xor_b32 v34, s61, v34
    v_lshl_add_u32 v34, v34, 4, v33
    v_add_u32 v35, s60, v34
    v_add_u32 v36, s63, v35
    v_pk_fma_f32 v[144:145], v[40:41], v[88:89], v[144:145] op_sel_hi:[0,1,1]
    v_pk_fma_f32 v[146:147], v[40:41], v[90:91], v[146:147] op_sel_hi:[0,1,1]
    v_pk_mul_f32 v[144:145], v[40:41], v[144:145] op_sel:[1,0] op_sel_hi:[1,1]
    v_pk_mul_f32 v[146:147], v[40:41], v[146:147] op_sel:[1,0] op_sel_hi:[1,1]
    v_cvt_pk_bf16_f32 v60, v144, v145
    v_cvt_pk_bf16_f32 v61, v146, v147
    ds_write_b64 v36, v[60:61] offset:0
    v_pk_fma_f32 v[148:149], v[42:43], v[88:89], v[148:149] op_sel_hi:[0,1,1]
    v_pk_fma_f32 v[150:151], v[42:43], v[90:91], v[150:151] op_sel_hi:[0,1,1]
    v_pk_mul_f32 v[148:149], v[42:43], v[148:149] op_sel:[1,0] op_sel_hi:[1,1]
    v_pk_mul_f32 v[150:151], v[42:43], v[150:151] op_sel:[1,0] op_sel_hi:[1,1]
    v_cvt_pk_bf16_f32 v62, v148, v149
    v_cvt_pk_bf16_f32 v63, v150, v151
    ds_write_b64 v36, v[62:63] offset:1024
    v_pk_fma_f32 v[152:153], v[44:45], v[88:89], v[152:153] op_sel_hi:[0,1,1]
    v_pk_fma_f32 v[154:155], v[44:45], v[90:91], v[154:155] op_sel_hi:[0,1,1]
    v_pk_mul_f32 v[152:153], v[44:45], v[152:153] op_sel:[1,0] op_sel_hi:[1,1]
    v_pk_mul_f32 v[154:155], v[44:45], v[154:155] op_sel:[1,0] op_sel_hi:[1,1]
    v_cvt_pk_bf16_f32 v64, v152, v153
    v_cvt_pk_bf16_f32 v65, v154, v155
    ds_write_b64 v36, v[64:65] offset:2048
    v_pk_fma_f32 v[156:157], v[46:47], v[88:89], v[156:157] op_sel_hi:[0,1,1]
    v_pk_fma_f32 v[158:159], v[46:47], v[90:91], v[158:159] op_sel_hi:[0,1,1]
    v_pk_mul_f32 v[156:157], v[46:47], v[156:157] op_sel:[1,0] op_sel_hi:[1,1]
    v_pk_mul_f32 v[158:159], v[46:47], v[158:159] op_sel:[1,0] op_sel_hi:[1,1]
    v_cvt_pk_bf16_f32 v66, v156, v157
    v_cvt_pk_bf16_f32 v67, v158, v159
    ds_write_b64 v36, v[66:67] offset:3072
    s_lshr_b32 s60, s66, 1
    s_cmp_eq_u32 s60, 2
    s_cselect_b64 vcc, -1, 0
    s_mul_i32 s60, s60, 17408
    s_add_u32 s60, s60, s62
    s_and_b32 s61, s66, 1
    s_lshl_b32 s61, s61, 1
    v_cndmask_b32 v34, v31, v32, vcc
    v_xor_b32 v34, s61, v34
    v_lshl_add_u32 v34, v34, 4, v33
    v_add_u32 v35, s60, v34
    v_add_u32 v36, s63, v35
    v_pk_fma_f32 v[160:161], v[40:41], v[92:93], v[160:161] op_sel_hi:[0,1,1]
    v_pk_fma_f32 v[162:163], v[40:41], v[94:95], v[162:163] op_sel_hi:[0,1,1]
    v_pk_mul_f32 v[160:161], v[40:41], v[160:161] op_sel:[1,0] op_sel_hi:[1,1]
    v_pk_mul_f32 v[162:163], v[40:41], v[162:163] op_sel:[1,0] op_sel_hi:[1,1]
    v_cvt_pk_bf16_f32 v68, v160, v161
    v_cvt_pk_bf16_f32 v69, v162, v163
    ds_write_b64 v36, v[68:69] offset:0
    v_pk_fma_f32 v[164:165], v[42:43], v[92:93], v[164:165] op_sel_hi:[0,1,1]
    v_pk_fma_f32 v[166:167], v[42:43], v[94:95], v[166:167] op_sel_hi:[0,1,1]
    v_pk_mul_f32 v[164:165], v[42:43], v[164:165] op_sel:[1,0] op_sel_hi:[1,1]
    v_pk_mul_f32 v[166:167], v[42:43], v[166:167] op_sel:[1,0] op_sel_hi:[1,1]
    v_cvt_pk_bf16_f32 v70, v164, v165
    v_cvt_pk_bf16_f32 v71, v166, v167
    ds_write_b64 v36, v[70:71] offset:1024
    v_pk_fma_f32 v[168:169], v[44:45], v[92:93], v[168:169] op_sel_hi:[0,1,1]
    v_pk_fma_f32 v[170:171], v[44:45], v[94:95], v[170:171] op_sel_hi:[0,1,1]
    v_pk_mul_f32 v[168:169], v[44:45], v[168:169] op_sel:[1,0] op_sel_hi:[1,1]
    v_pk_mul_f32 v[170:171], v[44:45], v[170:171] op_sel:[1,0] op_sel_hi:[1,1]
    v_cvt_pk_bf16_f32 v72, v168, v169
    v_cvt_pk_bf16_f32 v73, v170, v171
    ds_write_b64 v36, v[72:73] offset:2048
    v_pk_fma_f32 v[172:173], v[46:47], v[92:93], v[172:173] op_sel_hi:[0,1,1]
    v_pk_fma_f32 v[174:175], v[46:47], v[94:95], v[174:175] op_sel_hi:[0,1,1]
    v_pk_mul_f32 v[172:173], v[46:47], v[172:173] op_sel:[1,0] op_sel_hi:[1,1]
    v_pk_mul_f32 v[174:175], v[46:47], v[174:175] op_sel:[1,0] op_sel_hi:[1,1]
    v_cvt_pk_bf16_f32 v74, v172, v173
    v_cvt_pk_bf16_f32 v75, v174, v175
    ds_write_b64 v36, v[74:75] offset:3072
    s_lshr_b32 s60, s67, 1
    s_cmp_eq_u32 s60, 2
    s_cselect_b64 vcc, -1, 0
    s_mul_i32 s60, s60, 17408
    s_add_u32 s60, s60, s62
    s_and_b32 s61, s67, 1
    s_lshl_b32 s61, s61, 1
    v_cndmask_b32 v34, v31, v32, vcc
    v_xor_b32 v34, s61, v34
    v_lshl_add_u32 v34, v34, 4, v33
    v_add_u32 v35, s60, v34
    v_add_u32 v36, s63, v35
    v_pk_fma_f32 v[176:177], v[40:41], v[96:97], v[176:177] op_sel_hi:[0,1,1]
    v_pk_fma_f32 v[178:179], v[40:41], v[98:99], v[178:179] op_sel_hi:[0,1,1]
    v_pk_mul_f32 v[176:177], v[40:41], v[176:177] op_sel:[1,0] op_sel_hi:[1,1]
    v_pk_mul_f32 v[178:179], v[40:41], v[178:179] op_sel:[1,0] op_sel_hi:[1,1]
    v_cvt_pk_bf16_f32 v76, v176, v177
    v_cvt_pk_bf16_f32 v77, v178, v179
    ds_write_b64 v36, v[76:77] offset:0
    v_pk_fma_f32 v[180:181], v[42:43], v[96:97], v[180:181] op_sel_hi:[0,1,1]
    v_pk_fma_f32 v[182:183], v[42:43], v[98:99], v[182:183] op_sel_hi:[0,1,1]
    v_pk_mul_f32 v[180:181], v[42:43], v[180:181] op_sel:[1,0] op_sel_hi:[1,1]
    v_pk_mul_f32 v[182:183], v[42:43], v[182:183] op_sel:[1,0] op_sel_hi:[1,1]
    v_cvt_pk_bf16_f32 v78, v180, v181
    v_cvt_pk_bf16_f32 v79, v182, v183
    ds_write_b64 v36, v[78:79] offset:1024
    v_pk_fma_f32 v[184:185], v[44:45], v[96:97], v[184:185] op_sel_hi:[0,1,1]
    v_pk_fma_f32 v[186:187], v[44:45], v[98:99], v[186:187] op_sel_hi:[0,1,1]
    v_pk_mul_f32 v[184:185], v[44:45], v[184:185] op_sel:[1,0] op_sel_hi:[1,1]
    v_pk_mul_f32 v[186:187], v[44:45], v[186:187] op_sel:[1,0] op_sel_hi:[1,1]
    v_cvt_pk_bf16_f32 v80, v184, v185
    v_cvt_pk_bf16_f32 v81, v186, v187
    ds_write_b64 v36, v[80:81] offset:2048
    v_pk_fma_f32 v[188:189], v[46:47], v[96:97], v[188:189] op_sel_hi:[0,1,1]
    v_pk_fma_f32 v[190:191], v[46:47], v[98:99], v[190:191] op_sel_hi:[0,1,1]
    v_pk_mul_f32 v[188:189], v[46:47], v[188:189] op_sel:[1,0] op_sel_hi:[1,1]
    v_pk_mul_f32 v[190:191], v[46:47], v[190:191] op_sel:[1,0] op_sel_hi:[1,1]
    v_cvt_pk_bf16_f32 v82, v188, v189
    v_cvt_pk_bf16_f32 v83, v190, v191
    ds_write_b64 v36, v[82:83] offset:3072
    s_lshr_b32 s60, s68, 1
    s_cmp_eq_u32 s60, 2
    s_cselect_b64 vcc, -1, 0
    s_mul_i32 s60, s60, 17408
    s_add_u32 s60, s60, s62
    s_and_b32 s61, s68, 1
    s_lshl_b32 s61, s61, 1
    v_cndmask_b32 v34, v31, v32, vcc
    v_xor_b32 v34, s61, v34
    v_lshl_add_u32 v34, v34, 4, v33
    v_add_u32 v35, s60, v34
    v_add_u32 v36, s63, v35
    v_pk_fma_f32 v[192:193], v[40:41], v[100:101], v[192:193] op_sel_hi:[0,1,1]
    v_pk_fma_f32 v[194:195], v[40:41], v[102:103], v[194:195] op_sel_hi:[0,1,1]
    v_pk_mul_f32 v[192:193], v[40:41], v[192:193] op_sel:[1,0] op_sel_hi:[1,1]
    v_pk_mul_f32 v[194:195], v[40:41], v[194:195] op_sel:[1,0] op_sel_hi:[1,1]
    v_cvt_pk_bf16_f32 v52, v192, v193
    v_cvt_pk_bf16_f32 v53, v194, v195
    ds_write_b64 v36, v[52:53] offset:0
    v_pk_fma_f32 v[196:197], v[42:43], v[100:101], v[196:197] op_sel_hi:[0,1,1]
    v_pk_fma_f32 v[198:199], v[42:43], v[102:103], v[198:199] op_sel_hi:[0,1,1]
    v_pk_mul_f32 v[196:197], v[42:43], v[196:197] op_sel:[1,0] op_sel_hi:[1,1]
    v_pk_mul_f32 v[198:199], v[42:43], v[198:199] op_sel:[1,0] op_sel_hi:[1,1]
    v_cvt_pk_bf16_f32 v54, v196, v197
    v_cvt_pk_bf16_f32 v55, v198, v199
    ds_write_b64 v36, v[54:55] offset:1024
    v_pk_fma_f32 v[200:201], v[44:45], v[100:101], v[200:201] op_sel_hi:[0,1,1]
    v_pk_fma_f32 v[202:203], v[44:45], v[102:103], v[202:203] op_sel_hi:[0,1,1]
    v_pk_mul_f32 v[200:201], v[44:45], v[200:201] op_sel:[1,0] op_sel_hi:[1,1]
    v_pk_mul_f32 v[202:203], v[44:45], v[202:203] op_sel:[1,0] op_sel_hi:[1,1]
    v_cvt_pk_bf16_f32 v56, v200, v201
    v_cvt_pk_bf16_f32 v57, v202, v203
    ds_write_b64 v36, v[56:57] offset:2048
    v_pk_fma_f32 v[204:205], v[46:47], v[100:101], v[204:205] op_sel_hi:[0,1,1]
    v_pk_fma_f32 v[206:207], v[46:47], v[102:103], v[206:207] op_sel_hi:[0,1,1]
    v_pk_mul_f32 v[204:205], v[46:47], v[204:205] op_sel:[1,0] op_sel_hi:[1,1]
    v_pk_mul_f32 v[206:207], v[46:47], v[206:207] op_sel:[1,0] op_sel_hi:[1,1]
    v_cvt_pk_bf16_f32 v58, v204, v205
    v_cvt_pk_bf16_f32 v59, v206, v207
    ds_write_b64 v36, v[58:59] offset:3072
    s_lshr_b32 s60, s69, 1
    s_cmp_eq_u32 s60, 2
    s_cselect_b64 vcc, -1, 0
    s_mul_i32 s60, s60, 17408
    s_add_u32 s60, s60, s62
    s_and_b32 s61, s69, 1
    s_lshl_b32 s61, s61, 1
    v_cndmask_b32 v34, v31, v32, vcc
    v_xor_b32 v34, s61, v34
    v_lshl_add_u32 v34, v34, 4, v33
    v_add_u32 v35, s60, v34
    v_add_u32 v36, s63, v35
    v_pk_fma_f32 v[208:209], v[40:41], v[104:105], v[208:209] op_sel_hi:[0,1,1]
    v_pk_fma_f32 v[210:211], v[40:41], v[106:107], v[210:211] op_sel_hi:[0,1,1]
    v_pk_mul_f32 v[208:209], v[40:41], v[208:209] op_sel:[1,0] op_sel_hi:[1,1]
    v_pk_mul_f32 v[210:211], v[40:41], v[210:211] op_sel:[1,0] op_sel_hi:[1,1]
    v_cvt_pk_bf16_f32 v60, v208, v209
    v_cvt_pk_bf16_f32 v61, v210, v211
    ds_write_b64 v36, v[60:61] offset:0
    v_pk_fma_f32 v[212:213], v[42:43], v[104:105], v[212:213] op_sel_hi:[0,1,1]
    v_pk_fma_f32 v[214:215], v[42:43], v[106:107], v[214:215] op_sel_hi:[0,1,1]
    v_pk_mul_f32 v[212:213], v[42:43], v[212:213] op_sel:[1,0] op_sel_hi:[1,1]
    v_pk_mul_f32 v[214:215], v[42:43], v[214:215] op_sel:[1,0] op_sel_hi:[1,1]
    v_cvt_pk_bf16_f32 v62, v212, v213
    v_cvt_pk_bf16_f32 v63, v214, v215
    ds_write_b64 v36, v[62:63] offset:1024
    v_pk_fma_f32 v[216:217], v[44:45], v[104:105], v[216:217] op_sel_hi:[0,1,1]
    v_pk_fma_f32 v[218:219], v[44:45], v[106:107], v[218:219] op_sel_hi:[0,1,1]
    v_pk_mul_f32 v[216:217], v[44:45], v[216:217] op_sel:[1,0] op_sel_hi:[1,1]
    v_pk_mul_f32 v[218:219], v[44:45], v[218:219] op_sel:[1,0] op_sel_hi:[1,1]
    v_cvt_pk_bf16_f32 v64, v216, v217
    v_cvt_pk_bf16_f32 v65, v218, v219
    ds_write_b64 v36, v[64:65] offset:2048
    v_pk_fma_f32 v[220:221], v[46:47], v[104:105], v[220:221] op_sel_hi:[0,1,1]
    v_pk_fma_f32 v[222:223], v[46:47], v[106:107], v[222:223] op_sel_hi:[0,1,1]
    v_pk_mul_f32 v[220:221], v[46:47], v[220:221] op_sel:[1,0] op_sel_hi:[1,1]
    v_pk_mul_f32 v[222:223], v[46:47], v[222:223] op_sel:[1,0] op_sel_hi:[1,1]
    v_cvt_pk_bf16_f32 v66, v220, v221
    v_cvt_pk_bf16_f32 v67, v222, v223
    ds_write_b64 v36, v[66:67] offset:3072
    v_mov_b32 v6, 0x27c04
    v_mov_b32 v7, 1
    s_waitcnt lgkmcnt(0)
    s_mov_b64 exec, 1
    ds_add_u32 v6, v7
    s_mov_b64 exec, -1
    v_lshrrev_b32 v34, 2, v3
    v_and_b32 v34, 2, v34
    v_xor_b32 v34, v34, v4
    v_lshlrev_b32 v34, 4, v34
    v_lshl_add_u32 v34, v3, 6, v34
    s_lshl_b32 s60, s21, 12
    s_add_u32 s60, s60, s62
    v_add_u32 v31, s60, v34
    v_lshrrev_b32 v34, 2, v3
    v_lshl_add_u32 v34, v4, 2, v34
    v_lshrrev_b32 v35, 1, v34
    v_and_b32 v35, 2, v35
    v_lshlrev_b32 v35, 4, v35
    v_and_b32 v36, 3, v3
    v_lshlrev_b32 v36, 3, v36
    v_xor_b32 v36, v36, v35
    v_lshl_add_u32 v36, v34, 6, v36
    v_add_u32 v32, s60, v36
    v_xor_b32 v33, 32, v32
    s_mov_b32 s61, 0
L_q_stg:
    ds_read_b32 v7, v6
    s_waitcnt lgkmcnt(0)
    v_readfirstlane_b32 s60, v7
    s_add_u32 s61, s61, 1
    s_cmp_ge_u32 s60, 4
    s_cbranch_scc1 L_q_stgok
    s_cmp_lt_u32 s61, 0x200000
    s_cbranch_scc1 L_q_stg
L_q_stgok:
    ds_read_b128 v[40:43], v31 offset:1024
    ds_read_b128 v[44:47], v31 offset:2048
    ds_read_b128 v[48:51], v31 offset:3072
    ds_read_b128 v[52:55], v31 offset:4096
    ds_read_b128 v[56:59], v31 offset:17408
    ds_read_b128 v[60:63], v31 offset:18432
    ds_read_b128 v[64:67], v31 offset:19456
    ds_read_b128 v[68:71], v31 offset:20480
    ds_read_b128 v[72:75], v31 offset:21504
    ds_read_b64_tr_b16 v[76:77], v32 offset:34816
    ds_read_b64_tr_b16 v[86:87], v33 offset:34816
    ds_read_b64_tr_b16 v[78:79], v32 offset:35840
    ds_read_b64_tr_b16 v[88:89], v33 offset:35840
    ds_read_b64_tr_b16 v[80:81], v32 offset:36864
    ds_read_b64_tr_b16 v[90:91], v33 offset:36864
    ds_read_b64_tr_b16 v[82:83], v32 offset:37888
    ds_read_b64_tr_b16 v[92:93], v33 offset:37888
    ds_read_b64_tr_b16 v[84:85], v32 offset:38912
    ds_read_b64_tr_b16 v[94:95], v33 offset:38912
    v_and_b32 v34, 1, v3
    v_lshlrev_b32 v106, 4, v34
    v_cmp_eq_u32 s[76:77], 1, v34
    v_sub_u32 v35, v3, v34
    v_lshlrev_b32 v36, 2, v4
    v_sub_u32 v35, v35, v36
    v_mov_b32 v37, 0xff800000
    v_add_u32 v36, 16, v35
    v_cmp_ge_u32 vcc, 14, v36
    s_nop 1
    v_cndmask_b32_e64 v100, v37, 0, vcc
    v_add_u32 v36, 14, v35
    v_cmp_ge_u32 vcc, 14, v36
    s_nop 1
    v_cndmask_b32_e64 v101, v37, 0, vcc
    v_add_u32 v36, 0, v35
    v_cmp_ge_u32 vcc, 14, v36
    s_nop 1
    v_cndmask_b32_e64 v102, v37, 0, vcc
    v_add_u32 v36, -2, v35
    v_cmp_ge_u32 vcc, 14, v36
    s_nop 1
    v_cndmask_b32_e64 v103, v37, 0, vcc
    s_or_b32 s60, s23, s21
    s_cmp_eq_u32 s60, 0
    s_cselect_b64 vcc, -1, 0
    v_cndmask_b32 v104, v100, v37, vcc
    v_cndmask_b32 v105, v101, v37, vcc
    s_mov_b32 s78, 0x3e3504f3
    s_mov_b32 s79, 0x3fb8aa3b
    s_waitcnt lgkmcnt(0)
    s_mov_b32 s36, s12
    s_mov_b32 s37, s13
    s_mov_b32 s38, 0x700000
    s_mov_b32 s39, 0x20000
    s_lshl_b32 s60, s74, 8
    s_mul_i32 s49, s72, 0x1c0000
    s_add_u32 s49, s49, s60
    s_lshl_b32 s55, s72, 19
    s_add_u32 s55, s55, s60
    v_lshrrev_b32 v24, 3, v2
    v_and_b32 v25, 7, v2
    v_lshrrev_b32 v26, 2, v24
    v_and_b32 v27, 3, v24
    v_lshl_add_u32 v26, v26, 3, v27
    s_and_b32 s60, s20, 1
    s_lshl_b32 s60, s60, 4
    s_and_b32 s61, s20, 2
    s_lshl_b32 s61, s61, 1
    s_add_u32 s60, s60, s61
    v_add_u32 v26, s60, v26
    v_and_b32 v27, 6, v24
    v_xor_b32 v27, v27, v25
    v_lshlrev_b32 v27, 4, v27
    v_lshl_add_u32 v26, v26, 11, v27
    s_lshr_b32 s60, s20, 2
    s_lshl_b32 s60, s60, 7
    v_add_u32 v22, s60, v26
    s_lshl_b32 s50, s20, 10
    s_add_u32 s51, s50, 0x4000
    s_mov_b32 s52, 0
    s_lshl_b32 s58, s23, 2
    s_add_u32 s58, s58, s72
    s_lshl_b32 s58, s58, 8
    s_add_u32 s58, s58, 0x3810000
    s_lshl_b32 s63, s74, 2
    s_add_u32 s83, s63, s58
    s_mul_i32 s61, s23, 2359296
    s_lshl_b32 s60, s72, 13
    s_add_u32 s54, s61, s60
    s_add_u32 s61, s61, 0x8000
    s_mul_i32 s60, s72, 28672
    s_add_u32 s48, s61, s60
    s_mov_b32 s59, 0xff
    v_lshrrev_b32 v25, 5, v2
    v_mul_u32_u24 v25, 0x24000, v25
    v_and_b32 v26, 31, v2
    v_lshl_add_u32 v25, v26, 4, v25
    s_mul_i32 s60, s20, 294912
    v_add_u32 v20, s60, v25
    v_add_u32 v21, 0x200, v20
    v_and_b32 v6, 7, v2
    v_lshlrev_b32 v6, 2, v6
    v_mfma_f32_16x16x32_bf16 v[128:131], v[56:59], v[40:43], 0
    v_mfma_f32_16x16x32_bf16 v[132:135], v[60:63], v[40:43], 0
    v_mfma_f32_16x16x32_bf16 v[136:139], v[60:63], v[44:47], 0
    v_mfma_f32_16x16x32_bf16 v[140:143], v[64:67], v[44:47], 0
    v_mfma_f32_16x16x32_bf16 v[144:147], v[64:67], v[48:51], 0
    v_mfma_f32_16x16x32_bf16 v[148:151], v[68:71], v[48:51], 0
    v_mfma_f32_16x16x32_bf16 v[152:155], v[68:71], v[52:55], 0
    v_mfma_f32_16x16x32_bf16 v[156:159], v[72:75], v[52:55], 0
    s_nop 7
    s_nop 3
    v_cndmask_b32_e64 v160, v128, v129, s[76:77]
    v_cndmask_b32_e64 v164, v136, v137, s[76:77]
    v_cndmask_b32_e64 v168, v144, v145, s[76:77]
    v_cndmask_b32_e64 v172, v152, v153, s[76:77]
    v_cndmask_b32_e64 v161, v130, v131, s[76:77]
    v_cndmask_b32_e64 v165, v138, v139, s[76:77]
    v_cndmask_b32_e64 v169, v146, v147, s[76:77]
    v_cndmask_b32_e64 v173, v154, v155, s[76:77]
    v_cndmask_b32_e64 v162, v132, v133, s[76:77]
    v_cndmask_b32_e64 v166, v140, v141, s[76:77]
    v_cndmask_b32_e64 v170, v148, v149, s[76:77]
    v_cndmask_b32_e64 v174, v156, v157, s[76:77]
    v_cndmask_b32_e64 v163, v134, v135, s[76:77]
    v_cndmask_b32_e64 v167, v142, v143, s[76:77]
    v_cndmask_b32_e64 v171, v150, v151, s[76:77]
    v_cndmask_b32_e64 v175, v158, v159, s[76:77]
    v_cvt_pk_bf16_f32 v160, v160, v161
    v_cvt_pk_bf16_f32 v164, v164, v165
    v_cvt_pk_bf16_f32 v168, v168, v169
    v_cvt_pk_bf16_f32 v172, v172, v173
    s_add_u32 m0, s51, 0x0
    s_nop 0
    buffer_load_dwordx4 v22, s[36:39], s49 offen lds
    s_add_u32 s49, s49, 0x10000
    s_add_u32 s52, s52, 1
    s_cmp_eq_u32 s52, 28
    s_cselect_b32 s36, s8, s36
    s_cselect_b32 s37, s9, s37
    s_cselect_b32 s38, 0x200000, s38
    s_cselect_b32 s49, s55, s49
    v_cvt_pk_bf16_f32 v162, v162, v163
    v_cvt_pk_bf16_f32 v166, v166, v167
    v_cvt_pk_bf16_f32 v170, v170, v171
    v_cvt_pk_bf16_f32 v174, v174, v175
    v_and_b32 v161, s84, v160
    v_and_b32 v165, s84, v164
    v_and_b32 v169, s84, v168
    v_and_b32 v173, s84, v172
    v_lshlrev_b32 v160, 16, v160
    v_lshlrev_b32 v164, 16, v164
    v_lshlrev_b32 v168, 16, v168
    v_lshlrev_b32 v172, 16, v172
    v_and_b32 v163, s84, v162
    v_and_b32 v167, s84, v166
    v_and_b32 v171, s84, v170
    v_and_b32 v175, s84, v174
    v_lshlrev_b32 v162, 16, v162
    v_lshlrev_b32 v166, 16, v166
    v_lshlrev_b32 v170, 16, v170
    v_lshlrev_b32 v174, 16, v174
    s_add_u32 m0, s51, 0x6000
    s_nop 0
    buffer_load_dwordx4 v22, s[36:39], s49 offen lds
    s_add_u32 s49, s49, 0x10000
    s_add_u32 s52, s52, 1
    s_cmp_eq_u32 s52, 28
    s_cselect_b32 s36, s8, s36
    s_cselect_b32 s37, s9, s37
    s_cselect_b32 s38, 0x200000, s38
    s_cselect_b32 s49, s55, s49
    v_mul_f32 v160, s78, v160
    v_mul_f32 v164, s78, v164
    v_mul_f32 v168, s78, v168
    v_mul_f32 v172, s78, v172
    v_mul_f32 v161, s78, v161
    v_mul_f32 v165, s78, v165
    v_mul_f32 v169, s78, v169
    v_mul_f32 v173, s78, v173
    v_mul_f32 v162, s78, v162
    v_mul_f32 v166, s78, v166
    v_mul_f32 v170, s78, v170
    v_mul_f32 v174, s78, v174
    v_mul_f32 v163, s78, v163
    v_mul_f32 v167, s78, v167
    v_mul_f32 v171, s78, v171
    v_mul_f32 v175, s78, v175
    v_cvt_pk_bf16_f32 v160, v160, v161
    v_cvt_pk_bf16_f32 v164, v164, v165
    v_cvt_pk_bf16_f32 v168, v168, v169
    v_cvt_pk_bf16_f32 v172, v172, v173
    s_add_u32 m0, s51, 0xc000
    s_nop 0
    buffer_load_dwordx4 v22, s[36:39], s49 offen lds
    s_add_u32 s49, s49, 0x10000
    s_add_u32 s52, s52, 1
    s_cmp_eq_u32 s52, 28
    s_cselect_b32 s36, s8, s36
    s_cselect_b32 s37, s9, s37
    s_cselect_b32 s38, 0x200000, s38
    s_cselect_b32 s49, s55, s49
    v_cvt_pk_bf16_f32 v162, v162, v163
    v_cvt_pk_bf16_f32 v166, v166, v167
    v_cvt_pk_bf16_f32 v170, v170, v171
    v_cvt_pk_bf16_f32 v174, v174, v175
    v_and_b32 v161, s84, v160
    v_and_b32 v165, s84, v164
    v_and_b32 v169, s84, v168
    v_and_b32 v173, s84, v172
    v_lshlrev_b32 v160, 16, v160
    v_lshlrev_b32 v164, 16, v164
    v_lshlrev_b32 v168, 16, v168
    v_lshlrev_b32 v172, 16, v172
    v_and_b32 v163, s84, v162
    v_and_b32 v167, s84, v166
    v_and_b32 v171, s84, v170
    v_and_b32 v175, s84, v174
    v_lshlrev_b32 v162, 16, v162
    v_lshlrev_b32 v166, 16, v166
    v_lshlrev_b32 v170, 16, v170
    v_lshlrev_b32 v174, 16, v174
    s_add_u32 m0, s51, 0x12000
    s_nop 0
    buffer_load_dwordx4 v22, s[36:39], s49 offen lds
    s_add_u32 s49, s49, 0x10000
    s_add_u32 s52, s52, 1
    s_cmp_eq_u32 s52, 28
    s_cselect_b32 s36, s8, s36
    s_cselect_b32 s37, s9, s37
    s_cselect_b32 s38, 0x200000, s38
    s_cselect_b32 s49, s55, s49
    v_add_f32 v160, v160, v104
    v_add_f32 v164, v164, v100
    v_add_f32 v168, v168, v100
    v_add_f32 v172, v172, v100
    v_add_f32 v161, v161, v105
    v_add_f32 v165, v165, v101
    v_add_f32 v169, v169, v101
    v_add_f32 v173, v173, v101
    v_add_f32 v162, v162, v102
    v_add_f32 v166, v166, v102
    v_add_f32 v170, v170, v102
    v_add_f32 v174, v174, v102
    v_add_f32 v163, v163, v103
    v_add_f32 v167, v167, v103
    v_add_f32 v171, v171, v103
    v_add_f32 v175, v175, v103
    v_max3_f32 v176, v160, v161, v162
    v_max3_f32 v177, v164, v165, v166
    v_max3_f32 v178, v168, v169, v170
    v_max3_f32 v179, v172, v173, v174
    v_max_f32 v176, v176, v163
    v_max_f32 v177, v177, v167
    v_max_f32 v178, v178, v171
    v_max_f32 v179, v179, v175
    v_mov_b32 v180, v176
    v_mov_b32 v181, v177
    v_mov_b32 v182, v178
    v_mov_b32 v183, v179
    s_nop 1
    v_permlane16_swap_b32 v176, v180
    v_permlane16_swap_b32 v177, v181
    v_permlane16_swap_b32 v178, v182
    v_permlane16_swap_b32 v179, v183
    s_nop 1
    v_max_f32 v176, v176, v180
    v_max_f32 v177, v177, v181
    v_max_f32 v178, v178, v182
    v_max_f32 v179, v179, v183
    v_mov_b32 v180, v176
    v_mov_b32 v181, v177
    v_mov_b32 v182, v178
    v_mov_b32 v183, v179
    s_nop 1
    v_permlane32_swap_b32 v176, v180
    v_permlane32_swap_b32 v177, v181
    v_permlane32_swap_b32 v178, v182
    v_permlane32_swap_b32 v179, v183
    s_nop 1
    v_max_f32 v176, v176, v180
    v_max_f32 v177, v177, v181
    v_max_f32 v178, v178, v182
    v_max_f32 v179, v179, v183
    v_mul_f32 v176, s79, v176
    v_mul_f32 v177, s79, v177
    v_mul_f32 v178, s79, v178
    v_mul_f32 v179, s79, v179
    v_fma_f32 v160, v160, s79, -v176
    v_fma_f32 v164, v164, s79, -v177
    v_fma_f32 v168, v168, s79, -v178
    v_fma_f32 v172, v172, s79, -v179
    v_fma_f32 v161, v161, s79, -v176
    v_fma_f32 v165, v165, s79, -v177
    v_fma_f32 v169, v169, s79, -v178
    v_fma_f32 v173, v173, s79, -v179
    v_fma_f32 v162, v162, s79, -v176
    v_fma_f32 v166, v166, s79, -v177
    v_fma_f32 v170, v170, s79, -v178
    v_fma_f32 v174, v174, s79, -v179
    v_fma_f32 v163, v163, s79, -v176
    v_fma_f32 v167, v167, s79, -v177
    v_fma_f32 v171, v171, s79, -v178
    v_fma_f32 v175, v175, s79, -v179
    v_exp_f32 v160, v160
    v_exp_f32 v164, v164
    v_exp_f32 v168, v168
    v_exp_f32 v172, v172
    v_exp_f32 v161, v161
    v_exp_f32 v165, v165
    v_exp_f32 v169, v169
    v_exp_f32 v173, v173
    v_exp_f32 v162, v162
    v_exp_f32 v166, v166
    v_exp_f32 v170, v170
    v_exp_f32 v174, v174
    v_exp_f32 v163, v163
    v_exp_f32 v167, v167
    v_exp_f32 v171, v171
    v_exp_f32 v175, v175
    s_nop 0
    v_add_f32 v176, v160, v161
    v_add_f32 v177, v164, v165
    v_add_f32 v178, v168, v169
    v_add_f32 v179, v172, v173
    v_add_f32 v180, v162, v163
    v_add_f32 v181, v166, v167
    v_add_f32 v182, v170, v171
    v_add_f32 v183, v174, v175
    v_add_f32 v176, v176, v180
    v_add_f32 v177, v177, v181
    v_add_f32 v178, v178, v182
    v_add_f32 v179, v179, v183
    v_mov_b32 v180, v176
    v_mov_b32 v181, v177
    v_mov_b32 v182, v178
    v_mov_b32 v183, v179
    s_nop 1
    v_permlane16_swap_b32 v176, v180
    v_permlane16_swap_b32 v177, v181
    v_permlane16_swap_b32 v178, v182
    v_permlane16_swap_b32 v179, v183
    s_nop 1
    v_add_f32 v176, v176, v180
    v_add_f32 v177, v177, v181
    v_add_f32 v178, v178, v182
    v_add_f32 v179, v179, v183
    v_mov_b32 v180, v176
    v_mov_b32 v181, v177
    v_mov_b32 v182, v178
    v_mov_b32 v183, v179
    s_nop 1
    v_permlane32_swap_b32 v176, v180
    v_permlane32_swap_b32 v177, v181
    v_permlane32_swap_b32 v178, v182
    v_permlane32_swap_b32 v179, v183
    s_nop 1
    v_add_f32 v176, v176, v180
    v_add_f32 v177, v177, v181
    v_add_f32 v178, v178, v182
    v_add_f32 v179, v179, v183
    v_rcp_f32 v176, v176
    v_rcp_f32 v177, v177
    v_rcp_f32 v178, v178
    v_rcp_f32 v179, v179
    s_nop 0
    v_mul_f32 v160, v160, v176
    v_mul_f32 v164, v164, v177
    v_mul_f32 v168, v168, v178
    v_mul_f32 v172, v172, v179
    v_mul_f32 v161, v161, v176
    v_mul_f32 v165, v165, v177
    v_mul_f32 v169, v169, v178
    v_mul_f32 v173, v173, v179
    v_mul_f32 v162, v162, v176
    v_mul_f32 v166, v166, v177
    v_mul_f32 v170, v170, v178
    v_mul_f32 v174, v174, v179
    v_mul_f32 v163, v163, v176
    v_mul_f32 v167, v167, v177
    v_mul_f32 v171, v171, v178
    v_mul_f32 v175, v175, v179
    v_cvt_pk_bf16_f32 v184, v160, 0
    v_cvt_pk_bf16_f32 v188, v164, 0
    v_cvt_pk_bf16_f32 v192, v168, 0
    v_cvt_pk_bf16_f32 v196, v172, 0
    v_cvt_pk_bf16_f32 v185, v161, 0
    v_cvt_pk_bf16_f32 v189, v165, 0
    v_cvt_pk_bf16_f32 v193, v169, 0
    v_cvt_pk_bf16_f32 v197, v173, 0
    v_cvt_pk_bf16_f32 v186, v162, 0
    v_cvt_pk_bf16_f32 v190, v166, 0
    v_cvt_pk_bf16_f32 v194, v170, 0
    v_cvt_pk_bf16_f32 v198, v174, 0
    v_cvt_pk_bf16_f32 v187, v163, 0
    v_cvt_pk_bf16_f32 v191, v167, 0
    v_cvt_pk_bf16_f32 v195, v171, 0
    v_cvt_pk_bf16_f32 v199, v175, 0
    v_lshlrev_b32 v184, v106, v184
    v_lshlrev_b32 v188, v106, v188
    v_lshlrev_b32 v192, v106, v192
    v_lshlrev_b32 v196, v106, v196
    v_lshlrev_b32 v185, v106, v185
    v_lshlrev_b32 v189, v106, v189
    v_lshlrev_b32 v193, v106, v193
    v_lshlrev_b32 v197, v106, v197
    v_lshlrev_b32 v186, v106, v186
    v_lshlrev_b32 v190, v106, v190
    v_lshlrev_b32 v194, v106, v194
    v_lshlrev_b32 v198, v106, v198
    v_lshlrev_b32 v187, v106, v187
    v_lshlrev_b32 v191, v106, v191
    v_lshlrev_b32 v195, v106, v195
    v_lshlrev_b32 v199, v106, v199
    s_nop 1
    v_mfma_f32_16x16x32_bf16 v[200:203], v[76:79], v[184:187], 0
    v_mfma_f32_16x16x32_bf16 v[204:207], v[86:89], v[184:187], 0
    v_mfma_f32_16x16x32_bf16 v[208:211], v[78:81], v[188:191], 0
    v_mfma_f32_16x16x32_bf16 v[212:215], v[88:91], v[188:191], 0
    v_mfma_f32_16x16x32_bf16 v[216:219], v[80:83], v[192:195], 0
    v_mfma_f32_16x16x32_bf16 v[220:223], v[90:93], v[192:195], 0
    v_mfma_f32_16x16x32_bf16 v[224:227], v[82:85], v[196:199], 0
    v_mfma_f32_16x16x32_bf16 v[228:231], v[92:95], v[196:199], 0
    s_add_u32 s48, s48, 3072
    s_mov_b32 s82, 3
    v_and_b32 v33, 1, v4
    v_lshrrev_b32 v34, 1, v4
    v_lshlrev_b32 v35, 9, v33
    v_lshl_add_u32 v35, v34, 4, v35
    v_lshl_add_u32 v31, v3, 5, v35
    s_lshl_b32 s60, s23, 2
    s_add_u32 s60, s60, s21
    s_mul_i32 s60, s60, 589824
    s_lshl_b32 s61, s24, 10
    s_add_u32 s60, s60, s61
    s_nop 7
    v_cvt_pk_bf16_f32 v40, v200, v201
    v_cvt_pk_bf16_f32 v41, v202, v203
    v_cvt_pk_bf16_f32 v42, v204, v205
    v_cvt_pk_bf16_f32 v43, v206, v207
    s_nop 1
    v_permlane16_swap_b32 v40, v42
    v_permlane16_swap_b32 v41, v43
    s_nop 0
    buffer_store_dwordx4 v[40:43], v31, s[28:31], s60 offen sc1
    s_add_u32 s60, s60, 0x24000
    v_cvt_pk_bf16_f32 v44, v208, v209
    v_cvt_pk_bf16_f32 v45, v210, v211
    v_cvt_pk_bf16_f32 v46, v212, v213
    v_cvt_pk_bf16_f32 v47, v214, v215
    s_nop 1
    v_permlane16_swap_b32 v44, v46
    v_permlane16_swap_b32 v45, v47
    s_nop 0
    buffer_store_dwordx4 v[44:47], v31, s[28:31], s60 offen sc1
    s_add_u32 s60, s60, 0x24000
    v_cvt_pk_bf16_f32 v48, v216, v217
    v_cvt_pk_bf16_f32 v49, v218, v219
    v_cvt_pk_bf16_f32 v50, v220, v221
    v_cvt_pk_bf16_f32 v51, v222, v223
    s_nop 1
    v_permlane16_swap_b32 v48, v50
    v_permlane16_swap_b32 v49, v51
    s_nop 0
    buffer_store_dwordx4 v[48:51], v31, s[28:31], s60 offen sc1
    s_add_u32 s60, s60, 0x24000
    v_cvt_pk_bf16_f32 v52, v224, v225
    v_cvt_pk_bf16_f32 v53, v226, v227
    v_cvt_pk_bf16_f32 v54, v228, v229
    v_cvt_pk_bf16_f32 v55, v230, v231
    s_nop 1
    v_permlane16_swap_b32 v52, v54
    v_permlane16_swap_b32 v53, v55
    s_nop 0
    buffer_store_dwordx4 v[52:55], v31, s[28:31], s60 offen sc1
    v_lshrrev_b32 v23, 1, v4
    v_and_b32 v24, 1, v4
    v_lshlrev_b32 v24, 4, v24
    v_lshl_add_u32 v23, v23, 13, v24
    v_lshl_add_u32 v23, v3, 5, v23
    s_lshl_b32 s60, s85, 11
    s_lshl_b32 s61, s72, 9
    s_add_u32 s60, s60, s61
    v_add_u32 v8, s60, v23
    v_xor_b32 v9, 0x200, v8
    v_xor_b32 v10, 0x400, v8
    v_xor_b32 v11, 0x600, v8
    v_add_u32 v12, 0x12000, v8
    v_add_u32 v13, 0x12000, v9
    v_add_u32 v14, 0x12000, v10
    v_add_u32 v15, 0x12000, v11
    v_lshrrev_b32 v23, 2, v3
    v_lshl_add_u32 v23, v4, 2, v23
    v_and_b32 v24, 6, v23
    v_and_b32 v25, 3, v3
    v_lshlrev_b32 v25, 3, v25
    v_lshl_add_u32 v25, v23, 7, v25
    s_lshl_b32 s60, s86, 12
    s_add_u32 s60, s60, 0x4000
    v_add_u32 v25, s60, v25
    v_xor_b32 v26, 0, v24
    v_lshl_add_u32 v16, v26, 4, v25
    v_add_u32 v28, 0x12000, v16
    v_xor_b32 v26, 2, v24
    v_lshl_add_u32 v17, v26, 4, v25
    v_add_u32 v29, 0x12000, v17
    v_xor_b32 v26, 4, v24
    v_lshl_add_u32 v18, v26, 4, v25
    v_add_u32 v30, 0x12000, v18
    v_xor_b32 v26, 6, v24
    v_lshl_add_u32 v19, v26, 4, v25
    v_add_u32 v31, 0x12000, v19
L_phase2:
    s_waitcnt vmcnt(4)
    s_barrier
    ds_read_b128 v[32:35], v8 offset:0
    ds_read_b128 v[36:39], v9 offset:0
    ds_read_b128 v[40:43], v10 offset:0
    ds_read_b128 v[44:47], v11 offset:0
    ds_read_b64_tr_b16 v[48:49], v16 offset:0
    ds_read_b64_tr_b16 v[50:51], v16 offset:2048
    ds_read_b64_tr_b16 v[52:53], v17 offset:0
    ds_read_b64_tr_b16 v[54:55], v17 offset:2048
    ds_read_b64_tr_b16 v[56:57], v18 offset:0
    ds_read_b64_tr_b16 v[58:59], v18 offset:2048
    ds_read_b64_tr_b16 v[60:61], v19 offset:0
    ds_read_b64_tr_b16 v[62:63], v19 offset:2048
    s_waitcnt vmcnt(2) lgkmcnt(0)
    s_barrier
    v_mfma_f32_16x16x32_bf16 v[96:99], v[48:51], v[32:35], 0
    s_add_u32 m0, s50, 0x12000
    ds_read_b128 v[64:67], v8 offset:24576
    buffer_load_dwordx4 v20, s[28:31], s48 offen lds
    ds_read_b128 v[68:71], v9 offset:24576
    v_mfma_f32_16x16x32_bf16 v[112:115], v[48:51], v[36:39], 0
    s_add_u32 m0, s50, 0x14000
    ds_read_b128 v[72:75], v10 offset:24576
    buffer_load_dwordx4 v21, s[28:31], s48 offen lds
    v_mfma_f32_16x16x32_bf16 v[128:131], v[48:51], v[40:43], 0
    s_add_u32 s48, s48, 1024
    s_add_u32 s82, s82, 1
    s_cmp_eq_u32 s82, 28
    v_mfma_f32_16x16x32_bf16 v[144:147], v[48:51], v[44:47], 0
    s_cselect_b32 s48, s54, s48
    ds_read_b128 v[76:79], v11 offset:24576
    s_add_u32 m0, s50, 0x18000
    ds_read_b64_tr_b16 v[80:81], v16 offset:24576
    v_mfma_f32_16x16x32_bf16 v[100:103], v[52:55], v[32:35], 0
    buffer_load_dwordx4 v20, s[28:31], s48 offen lds
    ds_read_b64_tr_b16 v[82:83], v16 offset:26624
    s_add_u32 m0, s50, 0x1a000
    v_mfma_f32_16x16x32_bf16 v[116:119], v[52:55], v[36:39], 0
    ds_read_b64_tr_b16 v[84:85], v17 offset:24576
    buffer_load_dwordx4 v21, s[28:31], s48 offen lds
    s_add_u32 s48, s48, 1024
    v_mfma_f32_16x16x32_bf16 v[132:135], v[52:55], v[40:43], 0
    s_add_u32 s82, s82, 1
    s_cmp_eq_u32 s82, 28
    s_cselect_b32 s48, s54, s48
    v_mfma_f32_16x16x32_bf16 v[148:151], v[52:55], v[44:47], 0
    ds_read_b64_tr_b16 v[86:87], v17 offset:26624
    s_add_u32 m0, s51, 0x18000
    ds_read_b64_tr_b16 v[88:89], v18 offset:24576
    buffer_load_dwordx4 v22, s[36:39], s49 offen lds
    v_mfma_f32_16x16x32_bf16 v[104:107], v[56:59], v[32:35], 0
    s_add_u32 s49, s49, 0x10000
    s_add_u32 s52, s52, 1
    s_cmp_eq_u32 s52, 28
    v_mfma_f32_16x16x32_bf16 v[120:123], v[56:59], v[36:39], 0
    s_cselect_b32 s36, s8, s36
    s_cselect_b32 s37, s9, s37
    s_cselect_b32 s38, 0x200000, s38
    v_mfma_f32_16x16x32_bf16 v[136:139], v[56:59], v[40:43], 0
    s_cselect_b32 s49, s55, s49
    ds_read_b64_tr_b16 v[90:91], v18 offset:26624
    s_add_u32 m0, s51, 0x1e000
    ds_read_b64_tr_b16 v[92:93], v19 offset:24576
    v_mfma_f32_16x16x32_bf16 v[152:155], v[56:59], v[44:47], 0
    buffer_load_dwordx4 v22, s[36:39], s49 offen lds
    s_add_u32 s49, s49, 0x10000
    s_add_u32 s52, s52, 1
    v_mfma_f32_16x16x32_bf16 v[108:111], v[60:63], v[32:35], 0
    s_cmp_eq_u32 s52, 28
    s_cselect_b32 s36, s8, s36
    s_cselect_b32 s37, s9, s37
    v_mfma_f32_16x16x32_bf16 v[124:127], v[60:63], v[36:39], 0
    s_cselect_b32 s38, 0x200000, s38
    s_cselect_b32 s49, s55, s49
    ds_read_b64_tr_b16 v[94:95], v19 offset:26624
    v_mfma_f32_16x16x32_bf16 v[140:143], v[60:63], v[40:43], 0
    v_mfma_f32_16x16x32_bf16 v[156:159], v[60:63], v[44:47], 0
    s_waitcnt vmcnt(6) lgkmcnt(0)
    s_barrier
    v_mfma_f32_16x16x32_bf16 v[96:99], v[80:83], v[64:67], v[96:99]
    s_add_u32 m0, s50, 0x1e000
    ds_read_b128 v[32:35], v8 offset:49152
    buffer_load_dwordx4 v20, s[28:31], s48 offen lds
    ds_read_b128 v[36:39], v9 offset:49152
    v_mfma_f32_16x16x32_bf16 v[112:115], v[80:83], v[68:71], v[112:115]
    s_add_u32 m0, s50, 0x20000
    ds_read_b128 v[40:43], v10 offset:49152
    buffer_load_dwordx4 v21, s[28:31], s48 offen lds
    v_mfma_f32_16x16x32_bf16 v[128:131], v[80:83], v[72:75], v[128:131]
    s_add_u32 s48, s48, 1024
    s_add_u32 s82, s82, 1
    s_cmp_eq_u32 s82, 28
    v_mfma_f32_16x16x32_bf16 v[144:147], v[80:83], v[76:79], v[144:147]
    s_cselect_b32 s48, s54, s48
    ds_read_b128 v[44:47], v11 offset:49152
    s_add_u32 m0, s50, 0x0
    ds_read_b64_tr_b16 v[48:49], v16 offset:49152
    v_mfma_f32_16x16x32_bf16 v[100:103], v[84:87], v[64:67], v[100:103]
    buffer_load_dwordx4 v20, s[28:31], s48 offen lds
    ds_read_b64_tr_b16 v[50:51], v16 offset:51200
    s_add_u32 m0, s50, 0x2000
    v_mfma_f32_16x16x32_bf16 v[116:119], v[84:87], v[68:71], v[116:119]
    ds_read_b64_tr_b16 v[52:53], v17 offset:49152
    buffer_load_dwordx4 v21, s[28:31], s48 offen lds
    s_add_u32 s48, s48, 1024
    v_mfma_f32_16x16x32_bf16 v[132:135], v[84:87], v[72:75], v[132:135]
    s_add_u32 s82, s82, 1
    s_cmp_eq_u32 s82, 28
    s_cselect_b32 s48, s54, s48
    v_mfma_f32_16x16x32_bf16 v[148:151], v[84:87], v[76:79], v[148:151]
    ds_read_b64_tr_b16 v[54:55], v17 offset:51200
    s_add_u32 m0, s51, 0x0
    ds_read_b64_tr_b16 v[56:57], v18 offset:49152
    buffer_load_dwordx4 v22, s[36:39], s49 offen lds
    v_mfma_f32_16x16x32_bf16 v[104:107], v[88:91], v[64:67], v[104:107]
    s_add_u32 s49, s49, 0x10000
    s_add_u32 s52, s52, 1
    s_cmp_eq_u32 s52, 28
    v_mfma_f32_16x16x32_bf16 v[120:123], v[88:91], v[68:71], v[120:123]
    s_cselect_b32 s36, s8, s36
    s_cselect_b32 s37, s9, s37
    s_cselect_b32 s38, 0x200000, s38
    v_mfma_f32_16x16x32_bf16 v[136:139], v[88:91], v[72:75], v[136:139]
    s_cselect_b32 s49, s55, s49
    ds_read_b64_tr_b16 v[58:59], v18 offset:51200
    s_add_u32 m0, s51, 0x6000
    ds_read_b64_tr_b16 v[60:61], v19 offset:49152
    v_mfma_f32_16x16x32_bf16 v[152:155], v[88:91], v[76:79], v[152:155]
    buffer_load_dwordx4 v22, s[36:39], s49 offen lds
    s_add_u32 s49, s49, 0x10000
    s_add_u32 s52, s52, 1
    v_mfma_f32_16x16x32_bf16 v[108:111], v[92:95], v[64:67], v[108:111]
    s_cmp_eq_u32 s52, 28
    s_cselect_b32 s36, s8, s36
    s_cselect_b32 s37, s9, s37
    v_mfma_f32_16x16x32_bf16 v[124:127], v[92:95], v[68:71], v[124:127]
    s_cselect_b32 s38, 0x200000, s38
    s_cselect_b32 s49, s55, s49
    ds_read_b64_tr_b16 v[62:63], v19 offset:51200
    v_mfma_f32_16x16x32_bf16 v[140:143], v[92:95], v[72:75], v[140:143]
    v_mfma_f32_16x16x32_bf16 v[156:159], v[92:95], v[76:79], v[156:159]
    s_waitcnt vmcnt(10) lgkmcnt(0)
    s_barrier
    v_mfma_f32_16x16x32_bf16 v[96:99], v[48:51], v[32:35], v[96:99]
    s_add_u32 m0, s50, 0x6000
    ds_read_b128 v[64:67], v12 offset:0
    buffer_load_dwordx4 v20, s[28:31], s48 offen lds
    v_mfma_f32_16x16x32_bf16 v[112:115], v[48:51], v[36:39], v[112:115]
    ds_read_b128 v[68:71], v13 offset:0
    s_add_u32 m0, s50, 0x8000
    ds_read_b128 v[72:75], v14 offset:0
    v_mfma_f32_16x16x32_bf16 v[128:131], v[48:51], v[40:43], v[128:131]
    buffer_load_dwordx4 v21, s[28:31], s48 offen lds
    s_add_u32 s48, s48, 1024
    v_mfma_f32_16x16x32_bf16 v[144:147], v[48:51], v[44:47], v[144:147]
    s_add_u32 s82, s82, 1
    s_cmp_eq_u32 s82, 28
    s_cselect_b32 s48, s54, s48
    v_mfma_f32_16x16x32_bf16 v[100:103], v[52:55], v[32:35], v[100:103]
    ds_read_b128 v[76:79], v15 offset:0
    s_add_u32 m0, s50, 0xc000
    ds_read_b64_tr_b16 v[80:81], v28 offset:0
    v_mfma_f32_16x16x32_bf16 v[116:119], v[52:55], v[36:39], v[116:119]
    buffer_load_dwordx4 v20, s[28:31], s48 offen lds
    ds_read_b64_tr_b16 v[82:83], v28 offset:2048
    v_mfma_f32_16x16x32_bf16 v[132:135], v[52:55], v[40:43], v[132:135]
    s_add_u32 m0, s50, 0xe000
    ds_read_b64_tr_b16 v[84:85], v29 offset:0
    buffer_load_dwordx4 v21, s[28:31], s48 offen lds
    v_mfma_f32_16x16x32_bf16 v[148:151], v[52:55], v[44:47], v[148:151]
    s_add_u32 s48, s48, 1024
    s_add_u32 s82, s82, 1
    s_cmp_eq_u32 s82, 28
    v_mfma_f32_16x16x32_bf16 v[104:107], v[56:59], v[32:35], v[104:107]
    s_cselect_b32 s48, s54, s48
    ds_read_b64_tr_b16 v[86:87], v29 offset:2048
    v_mfma_f32_16x16x32_bf16 v[120:123], v[56:59], v[36:39], v[120:123]
    s_add_u32 m0, s51, 0xc000
    ds_read_b64_tr_b16 v[88:89], v30 offset:0
    buffer_load_dwordx4 v22, s[36:39], s49 offen lds
    v_mfma_f32_16x16x32_bf16 v[136:139], v[56:59], v[40:43], v[136:139]
    s_add_u32 s49, s49, 0x10000
    s_add_u32 s52, s52, 1
    s_cmp_eq_u32 s52, 28
    v_mfma_f32_16x16x32_bf16 v[152:155], v[56:59], v[44:47], v[152:155]
    s_cselect_b32 s36, s8, s36
    s_cselect_b32 s37, s9, s37
    v_mfma_f32_16x16x32_bf16 v[108:111], v[60:63], v[32:35], v[108:111]
    s_cselect_b32 s38, 0x200000, s38
    s_cselect_b32 s49, s55, s49
    ds_read_b64_tr_b16 v[90:91], v30 offset:2048
    v_mfma_f32_16x16x32_bf16 v[124:127], v[60:63], v[36:39], v[124:127]
    ds_read_b64_tr_b16 v[92:93], v31 offset:0
    ds_read_b64_tr_b16 v[94:95], v31 offset:2048
    v_mfma_f32_16x16x32_bf16 v[140:143], v[60:63], v[40:43], v[140:143]
    v_mfma_f32_16x16x32_bf16 v[156:159], v[60:63], v[44:47], v[156:159]
    s_waitcnt vmcnt(12) lgkmcnt(0)
    s_barrier
    v_mfma_f32_16x16x32_bf16 v[96:99], v[80:83], v[64:67], v[96:99]
    s_add_u32 m0, s50, 0x12000
    ds_read_b128 v[32:35], v12 offset:24576
    buffer_load_dwordx4 v20, s[28:31], s48 offen lds
    v_mfma_f32_16x16x32_bf16 v[112:115], v[80:83], v[68:71], v[112:115]
    ds_read_b128 v[36:39], v13 offset:24576
    ds_read_b128 v[40:43], v14 offset:24576
    v_mfma_f32_16x16x32_bf16 v[128:131], v[80:83], v[72:75], v[128:131]
    s_add_u32 m0, s50, 0x14000
    ds_read_b128 v[44:47], v15 offset:24576
    v_mfma_f32_16x16x32_bf16 v[144:147], v[80:83], v[76:79], v[144:147]
    buffer_load_dwordx4 v21, s[28:31], s48 offen lds
    s_add_u32 s48, s48, 1024
    v_mfma_f32_16x16x32_bf16 v[100:103], v[84:87], v[64:67], v[100:103]
    s_add_u32 s82, s82, 1
    s_cmp_eq_u32 s82, 28
    v_mfma_f32_16x16x32_bf16 v[116:119], v[84:87], v[68:71], v[116:119]
    s_cselect_b32 s48, s54, s48
    ds_read_b64_tr_b16 v[48:49], v28 offset:24576
    v_mfma_f32_16x16x32_bf16 v[132:135], v[84:87], v[72:75], v[132:135]
    ds_read_b64_tr_b16 v[50:51], v28 offset:26624
    s_add_u32 m0, s51, 0x12000
    v_mfma_f32_16x16x32_bf16 v[148:151], v[84:87], v[76:79], v[148:151]
    ds_read_b64_tr_b16 v[52:53], v29 offset:24576
    buffer_load_dwordx4 v22, s[36:39], s49 offen lds
    v_mfma_f32_16x16x32_bf16 v[104:107], v[88:91], v[64:67], v[104:107]
    s_add_u32 s49, s49, 0x10000
    s_add_u32 s52, s52, 1
    v_mfma_f32_16x16x32_bf16 v[120:123], v[88:91], v[68:71], v[120:123]
    s_cmp_eq_u32 s52, 28
    s_cselect_b32 s36, s8, s36
    v_mfma_f32_16x16x32_bf16 v[136:139], v[88:91], v[72:75], v[136:139]
    s_cselect_b32 s37, s9, s37
    s_cselect_b32 s38, 0x200000, s38
    v_mfma_f32_16x16x32_bf16 v[152:155], v[88:91], v[76:79], v[152:155]
    s_cselect_b32 s49, s55, s49
    ds_read_b64_tr_b16 v[54:55], v29 offset:26624
    v_mfma_f32_16x16x32_bf16 v[108:111], v[92:95], v[64:67], v[108:111]
    ds_read_b64_tr_b16 v[56:57], v30 offset:24576
    ds_read_b64_tr_b16 v[58:59], v30 offset:26624
    v_mfma_f32_16x16x32_bf16 v[124:127], v[92:95], v[68:71], v[124:127]
    ds_read_b64_tr_b16 v[60:61], v31 offset:24576
    ds_read_b64_tr_b16 v[62:63], v31 offset:26624
    v_mfma_f32_16x16x32_bf16 v[140:143], v[92:95], v[72:75], v[140:143]
    v_mfma_f32_16x16x32_bf16 v[156:159], v[92:95], v[76:79], v[156:159]
    s_waitcnt vmcnt(12) lgkmcnt(0)
    s_barrier
    v_mfma_f32_16x16x32_bf16 v[96:99], v[48:51], v[32:35], v[96:99]
    s_add_u32 m0, s50, 0x18000
    ds_read_b128 v[64:67], v12 offset:49152
    buffer_load_dwordx4 v20, s[28:31], s48 offen lds
    v_mfma_f32_16x16x32_bf16 v[112:115], v[48:51], v[36:39], v[112:115]
    ds_read_b128 v[68:71], v13 offset:49152
    ds_read_b128 v[72:75], v14 offset:49152
    v_mfma_f32_16x16x32_bf16 v[128:131], v[48:51], v[40:43], v[128:131]
    s_add_u32 m0, s50, 0x1a000
    ds_read_b128 v[76:79], v15 offset:49152
    v_mfma_f32_16x16x32_bf16 v[144:147], v[48:51], v[44:47], v[144:147]
    buffer_load_dwordx4 v21, s[28:31], s48 offen lds
    s_add_u32 s48, s48, 1024
    v_mfma_f32_16x16x32_bf16 v[100:103], v[52:55], v[32:35], v[100:103]
    s_add_u32 s82, s82, 1
    s_cmp_eq_u32 s82, 28
    v_mfma_f32_16x16x32_bf16 v[116:119], v[52:55], v[36:39], v[116:119]
    s_cselect_b32 s48, s54, s48
    ds_read_b64_tr_b16 v[80:81], v28 offset:49152
    v_mfma_f32_16x16x32_bf16 v[132:135], v[52:55], v[40:43], v[132:135]
    ds_read_b64_tr_b16 v[82:83], v28 offset:51200
    s_add_u32 m0, s51, 0x18000
    v_mfma_f32_16x16x32_bf16 v[148:151], v[52:55], v[44:47], v[148:151]
    ds_read_b64_tr_b16 v[84:85], v29 offset:49152
    buffer_load_dwordx4 v22, s[36:39], s49 offen lds
    v_mfma_f32_16x16x32_bf16 v[104:107], v[56:59], v[32:35], v[104:107]
    s_add_u32 s49, s49, 0x10000
    s_add_u32 s52, s52, 1
    v_mfma_f32_16x16x32_bf16 v[120:123], v[56:59], v[36:39], v[120:123]
    s_cmp_eq_u32 s52, 28
    s_cselect_b32 s36, s8, s36
    v_mfma_f32_16x16x32_bf16 v[136:139], v[56:59], v[40:43], v[136:139]
    s_cselect_b32 s37, s9, s37
    s_cselect_b32 s38, 0x200000, s38
    v_mfma_f32_16x16x32_bf16 v[152:155], v[56:59], v[44:47], v[152:155]
    s_cselect_b32 s49, s55, s49
    ds_read_b64_tr_b16 v[86:87], v29 offset:51200
    v_mfma_f32_16x16x32_bf16 v[108:111], v[60:63], v[32:35], v[108:111]
    ds_read_b64_tr_b16 v[88:89], v30 offset:49152
    ds_read_b64_tr_b16 v[90:91], v30 offset:51200
    v_mfma_f32_16x16x32_bf16 v[124:127], v[60:63], v[36:39], v[124:127]
    ds_read_b64_tr_b16 v[92:93], v31 offset:49152
    ds_read_b64_tr_b16 v[94:95], v31 offset:51200
    v_mfma_f32_16x16x32_bf16 v[140:143], v[60:63], v[40:43], v[140:143]
    v_mfma_f32_16x16x32_bf16 v[156:159], v[60:63], v[44:47], v[156:159]
    s_waitcnt vmcnt(12) lgkmcnt(0)
    s_barrier
    v_mfma_f32_16x16x32_bf16 v[96:99], v[80:83], v[64:67], v[96:99]
    s_cmp_lg_u32 s20, 0
    s_cbranch_scc1 L_p2_npub
    v_mov_b32 v7, 1
    s_mov_b64 exec, 1
    buffer_store_dword v7, off, s[28:31], s83 offset:128 sc1
    s_mov_b64 exec, -1
L_p2_npub:
    s_add_u32 m0, s50, 0x1e000
    ds_read_b128 v[32:35], v8 offset:0
    v_mfma_f32_16x16x32_bf16 v[112:115], v[80:83], v[68:71], v[112:115]
    buffer_load_dwordx4 v20, s[28:31], s48 offen lds
    ds_read_b128 v[36:39], v9 offset:0
    v_mfma_f32_16x16x32_bf16 v[128:131], v[80:83], v[72:75], v[128:131]
    ds_read_b128 v[40:43], v10 offset:0
    s_add_u32 m0, s50, 0x20000
    v_mfma_f32_16x16x32_bf16 v[144:147], v[80:83], v[76:79], v[144:147]
    ds_read_b128 v[44:47], v11 offset:0
    buffer_load_dwordx4 v21, s[28:31], s48 offen lds
    v_mfma_f32_16x16x32_bf16 v[100:103], v[84:87], v[64:67], v[100:103]
    s_add_u32 s48, s48, 1024
    s_add_u32 s82, s82, 1
    v_mfma_f32_16x16x32_bf16 v[116:119], v[84:87], v[68:71], v[116:119]
    s_cmp_eq_u32 s82, 28
    s_cselect_b32 s48, s54, s48
    v_mfma_f32_16x16x32_bf16 v[132:135], v[84:87], v[72:75], v[132:135]
    ds_read_b64_tr_b16 v[48:49], v16 offset:0
    ds_read_b64_tr_b16 v[50:51], v16 offset:2048
    v_mfma_f32_16x16x32_bf16 v[148:151], v[84:87], v[76:79], v[148:151]
    s_add_u32 m0, s51, 0x1e000
    ds_read_b64_tr_b16 v[52:53], v17 offset:0
    buffer_load_dwordx4 v22, s[36:39], s49 offen lds
    v_mfma_f32_16x16x32_bf16 v[104:107], v[88:91], v[64:67], v[104:107]
    s_add_u32 s49, s49, 0x10000
    s_add_u32 s52, s52, 1
    v_mfma_f32_16x16x32_bf16 v[120:123], v[88:91], v[68:71], v[120:123]
    s_cmp_eq_u32 s52, 28
    s_cselect_b32 s36, s8, s36
    v_mfma_f32_16x16x32_bf16 v[136:139], v[88:91], v[72:75], v[136:139]
    s_cselect_b32 s37, s9, s37
    s_cselect_b32 s38, 0x200000, s38
    v_mfma_f32_16x16x32_bf16 v[152:155], v[88:91], v[76:79], v[152:155]
    s_cselect_b32 s49, s55, s49
    ds_read_b64_tr_b16 v[54:55], v17 offset:2048
    v_mfma_f32_16x16x32_bf16 v[108:111], v[92:95], v[64:67], v[108:111]
    ds_read_b64_tr_b16 v[56:57], v18 offset:0
    ds_read_b64_tr_b16 v[58:59], v18 offset:2048
    v_mfma_f32_16x16x32_bf16 v[124:127], v[92:95], v[68:71], v[124:127]
    ds_read_b64_tr_b16 v[60:61], v19 offset:0
    ds_read_b64_tr_b16 v[62:63], v19 offset:2048
    v_mfma_f32_16x16x32_bf16 v[140:143], v[92:95], v[72:75], v[140:143]
    v_mfma_f32_16x16x32_bf16 v[156:159], v[92:95], v[76:79], v[156:159]
    s_waitcnt vmcnt(12) lgkmcnt(0)
    s_mov_b32 s53, 0
.p2align 6
L_p2_loop:
    s_barrier
    v_mfma_f32_16x16x32_bf16 v[96:99], v[48:51], v[32:35], v[96:99]
    s_add_u32 m0, s50, 0x0
    ds_read_b128 v[64:67], v8 offset:24576
    buffer_load_dwordx4 v20, s[28:31], s48 offen lds
    v_mfma_f32_16x16x32_bf16 v[112:115], v[48:51], v[36:39], v[112:115]
    ds_read_b128 v[68:71], v9 offset:24576
    ds_read_b128 v[72:75], v10 offset:24576
    v_mfma_f32_16x16x32_bf16 v[128:131], v[48:51], v[40:43], v[128:131]
    s_add_u32 m0, s50, 0x2000
    ds_read_b128 v[76:79], v11 offset:24576
    v_mfma_f32_16x16x32_bf16 v[144:147], v[48:51], v[44:47], v[144:147]
    buffer_load_dwordx4 v21, s[28:31], s48 offen lds
    s_add_u32 s48, s48, 1024
    v_mfma_f32_16x16x32_bf16 v[100:103], v[52:55], v[32:35], v[100:103]
    s_add_u32 s82, s82, 1
    s_cmp_eq_u32 s82, 28
    v_mfma_f32_16x16x32_bf16 v[116:119], v[52:55], v[36:39], v[116:119]
    s_cselect_b32 s48, s54, s48
    ds_read_b64_tr_b16 v[80:81], v16 offset:24576
    v_mfma_f32_16x16x32_bf16 v[132:135], v[52:55], v[40:43], v[132:135]
    ds_read_b64_tr_b16 v[82:83], v16 offset:26624
    s_add_u32 m0, s51, 0x0
    v_mfma_f32_16x16x32_bf16 v[148:151], v[52:55], v[44:47], v[148:151]
    ds_read_b64_tr_b16 v[84:85], v17 offset:24576
    buffer_load_dwordx4 v22, s[36:39], s49 offen lds
    v_mfma_f32_16x16x32_bf16 v[104:107], v[56:59], v[32:35], v[104:107]
    s_add_u32 s49, s49, 0x10000
    s_add_u32 s52, s52, 1
    v_mfma_f32_16x16x32_bf16 v[120:123], v[56:59], v[36:39], v[120:123]
    s_cmp_eq_u32 s52, 28
    s_cselect_b32 s36, s8, s36
    v_mfma_f32_16x16x32_bf16 v[136:139], v[56:59], v[40:43], v[136:139]
    s_cselect_b32 s37, s9, s37
    s_cselect_b32 s38, 0x200000, s38
    v_mfma_f32_16x16x32_bf16 v[152:155], v[56:59], v[44:47], v[152:155]
    s_cselect_b32 s49, s55, s49
    ds_read_b64_tr_b16 v[86:87], v17 offset:26624
    v_mfma_f32_16x16x32_bf16 v[108:111], v[60:63], v[32:35], v[108:111]
    ds_read_b64_tr_b16 v[88:89], v18 offset:24576
    ds_read_b64_tr_b16 v[90:91], v18 offset:26624
    v_mfma_f32_16x16x32_bf16 v[124:127], v[60:63], v[36:39], v[124:127]
    ds_read_b64_tr_b16 v[92:93], v19 offset:24576
    ds_read_b64_tr_b16 v[94:95], v19 offset:26624
    v_mfma_f32_16x16x32_bf16 v[140:143], v[60:63], v[40:43], v[140:143]
    v_mfma_f32_16x16x32_bf16 v[156:159], v[60:63], v[44:47], v[156:159]
    s_waitcnt vmcnt(12) lgkmcnt(0)
    s_barrier
    v_mfma_f32_16x16x32_bf16 v[96:99], v[80:83], v[64:67], v[96:99]
    s_add_u32 m0, s50, 0x6000
    ds_read_b128 v[32:35], v8 offset:49152
    buffer_load_dwordx4 v20, s[28:31], s48 offen lds
    v_mfma_f32_16x16x32_bf16 v[112:115], v[80:83], v[68:71], v[112:115]
    ds_read_b128 v[36:39], v9 offset:49152
    ds_read_b128 v[40:43], v10 offset:49152
    v_mfma_f32_16x16x32_bf16 v[128:131], v[80:83], v[72:75], v[128:131]
    s_add_u32 m0, s50, 0x8000
    ds_read_b128 v[44:47], v11 offset:49152
    v_mfma_f32_16x16x32_bf16 v[144:147], v[80:83], v[76:79], v[144:147]
    buffer_load_dwordx4 v21, s[28:31], s48 offen lds
    s_add_u32 s48, s48, 1024
    v_mfma_f32_16x16x32_bf16 v[100:103], v[84:87], v[64:67], v[100:103]
    s_add_u32 s82, s82, 1
    s_cmp_eq_u32 s82, 28
    v_mfma_f32_16x16x32_bf16 v[116:119], v[84:87], v[68:71], v[116:119]
    s_cselect_b32 s48, s54, s48
    ds_read_b64_tr_b16 v[48:49], v16 offset:49152
    v_mfma_f32_16x16x32_bf16 v[132:135], v[84:87], v[72:75], v[132:135]
    ds_read_b64_tr_b16 v[50:51], v16 offset:51200
    s_add_u32 m0, s51, 0x6000
    v_mfma_f32_16x16x32_bf16 v[148:151], v[84:87], v[76:79], v[148:151]
    ds_read_b64_tr_b16 v[52:53], v17 offset:49152
    buffer_load_dwordx4 v22, s[36:39], s49 offen lds
    v_mfma_f32_16x16x32_bf16 v[104:107], v[88:91], v[64:67], v[104:107]
    s_add_u32 s49, s49, 0x10000
    s_add_u32 s52, s52, 1
    v_mfma_f32_16x16x32_bf16 v[120:123], v[88:91], v[68:71], v[120:123]
    s_cmp_eq_u32 s52, 28
    s_cselect_b32 s36, s8, s36
    v_mfma_f32_16x16x32_bf16 v[136:139], v[88:91], v[72:75], v[136:139]
    s_cselect_b32 s37, s9, s37
    s_cselect_b32 s38, 0x200000, s38
    v_mfma_f32_16x16x32_bf16 v[152:155], v[88:91], v[76:79], v[152:155]
    s_cselect_b32 s49, s55, s49
    ds_read_b64_tr_b16 v[54:55], v17 offset:51200
    v_mfma_f32_16x16x32_bf16 v[108:111], v[92:95], v[64:67], v[108:111]
    ds_read_b64_tr_b16 v[56:57], v18 offset:49152
    ds_read_b64_tr_b16 v[58:59], v18 offset:51200
    v_mfma_f32_16x16x32_bf16 v[124:127], v[92:95], v[68:71], v[124:127]
    ds_read_b64_tr_b16 v[60:61], v19 offset:49152
    ds_read_b64_tr_b16 v[62:63], v19 offset:51200
    v_mfma_f32_16x16x32_bf16 v[140:143], v[92:95], v[72:75], v[140:143]
    v_mfma_f32_16x16x32_bf16 v[156:159], v[92:95], v[76:79], v[156:159]
    s_waitcnt vmcnt(12) lgkmcnt(0)
    s_barrier
    v_mfma_f32_16x16x32_bf16 v[96:99], v[48:51], v[32:35], v[96:99]
    s_xor_b32 s62, s53, 2
    s_or_b32 s62, s62, s20
    s_cbranch_scc1 L_p2_nq
    buffer_load_dword v5, v6, s[28:31], s58 offen offset:128 sc1
L_p2_nq:
    s_add_u32 m0, s50, 0xc000
    ds_read_b128 v[64:67], v12 offset:0
    v_mfma_f32_16x16x32_bf16 v[112:115], v[48:51], v[36:39], v[112:115]
    buffer_load_dwordx4 v20, s[28:31], s48 offen lds
    ds_read_b128 v[68:71], v13 offset:0
    v_mfma_f32_16x16x32_bf16 v[128:131], v[48:51], v[40:43], v[128:131]
    ds_read_b128 v[72:75], v14 offset:0
    s_add_u32 m0, s50, 0xe000
    v_mfma_f32_16x16x32_bf16 v[144:147], v[48:51], v[44:47], v[144:147]
    ds_read_b128 v[76:79], v15 offset:0
    buffer_load_dwordx4 v21, s[28:31], s48 offen lds
    v_mfma_f32_16x16x32_bf16 v[100:103], v[52:55], v[32:35], v[100:103]
    s_add_u32 s48, s48, 1024
    s_add_u32 s82, s82, 1
    v_mfma_f32_16x16x32_bf16 v[116:119], v[52:55], v[36:39], v[116:119]
    s_cmp_eq_u32 s82, 28
    s_cselect_b32 s48, s54, s48
    v_mfma_f32_16x16x32_bf16 v[132:135], v[52:55], v[40:43], v[132:135]
    ds_read_b64_tr_b16 v[80:81], v28 offset:0
    ds_read_b64_tr_b16 v[82:83], v28 offset:2048
    v_mfma_f32_16x16x32_bf16 v[148:151], v[52:55], v[44:47], v[148:151]
    s_add_u32 m0, s51, 0xc000
    ds_read_b64_tr_b16 v[84:85], v29 offset:0
    buffer_load_dwordx4 v22, s[36:39], s49 offen lds
    v_mfma_f32_16x16x32_bf16 v[104:107], v[56:59], v[32:35], v[104:107]
    s_add_u32 s49, s49, 0x10000
    s_add_u32 s52, s52, 1
    v_mfma_f32_16x16x32_bf16 v[120:123], v[56:59], v[36:39], v[120:123]
    s_cmp_eq_u32 s52, 28
    s_cselect_b32 s36, s8, s36
    v_mfma_f32_16x16x32_bf16 v[136:139], v[56:59], v[40:43], v[136:139]
    s_cselect_b32 s37, s9, s37
    s_cselect_b32 s38, 0x200000, s38
    v_mfma_f32_16x16x32_bf16 v[152:155], v[56:59], v[44:47], v[152:155]
    s_cselect_b32 s49, s55, s49
    ds_read_b64_tr_b16 v[86:87], v29 offset:2048
    v_mfma_f32_16x16x32_bf16 v[108:111], v[60:63], v[32:35], v[108:111]
    ds_read_b64_tr_b16 v[88:89], v30 offset:0
    ds_read_b64_tr_b16 v[90:91], v30 offset:2048
    v_mfma_f32_16x16x32_bf16 v[124:127], v[60:63], v[36:39], v[124:127]
    ds_read_b64_tr_b16 v[92:93], v31 offset:0
    ds_read_b64_tr_b16 v[94:95], v31 offset:2048
    v_mfma_f32_16x16x32_bf16 v[140:143], v[60:63], v[40:43], v[140:143]
    v_mfma_f32_16x16x32_bf16 v[156:159], v[60:63], v[44:47], v[156:159]
    s_waitcnt vmcnt(12) lgkmcnt(0)
    s_barrier
    v_mfma_f32_16x16x32_bf16 v[96:99], v[80:83], v[64:67], v[96:99]
    s_add_u32 m0, s50, 0x12000
    ds_read_b128 v[32:35], v12 offset:24576
    buffer_load_dwordx4 v20, s[28:31], s48 offen lds
    v_mfma_f32_16x16x32_bf16 v[112:115], v[80:83], v[68:71], v[112:115]
    ds_read_b128 v[36:39], v13 offset:24576
    ds_read_b128 v[40:43], v14 offset:24576
    v_mfma_f32_16x16x32_bf16 v[128:131], v[80:83], v[72:75], v[128:131]
    s_add_u32 m0, s50, 0x14000
    ds_read_b128 v[44:47], v15 offset:24576
    v_mfma_f32_16x16x32_bf16 v[144:147], v[80:83], v[76:79], v[144:147]
    buffer_load_dwordx4 v21, s[28:31], s48 offen lds
    s_add_u32 s48, s48, 1024
    v_mfma_f32_16x16x32_bf16 v[100:103], v[84:87], v[64:67], v[100:103]
    s_add_u32 s82, s82, 1
    s_cmp_eq_u32 s82, 28
    v_mfma_f32_16x16x32_bf16 v[116:119], v[84:87], v[68:71], v[116:119]
    s_cselect_b32 s48, s54, s48
    ds_read_b64_tr_b16 v[48:49], v28 offset:24576
    v_mfma_f32_16x16x32_bf16 v[132:135], v[84:87], v[72:75], v[132:135]
    ds_read_b64_tr_b16 v[50:51], v28 offset:26624
    s_add_u32 m0, s51, 0x12000
    v_mfma_f32_16x16x32_bf16 v[148:151], v[84:87], v[76:79], v[148:151]
    ds_read_b64_tr_b16 v[52:53], v29 offset:24576
    buffer_load_dwordx4 v22, s[36:39], s49 offen lds
    v_mfma_f32_16x16x32_bf16 v[104:107], v[88:91], v[64:67], v[104:107]
    s_add_u32 s49, s49, 0x10000
    s_add_u32 s52, s52, 1
    v_mfma_f32_16x16x32_bf16 v[120:123], v[88:91], v[68:71], v[120:123]
    s_cmp_eq_u32 s52, 28
    s_cselect_b32 s36, s8, s36
    v_mfma_f32_16x16x32_bf16 v[136:139], v[88:91], v[72:75], v[136:139]
    s_cselect_b32 s37, s9, s37
    s_cselect_b32 s38, 0x200000, s38
    v_mfma_f32_16x16x32_bf16 v[152:155], v[88:91], v[76:79], v[152:155]
    s_cselect_b32 s49, s55, s49
    ds_read_b64_tr_b16 v[54:55], v29 offset:26624
    v_mfma_f32_16x16x32_bf16 v[108:111], v[92:95], v[64:67], v[108:111]
    ds_read_b64_tr_b16 v[56:57], v30 offset:24576
    ds_read_b64_tr_b16 v[58:59], v30 offset:26624
    v_mfma_f32_16x16x32_bf16 v[124:127], v[92:95], v[68:71], v[124:127]
    ds_read_b64_tr_b16 v[60:61], v31 offset:24576
    ds_read_b64_tr_b16 v[62:63], v31 offset:26624
    v_mfma_f32_16x16x32_bf16 v[140:143], v[92:95], v[72:75], v[140:143]
    v_mfma_f32_16x16x32_bf16 v[156:159], v[92:95], v[76:79], v[156:159]
    s_xor_b32 s62, s53, 2
    s_or_b32 s62, s62, s20
    s_cbranch_scc1 L_p2_p3ok
    s_mov_b32 s62, 0
    s_waitcnt vmcnt(6)
    s_branch L_p2_p3chk
L_p2_p3:
    buffer_load_dword v5, v6, s[28:31], s58 offen offset:128 sc1
    s_waitcnt vmcnt(0)
L_p2_p3chk:
    v_cmp_eq_u32 vcc, 1, v5
    s_nop 3
    s_and_b32 s63, vcc_lo, s59
    s_cmp_eq_u32 s63, s59
    s_cbranch_scc1 L_p2_p3ok
    s_sleep 1
    s_add_u32 s62, s62, 1
    s_cmp_lt_u32 s62, 0x20000
    s_cbranch_scc1 L_p2_p3
L_p2_p3ok:
    s_waitcnt vmcnt(12) lgkmcnt(0)
    s_barrier
    v_mfma_f32_16x16x32_bf16 v[96:99], v[48:51], v[32:35], v[96:99]
    s_add_u32 m0, s50, 0x18000
    ds_read_b128 v[64:67], v12 offset:49152
    buffer_load_dwordx4 v20, s[28:31], s48 offen lds
    v_mfma_f32_16x16x32_bf16 v[112:115], v[48:51], v[36:39], v[112:115]
    ds_read_b128 v[68:71], v13 offset:49152
    ds_read_b128 v[72:75], v14 offset:49152
    v_mfma_f32_16x16x32_bf16 v[128:131], v[48:51], v[40:43], v[128:131]
    s_add_u32 m0, s50, 0x1a000
    ds_read_b128 v[76:79], v15 offset:49152
    v_mfma_f32_16x16x32_bf16 v[144:147], v[48:51], v[44:47], v[144:147]
    buffer_load_dwordx4 v21, s[28:31], s48 offen lds
    s_add_u32 s48, s48, 1024
    v_mfma_f32_16x16x32_bf16 v[100:103], v[52:55], v[32:35], v[100:103]
    s_add_u32 s82, s82, 1
    s_cmp_eq_u32 s82, 28
    v_mfma_f32_16x16x32_bf16 v[116:119], v[52:55], v[36:39], v[116:119]
    s_cselect_b32 s48, s54, s48
    ds_read_b64_tr_b16 v[80:81], v28 offset:49152
    v_mfma_f32_16x16x32_bf16 v[132:135], v[52:55], v[40:43], v[132:135]
    ds_read_b64_tr_b16 v[82:83], v28 offset:51200
    s_add_u32 m0, s51, 0x18000
    v_mfma_f32_16x16x32_bf16 v[148:151], v[52:55], v[44:47], v[148:151]
    ds_read_b64_tr_b16 v[84:85], v29 offset:49152
    buffer_load_dwordx4 v22, s[36:39], s49 offen lds
    v_mfma_f32_16x16x32_bf16 v[104:107], v[56:59], v[32:35], v[104:107]
    s_add_u32 s49, s49, 0x10000
    s_add_u32 s52, s52, 1
    v_mfma_f32_16x16x32_bf16 v[120:123], v[56:59], v[36:39], v[120:123]
    s_cmp_eq_u32 s52, 28
    s_cselect_b32 s36, s8, s36
    v_mfma_f32_16x16x32_bf16 v[136:139], v[56:59], v[40:43], v[136:139]
    s_cselect_b32 s37, s9, s37
    s_cselect_b32 s38, 0x200000, s38
    v_mfma_f32_16x16x32_bf16 v[152:155], v[56:59], v[44:47], v[152:155]
    s_cselect_b32 s49, s55, s49
    ds_read_b64_tr_b16 v[86:87], v29 offset:51200
    v_mfma_f32_16x16x32_bf16 v[108:111], v[60:63], v[32:35], v[108:111]
    ds_read_b64_tr_b16 v[88:89], v30 offset:49152
    ds_read_b64_tr_b16 v[90:91], v30 offset:51200
    v_mfma_f32_16x16x32_bf16 v[124:127], v[60:63], v[36:39], v[124:127]
    ds_read_b64_tr_b16 v[92:93], v31 offset:49152
    ds_read_b64_tr_b16 v[94:95], v31 offset:51200
    v_mfma_f32_16x16x32_bf16 v[140:143], v[60:63], v[40:43], v[140:143]
    v_mfma_f32_16x16x32_bf16 v[156:159], v[60:63], v[44:47], v[156:159]
    s_waitcnt vmcnt(12) lgkmcnt(0)
    s_barrier
    v_mfma_f32_16x16x32_bf16 v[96:99], v[80:83], v[64:67], v[96:99]
    s_add_u32 m0, s50, 0x1e000
    ds_read_b128 v[32:35], v8 offset:0
    buffer_load_dwordx4 v20, s[28:31], s48 offen lds
    v_mfma_f32_16x16x32_bf16 v[112:115], v[80:83], v[68:71], v[112:115]
    ds_read_b128 v[36:39], v9 offset:0
    ds_read_b128 v[40:43], v10 offset:0
    v_mfma_f32_16x16x32_bf16 v[128:131], v[80:83], v[72:75], v[128:131]
    s_add_u32 m0, s50, 0x20000
    ds_read_b128 v[44:47], v11 offset:0
    v_mfma_f32_16x16x32_bf16 v[144:147], v[80:83], v[76:79], v[144:147]
    buffer_load_dwordx4 v21, s[28:31], s48 offen lds
    s_add_u32 s48, s48, 1024
    v_mfma_f32_16x16x32_bf16 v[100:103], v[84:87], v[64:67], v[100:103]
    s_add_u32 s82, s82, 1
    s_cmp_eq_u32 s82, 28
    v_mfma_f32_16x16x32_bf16 v[116:119], v[84:87], v[68:71], v[116:119]
    s_cselect_b32 s48, s54, s48
    ds_read_b64_tr_b16 v[48:49], v16 offset:0
    v_mfma_f32_16x16x32_bf16 v[132:135], v[84:87], v[72:75], v[132:135]
    ds_read_b64_tr_b16 v[50:51], v16 offset:2048
    s_add_u32 m0, s51, 0x1e000
    v_mfma_f32_16x16x32_bf16 v[148:151], v[84:87], v[76:79], v[148:151]
    ds_read_b64_tr_b16 v[52:53], v17 offset:0
    buffer_load_dwordx4 v22, s[36:39], s49 offen lds
    v_mfma_f32_16x16x32_bf16 v[104:107], v[88:91], v[64:67], v[104:107]
    s_add_u32 s49, s49, 0x10000
    s_add_u32 s52, s52, 1
    v_mfma_f32_16x16x32_bf16 v[120:123], v[88:91], v[68:71], v[120:123]
    s_cmp_eq_u32 s52, 28
    s_cselect_b32 s36, s8, s36
    v_mfma_f32_16x16x32_bf16 v[136:139], v[88:91], v[72:75], v[136:139]
    s_cselect_b32 s37, s9, s37
    s_cselect_b32 s38, 0x200000, s38
    v_mfma_f32_16x16x32_bf16 v[152:155], v[88:91], v[76:79], v[152:155]
    s_cselect_b32 s49, s55, s49
    ds_read_b64_tr_b16 v[54:55], v17 offset:2048
    v_mfma_f32_16x16x32_bf16 v[108:111], v[92:95], v[64:67], v[108:111]
    ds_read_b64_tr_b16 v[56:57], v18 offset:0
    ds_read_b64_tr_b16 v[58:59], v18 offset:2048
    v_mfma_f32_16x16x32_bf16 v[124:127], v[92:95], v[68:71], v[124:127]
    ds_read_b64_tr_b16 v[60:61], v19 offset:0
    ds_read_b64_tr_b16 v[62:63], v19 offset:2048
    v_mfma_f32_16x16x32_bf16 v[140:143], v[92:95], v[72:75], v[140:143]
    v_mfma_f32_16x16x32_bf16 v[156:159], v[92:95], v[76:79], v[156:159]
    s_waitcnt vmcnt(12) lgkmcnt(0)
    s_add_u32 s53, s53, 1
    s_cmp_lt_u32 s53, 4
    s_cbranch_scc1 L_p2_loop
    s_barrier
    v_mfma_f32_16x16x32_bf16 v[96:99], v[48:51], v[32:35], v[96:99]
    ds_read_b128 v[64:67], v8 offset:24576
    v_mfma_f32_16x16x32_bf16 v[112:115], v[48:51], v[36:39], v[112:115]
    ds_read_b128 v[68:71], v9 offset:24576
    v_mfma_f32_16x16x32_bf16 v[128:131], v[48:51], v[40:43], v[128:131]
    ds_read_b128 v[72:75], v10 offset:24576
    v_mfma_f32_16x16x32_bf16 v[144:147], v[48:51], v[44:47], v[144:147]
    ds_read_b128 v[76:79], v11 offset:24576
    v_mfma_f32_16x16x32_bf16 v[100:103], v[52:55], v[32:35], v[100:103]
    ds_read_b64_tr_b16 v[80:81], v16 offset:24576
    v_mfma_f32_16x16x32_bf16 v[116:119], v[52:55], v[36:39], v[116:119]
    ds_read_b64_tr_b16 v[82:83], v16 offset:26624
    v_mfma_f32_16x16x32_bf16 v[132:135], v[52:55], v[40:43], v[132:135]
    v_mfma_f32_16x16x32_bf16 v[148:151], v[52:55], v[44:47], v[148:151]
    ds_read_b64_tr_b16 v[84:85], v17 offset:24576
    v_mfma_f32_16x16x32_bf16 v[104:107], v[56:59], v[32:35], v[104:107]
    ds_read_b64_tr_b16 v[86:87], v17 offset:26624
    v_mfma_f32_16x16x32_bf16 v[120:123], v[56:59], v[36:39], v[120:123]
    ds_read_b64_tr_b16 v[88:89], v18 offset:24576
    v_mfma_f32_16x16x32_bf16 v[136:139], v[56:59], v[40:43], v[136:139]
    ds_read_b64_tr_b16 v[90:91], v18 offset:26624
    v_mfma_f32_16x16x32_bf16 v[152:155], v[56:59], v[44:47], v[152:155]
    ds_read_b64_tr_b16 v[92:93], v19 offset:24576
    v_mfma_f32_16x16x32_bf16 v[108:111], v[60:63], v[32:35], v[108:111]
    ds_read_b64_tr_b16 v[94:95], v19 offset:26624
    v_mfma_f32_16x16x32_bf16 v[124:127], v[60:63], v[36:39], v[124:127]
    v_mfma_f32_16x16x32_bf16 v[140:143], v[60:63], v[40:43], v[140:143]
    v_mfma_f32_16x16x32_bf16 v[156:159], v[60:63], v[44:47], v[156:159]
    s_waitcnt vmcnt(9) lgkmcnt(0)
    s_barrier
    v_mfma_f32_16x16x32_bf16 v[96:99], v[80:83], v[64:67], v[96:99]
    ds_read_b128 v[32:35], v8 offset:49152
    v_mfma_f32_16x16x32_bf16 v[112:115], v[80:83], v[68:71], v[112:115]
    ds_read_b128 v[36:39], v9 offset:49152
    v_mfma_f32_16x16x32_bf16 v[128:131], v[80:83], v[72:75], v[128:131]
    ds_read_b128 v[40:43], v10 offset:49152
    v_mfma_f32_16x16x32_bf16 v[144:147], v[80:83], v[76:79], v[144:147]
    ds_read_b128 v[44:47], v11 offset:49152
    v_mfma_f32_16x16x32_bf16 v[100:103], v[84:87], v[64:67], v[100:103]
    ds_read_b64_tr_b16 v[48:49], v16 offset:49152
    v_mfma_f32_16x16x32_bf16 v[116:119], v[84:87], v[68:71], v[116:119]
    ds_read_b64_tr_b16 v[50:51], v16 offset:51200
    v_mfma_f32_16x16x32_bf16 v[132:135], v[84:87], v[72:75], v[132:135]
    v_mfma_f32_16x16x32_bf16 v[148:151], v[84:87], v[76:79], v[148:151]
    ds_read_b64_tr_b16 v[52:53], v17 offset:49152
    v_mfma_f32_16x16x32_bf16 v[104:107], v[88:91], v[64:67], v[104:107]
    ds_read_b64_tr_b16 v[54:55], v17 offset:51200
    v_mfma_f32_16x16x32_bf16 v[120:123], v[88:91], v[68:71], v[120:123]
    ds_read_b64_tr_b16 v[56:57], v18 offset:49152
    v_mfma_f32_16x16x32_bf16 v[136:139], v[88:91], v[72:75], v[136:139]
    ds_read_b64_tr_b16 v[58:59], v18 offset:51200
    v_mfma_f32_16x16x32_bf16 v[152:155], v[88:91], v[76:79], v[152:155]
    ds_read_b64_tr_b16 v[60:61], v19 offset:49152
    v_mfma_f32_16x16x32_bf16 v[108:111], v[92:95], v[64:67], v[108:111]
    ds_read_b64_tr_b16 v[62:63], v19 offset:51200
    v_mfma_f32_16x16x32_bf16 v[124:127], v[92:95], v[68:71], v[124:127]
    v_mfma_f32_16x16x32_bf16 v[140:143], v[92:95], v[72:75], v[140:143]
    v_mfma_f32_16x16x32_bf16 v[156:159], v[92:95], v[76:79], v[156:159]
    s_waitcnt vmcnt(6) lgkmcnt(0)
    s_barrier
    v_mfma_f32_16x16x32_bf16 v[96:99], v[48:51], v[32:35], v[96:99]
    ds_read_b128 v[64:67], v12 offset:0
    v_mfma_f32_16x16x32_bf16 v[112:115], v[48:51], v[36:39], v[112:115]
    ds_read_b128 v[68:71], v13 offset:0
    v_mfma_f32_16x16x32_bf16 v[128:131], v[48:51], v[40:43], v[128:131]
    ds_read_b128 v[72:75], v14 offset:0
    v_mfma_f32_16x16x32_bf16 v[144:147], v[48:51], v[44:47], v[144:147]
    ds_read_b128 v[76:79], v15 offset:0
    v_mfma_f32_16x16x32_bf16 v[100:103], v[52:55], v[32:35], v[100:103]
    ds_read_b64_tr_b16 v[80:81], v28 offset:0
    v_mfma_f32_16x16x32_bf16 v[116:119], v[52:55], v[36:39], v[116:119]
    ds_read_b64_tr_b16 v[82:83], v28 offset:2048
    v_mfma_f32_16x16x32_bf16 v[132:135], v[52:55], v[40:43], v[132:135]
    v_mfma_f32_16x16x32_bf16 v[148:151], v[52:55], v[44:47], v[148:151]
    ds_read_b64_tr_b16 v[84:85], v29 offset:0
    v_mfma_f32_16x16x32_bf16 v[104:107], v[56:59], v[32:35], v[104:107]
    ds_read_b64_tr_b16 v[86:87], v29 offset:2048
    v_mfma_f32_16x16x32_bf16 v[120:123], v[56:59], v[36:39], v[120:123]
    ds_read_b64_tr_b16 v[88:89], v30 offset:0
    v_mfma_f32_16x16x32_bf16 v[136:139], v[56:59], v[40:43], v[136:139]
    ds_read_b64_tr_b16 v[90:91], v30 offset:2048
    v_mfma_f32_16x16x32_bf16 v[152:155], v[56:59], v[44:47], v[152:155]
    ds_read_b64_tr_b16 v[92:93], v31 offset:0
    v_mfma_f32_16x16x32_bf16 v[108:111], v[60:63], v[32:35], v[108:111]
    ds_read_b64_tr_b16 v[94:95], v31 offset:2048
    v_mfma_f32_16x16x32_bf16 v[124:127], v[60:63], v[36:39], v[124:127]
    v_mfma_f32_16x16x32_bf16 v[140:143], v[60:63], v[40:43], v[140:143]
    v_mfma_f32_16x16x32_bf16 v[156:159], v[60:63], v[44:47], v[156:159]
    s_waitcnt vmcnt(3) lgkmcnt(0)
    s_barrier
    v_mfma_f32_16x16x32_bf16 v[96:99], v[80:83], v[64:67], v[96:99]
    ds_read_b128 v[32:35], v12 offset:24576
    v_mfma_f32_16x16x32_bf16 v[112:115], v[80:83], v[68:71], v[112:115]
    ds_read_b128 v[36:39], v13 offset:24576
    v_mfma_f32_16x16x32_bf16 v[128:131], v[80:83], v[72:75], v[128:131]
    ds_read_b128 v[40:43], v14 offset:24576
    v_mfma_f32_16x16x32_bf16 v[144:147], v[80:83], v[76:79], v[144:147]
    ds_read_b128 v[44:47], v15 offset:24576
    v_mfma_f32_16x16x32_bf16 v[100:103], v[84:87], v[64:67], v[100:103]
    ds_read_b64_tr_b16 v[48:49], v28 offset:24576
    v_mfma_f32_16x16x32_bf16 v[116:119], v[84:87], v[68:71], v[116:119]
    ds_read_b64_tr_b16 v[50:51], v28 offset:26624
    v_mfma_f32_16x16x32_bf16 v[132:135], v[84:87], v[72:75], v[132:135]
    v_mfma_f32_16x16x32_bf16 v[148:151], v[84:87], v[76:79], v[148:151]
    ds_read_b64_tr_b16 v[52:53], v29 offset:24576
    v_mfma_f32_16x16x32_bf16 v[104:107], v[88:91], v[64:67], v[104:107]
    ds_read_b64_tr_b16 v[54:55], v29 offset:26624
    v_mfma_f32_16x16x32_bf16 v[120:123], v[88:91], v[68:71], v[120:123]
    ds_read_b64_tr_b16 v[56:57], v30 offset:24576
    v_mfma_f32_16x16x32_bf16 v[136:139], v[88:91], v[72:75], v[136:139]
    ds_read_b64_tr_b16 v[58:59], v30 offset:26624
    v_mfma_f32_16x16x32_bf16 v[152:155], v[88:91], v[76:79], v[152:155]
    ds_read_b64_tr_b16 v[60:61], v31 offset:24576
    v_mfma_f32_16x16x32_bf16 v[108:111], v[92:95], v[64:67], v[108:111]
    ds_read_b64_tr_b16 v[62:63], v31 offset:26624
    v_mfma_f32_16x16x32_bf16 v[124:127], v[92:95], v[68:71], v[124:127]
    v_mfma_f32_16x16x32_bf16 v[140:143], v[92:95], v[72:75], v[140:143]
    v_mfma_f32_16x16x32_bf16 v[156:159], v[92:95], v[76:79], v[156:159]
    s_waitcnt vmcnt(0) lgkmcnt(0)
    s_barrier
    v_mfma_f32_16x16x32_bf16 v[96:99], v[48:51], v[32:35], v[96:99]
    ds_read_b128 v[64:67], v12 offset:49152
    v_mfma_f32_16x16x32_bf16 v[112:115], v[48:51], v[36:39], v[112:115]
    ds_read_b128 v[68:71], v13 offset:49152
    v_mfma_f32_16x16x32_bf16 v[128:131], v[48:51], v[40:43], v[128:131]
    ds_read_b128 v[72:75], v14 offset:49152
    v_mfma_f32_16x16x32_bf16 v[144:147], v[48:51], v[44:47], v[144:147]
    ds_read_b128 v[76:79], v15 offset:49152
    v_mfma_f32_16x16x32_bf16 v[100:103], v[52:55], v[32:35], v[100:103]
    ds_read_b64_tr_b16 v[80:81], v28 offset:49152
    v_mfma_f32_16x16x32_bf16 v[116:119], v[52:55], v[36:39], v[116:119]
    ds_read_b64_tr_b16 v[82:83], v28 offset:51200
    v_mfma_f32_16x16x32_bf16 v[132:135], v[52:55], v[40:43], v[132:135]
    v_mfma_f32_16x16x32_bf16 v[148:151], v[52:55], v[44:47], v[148:151]
    ds_read_b64_tr_b16 v[84:85], v29 offset:49152
    v_mfma_f32_16x16x32_bf16 v[104:107], v[56:59], v[32:35], v[104:107]
    ds_read_b64_tr_b16 v[86:87], v29 offset:51200
    v_mfma_f32_16x16x32_bf16 v[120:123], v[56:59], v[36:39], v[120:123]
    ds_read_b64_tr_b16 v[88:89], v30 offset:49152
    v_mfma_f32_16x16x32_bf16 v[136:139], v[56:59], v[40:43], v[136:139]
    ds_read_b64_tr_b16 v[90:91], v30 offset:51200
    v_mfma_f32_16x16x32_bf16 v[152:155], v[56:59], v[44:47], v[152:155]
    ds_read_b64_tr_b16 v[92:93], v31 offset:49152
    v_mfma_f32_16x16x32_bf16 v[108:111], v[60:63], v[32:35], v[108:111]
    ds_read_b64_tr_b16 v[94:95], v31 offset:51200
    v_mfma_f32_16x16x32_bf16 v[124:127], v[60:63], v[36:39], v[124:127]
    v_mfma_f32_16x16x32_bf16 v[140:143], v[60:63], v[40:43], v[140:143]
    v_mfma_f32_16x16x32_bf16 v[156:159], v[60:63], v[44:47], v[156:159]
    s_waitcnt lgkmcnt(0)
    s_barrier
    v_mfma_f32_16x16x32_bf16 v[96:99], v[80:83], v[64:67], v[96:99]
    v_mfma_f32_16x16x32_bf16 v[112:115], v[80:83], v[68:71], v[112:115]
    v_mfma_f32_16x16x32_bf16 v[128:131], v[80:83], v[72:75], v[128:131]
    v_mfma_f32_16x16x32_bf16 v[144:147], v[80:83], v[76:79], v[144:147]
    v_mfma_f32_16x16x32_bf16 v[100:103], v[84:87], v[64:67], v[100:103]
    v_mfma_f32_16x16x32_bf16 v[116:119], v[84:87], v[68:71], v[116:119]
    v_mfma_f32_16x16x32_bf16 v[132:135], v[84:87], v[72:75], v[132:135]
    v_mfma_f32_16x16x32_bf16 v[148:151], v[84:87], v[76:79], v[148:151]
    v_mfma_f32_16x16x32_bf16 v[104:107], v[88:91], v[64:67], v[104:107]
    v_mfma_f32_16x16x32_bf16 v[120:123], v[88:91], v[68:71], v[120:123]
    v_mfma_f32_16x16x32_bf16 v[136:139], v[88:91], v[72:75], v[136:139]
    v_mfma_f32_16x16x32_bf16 v[152:155], v[88:91], v[76:79], v[152:155]
    v_mfma_f32_16x16x32_bf16 v[108:111], v[92:95], v[64:67], v[108:111]
    v_mfma_f32_16x16x32_bf16 v[124:127], v[92:95], v[68:71], v[124:127]
    v_mfma_f32_16x16x32_bf16 v[140:143], v[92:95], v[72:75], v[140:143]
    v_mfma_f32_16x16x32_bf16 v[156:159], v[92:95], v[76:79], v[156:159]
    v_lshlrev_b32 v23, 4, v2
    s_lshl_b32 s60, s23, 3
    s_add_u32 s60, s60, s74
    s_lshl_b32 s61, s60, 18
    s_lshl_b32 s62, s20, 11
    s_add_u32 s61, s61, s62
    s_add_u32 s61, s61, 0x1400000
    s_lshl_b32 s62, s72, 14
    s_add_u32 s76, s61, s62
    s_lshl_b32 s62, s72, 16
    s_add_u32 s77, s61, s62
    s_lshl_b32 s61, s23, 2
    s_add_u32 s61, s61, s85
    s_lshl_b32 s61, s61, 2
    s_add_u32 s61, s61, s72
    s_lshl_b32 s61, s61, 15
    s_lshl_b32 s62, s74, 8
    s_add_u32 s61, s61, s62
    s_lshl_b32 s62, s86, 7
    s_add_u32 s79, s61, s62
    s_nop 4
    s_xor_b32 s61, s72, 1
    s_lshl_b32 s61, s61, 16
    s_add_u32 s61, s61, s76
    v_cvt_pk_bf16_f32 v160, v112, v113
    v_cvt_pk_bf16_f32 v161, v114, v115
    v_cvt_pk_bf16_f32 v162, v116, v117
    v_cvt_pk_bf16_f32 v163, v118, v119
    v_cvt_pk_bf16_f32 v164, v120, v121
    v_cvt_pk_bf16_f32 v165, v122, v123
    v_cvt_pk_bf16_f32 v166, v124, v125
    v_cvt_pk_bf16_f32 v167, v126, v127
    buffer_store_dwordx4 v[160:163], v23, s[28:31], s61 offen offset:0 sc1
    buffer_store_dwordx4 v[164:167], v23, s[28:31], s61 offen offset:1024 sc1
    s_xor_b32 s61, s72, 2
    s_lshl_b32 s61, s61, 16
    s_add_u32 s61, s61, s76
    v_cvt_pk_bf16_f32 v168, v128, v129
    v_cvt_pk_bf16_f32 v169, v130, v131
    v_cvt_pk_bf16_f32 v170, v132, v133
    v_cvt_pk_bf16_f32 v171, v134, v135
    v_cvt_pk_bf16_f32 v172, v136, v137
    v_cvt_pk_bf16_f32 v173, v138, v139
    v_cvt_pk_bf16_f32 v174, v140, v141
    v_cvt_pk_bf16_f32 v175, v142, v143
    buffer_store_dwordx4 v[168:171], v23, s[28:31], s61 offen offset:0 sc1
    buffer_store_dwordx4 v[172:175], v23, s[28:31], s61 offen offset:1024 sc1
    s_xor_b32 s61, s72, 3
    s_lshl_b32 s61, s61, 16
    s_add_u32 s61, s61, s76
    v_cvt_pk_bf16_f32 v176, v144, v145
    v_cvt_pk_bf16_f32 v177, v146, v147
    v_cvt_pk_bf16_f32 v178, v148, v149
    v_cvt_pk_bf16_f32 v179, v150, v151
    v_cvt_pk_bf16_f32 v180, v152, v153
    v_cvt_pk_bf16_f32 v181, v154, v155
    v_cvt_pk_bf16_f32 v182, v156, v157
    v_cvt_pk_bf16_f32 v183, v158, v159
    buffer_store_dwordx4 v[176:179], v23, s[28:31], s61 offen offset:0 sc1
    buffer_store_dwordx4 v[180:183], v23, s[28:31], s61 offen offset:1024 sc1
    v_lshlrev_b32 v24, 3, v4
    v_lshl_add_u32 v24, v3, 11, v24
    buffer_load_dwordx2 v[8:9], v24, s[32:35], s79 offen offset:0
    buffer_load_dwordx2 v[10:11], v24, s[32:35], s79 offen offset:32
    buffer_load_dwordx2 v[12:13], v24, s[32:35], s79 offen offset:64
    buffer_load_dwordx2 v[14:15], v24, s[32:35], s79 offen offset:96
    v_and_b32 v25, 1, v4
    v_lshrrev_b32 v26, 1, v4
    v_lshlrev_b32 v25, 5, v25
    v_lshl_add_u32 v25, v26, 4, v25
    v_lshl_add_u32 v25, v3, 11, v25
    s_lshl_b32 s78, s60, 12
    s_lshl_b32 s62, s20, 7
    s_add_u32 s78, s78, s62
    s_add_u32 s78, s78, 0x3820000
    v_and_b32 v6, 3, v2
    v_xor_b32 v6, s72, v6
    v_lshlrev_b32 v6, 10, v6
    v_mov_b32 v26, 1
    s_waitcnt vmcnt(4)
    s_mov_b64 exec, 1
    buffer_store_dword v26, v6, s[28:31], s78 offen sc1
    s_mov_b64 exec, -1
    s_mov_b32 s62, 0
L_p2_poll2:
    s_mov_b64 exec, 14
    buffer_load_dword v5, v6, s[28:31], s78 offen sc1
    s_mov_b64 exec, -1
    s_waitcnt vmcnt(0)
    v_cmp_eq_u32 vcc, 1, v5
    s_nop 3
    s_and_b32 s63, vcc_lo, 14
    s_cmp_eq_u32 s63, 14
    s_cbranch_scc1 L_p2_go
    s_sleep 1
    s_add_u32 s62, s62, 1
    s_cmp_lt_u32 s62, 0x20000
    s_cbranch_scc1 L_p2_poll2
L_p2_go:
    s_xor_b32 s61, s72, 1
    s_lshl_b32 s61, s61, 14
    s_add_u32 s61, s61, s77
    buffer_load_dwordx4 v[32:35], v23, s[28:31], s61 offen offset:0 sc1
    buffer_load_dwordx4 v[36:39], v23, s[28:31], s61 offen offset:1024 sc1
    s_xor_b32 s61, s72, 2
    s_lshl_b32 s61, s61, 14
    s_add_u32 s61, s61, s77
    buffer_load_dwordx4 v[40:43], v23, s[28:31], s61 offen offset:0 sc1
    buffer_load_dwordx4 v[44:47], v23, s[28:31], s61 offen offset:1024 sc1
    s_xor_b32 s61, s72, 3
    s_lshl_b32 s61, s61, 14
    s_add_u32 s61, s61, s77
    buffer_load_dwordx4 v[48:51], v23, s[28:31], s61 offen offset:0 sc1
    buffer_load_dwordx4 v[52:55], v23, s[28:31], s61 offen offset:1024 sc1
    v_lshlrev_b32 v16, 16, v8
    v_and_b32 v17, s84, v8
    v_lshlrev_b32 v18, 16, v9
    v_and_b32 v19, s84, v9
    v_add_f32 v96, v96, v16
    v_add_f32 v97, v97, v17
    v_add_f32 v98, v98, v18
    v_add_f32 v99, v99, v19
    v_lshlrev_b32 v16, 16, v10
    v_and_b32 v17, s84, v10
    v_lshlrev_b32 v18, 16, v11
    v_and_b32 v19, s84, v11
    v_add_f32 v100, v100, v16
    v_add_f32 v101, v101, v17
    v_add_f32 v102, v102, v18
    v_add_f32 v103, v103, v19
    v_lshlrev_b32 v16, 16, v12
    v_and_b32 v17, s84, v12
    v_lshlrev_b32 v18, 16, v13
    v_and_b32 v19, s84, v13
    v_add_f32 v104, v104, v16
    v_add_f32 v105, v105, v17
    v_add_f32 v106, v106, v18
    v_add_f32 v107, v107, v19
    v_lshlrev_b32 v16, 16, v14
    v_and_b32 v17, s84, v14
    v_lshlrev_b32 v18, 16, v15
    v_and_b32 v19, s84, v15
    v_add_f32 v108, v108, v16
    v_add_f32 v109, v109, v17
    v_add_f32 v110, v110, v18
    v_add_f32 v111, v111, v19
    s_waitcnt vmcnt(4)
    v_lshlrev_b32 v64, 16, v32
    v_and_b32 v65, s84, v32
    v_lshlrev_b32 v66, 16, v33
    v_and_b32 v67, s84, v33
    v_lshlrev_b32 v68, 16, v34
    v_and_b32 v69, s84, v34
    v_lshlrev_b32 v70, 16, v35
    v_and_b32 v71, s84, v35
    v_lshlrev_b32 v72, 16, v36
    v_and_b32 v73, s84, v36
    v_lshlrev_b32 v74, 16, v37
    v_and_b32 v75, s84, v37
    v_lshlrev_b32 v76, 16, v38
    v_and_b32 v77, s84, v38
    v_lshlrev_b32 v78, 16, v39
    v_and_b32 v79, s84, v39
    v_pk_add_f32 v[96:97], v[96:97], v[64:65]
    v_pk_add_f32 v[98:99], v[98:99], v[66:67]
    v_pk_add_f32 v[100:101], v[100:101], v[68:69]
    v_pk_add_f32 v[102:103], v[102:103], v[70:71]
    v_pk_add_f32 v[104:105], v[104:105], v[72:73]
    v_pk_add_f32 v[106:107], v[106:107], v[74:75]
    v_pk_add_f32 v[108:109], v[108:109], v[76:77]
    v_pk_add_f32 v[110:111], v[110:111], v[78:79]
    s_waitcnt vmcnt(2)
    v_lshlrev_b32 v64, 16, v40
    v_and_b32 v65, s84, v40
    v_lshlrev_b32 v66, 16, v41
    v_and_b32 v67, s84, v41
    v_lshlrev_b32 v68, 16, v42
    v_and_b32 v69, s84, v42
    v_lshlrev_b32 v70, 16, v43
    v_and_b32 v71, s84, v43
    v_lshlrev_b32 v72, 16, v44
    v_and_b32 v73, s84, v44
    v_lshlrev_b32 v74, 16, v45
    v_and_b32 v75, s84, v45
    v_lshlrev_b32 v76, 16, v46
    v_and_b32 v77, s84, v46
    v_lshlrev_b32 v78, 16, v47
    v_and_b32 v79, s84, v47
    v_pk_add_f32 v[96:97], v[96:97], v[64:65]
    v_pk_add_f32 v[98:99], v[98:99], v[66:67]
    v_pk_add_f32 v[100:101], v[100:101], v[68:69]
    v_pk_add_f32 v[102:103], v[102:103], v[70:71]
    v_pk_add_f32 v[104:105], v[104:105], v[72:73]
    v_pk_add_f32 v[106:107], v[106:107], v[74:75]
    v_pk_add_f32 v[108:109], v[108:109], v[76:77]
    v_pk_add_f32 v[110:111], v[110:111], v[78:79]
    s_waitcnt vmcnt(0)
    v_lshlrev_b32 v64, 16, v48
    v_and_b32 v65, s84, v48
    v_lshlrev_b32 v66, 16, v49
    v_and_b32 v67, s84, v49
    v_lshlrev_b32 v68, 16, v50
    v_and_b32 v69, s84, v50
    v_lshlrev_b32 v70, 16, v51
    v_and_b32 v71, s84, v51
    v_lshlrev_b32 v72, 16, v52
    v_and_b32 v73, s84, v52
    v_lshlrev_b32 v74, 16, v53
    v_and_b32 v75, s84, v53
    v_lshlrev_b32 v76, 16, v54
    v_and_b32 v77, s84, v54
    v_lshlrev_b32 v78, 16, v55
    v_and_b32 v79, s84, v55
    v_pk_add_f32 v[96:97], v[96:97], v[64:65]
    v_pk_add_f32 v[98:99], v[98:99], v[66:67]
    v_pk_add_f32 v[100:101], v[100:101], v[68:69]
    v_pk_add_f32 v[102:103], v[102:103], v[70:71]
    v_pk_add_f32 v[104:105], v[104:105], v[72:73]
    v_pk_add_f32 v[106:107], v[106:107], v[74:75]
    v_pk_add_f32 v[108:109], v[108:109], v[76:77]
    v_pk_add_f32 v[110:111], v[110:111], v[78:79]
    v_cvt_pk_bf16_f32 v8, v96, v97
    v_cvt_pk_bf16_f32 v9, v98, v99
    v_cvt_pk_bf16_f32 v10, v100, v101
    v_cvt_pk_bf16_f32 v11, v102, v103
    s_nop 1
    v_permlane16_swap_b32 v8, v10
    v_permlane16_swap_b32 v9, v11
    s_nop 0
    buffer_store_dwordx4 v[8:11], v25, s[44:47], s79 offen offset:0
    v_cvt_pk_bf16_f32 v12, v104, v105
    v_cvt_pk_bf16_f32 v13, v106, v107
    v_cvt_pk_bf16_f32 v14, v108, v109
    v_cvt_pk_bf16_f32 v15, v110, v111
    s_nop 1
    v_permlane16_swap_b32 v12, v14
    v_permlane16_swap_b32 v13, v15
    s_nop 0
    buffer_store_dwordx4 v[12:15], v25, s[44:47], s79 offen offset:64
L_end:
    s_endpgm
.section .rodata,"a"
.p2align 6
.amdhsa_kernel parallel_sum__sliding_local_dilated__dense_activation_relu__prompt_kernel
  .amdhsa_next_free_vgpr 256
  .amdhsa_next_free_sgpr 96
  .amdhsa_accum_offset 256
  .amdhsa_group_segment_fixed_size 0
  .amdhsa_kernarg_size 72
  .amdhsa_user_sgpr_count 2
  .amdhsa_user_sgpr_kernarg_segment_ptr 1
  .amdhsa_system_sgpr_workgroup_id_x 1
.end_amdhsa_kernel
```
